```python
import torch

def _softmax(x, axis=-1):
    return torch.softmax(x, dim=axis)
def _gelu(x):
    return torch.nn.functional.gelu(x, approximate="tanh")
def _silu(x):
    return torch.nn.functional.silu(x)
def _sigmoid(x):
    return torch.sigmoid(x)
def _layernorm(x, axis=-1, eps=1e-5):
    m = x.mean(dim=axis, keepdim=True)
    v = x.var(dim=axis, keepdim=True, unbiased=False)
    return (x - m) / torch.sqrt(v + eps)
def _scatter_add(tgt, idx, src, axis=0):
    return tgt.clone().index_add_(axis, idx, src)
def _segment_sum(src, seg, n):
    out = torch.zeros((n,) + src.shape[1:], dtype=src.dtype)
    return out.index_add_(0, seg, src)
def _pad(x, pw):
    flat = tuple(v for pair in reversed(pw) for v in pair)
    return torch.nn.functional.pad(x, flat)

kernel_name = 'sequential_preLN__softmax_full_mha__glu_gated_reglu__prompt'

def setup_inputs():

    _w = (lambda a: (lambda t: t.to(torch.bfloat16) if t.is_floating_point() else t)(torch.as_tensor(a)))
    def _A_setup():
        B, S, D = 1, 2048, 448
        return {
            "x": _w((lambda *s: torch.randn(*s, dtype=torch.bfloat16) * 0.05)(B, S, D)),
            "wqkv": _w((lambda *s: torch.randn(*s, dtype=torch.bfloat16) * 0.05)(D, 3 * D)),
            "wo": _w((lambda *s: torch.randn(*s, dtype=torch.bfloat16) * 0.05)(D, D)),
        }
    _A_in = _A_setup()

    def _B_setup():
        B, S, D, F = 1, 2048, 448, 1792
        return {
            "x": _w((lambda *s: torch.randn(*s, dtype=torch.bfloat16) * 0.05)(B, S, D)),
            "W_gate": _w((lambda *s: torch.randn(*s, dtype=torch.bfloat16) * 0.4)(D, F) * (2.0 / D) ** 0.5),
            "W_up": _w((lambda *s: torch.randn(*s, dtype=torch.bfloat16) * 0.4)(D, F) * (2.0 / D) ** 0.5),
            "W_down": _w((lambda *s: torch.randn(*s, dtype=torch.bfloat16) * 0.4)(F, D) * (1.0 / F) ** 0.5),
        }
    _B_in = _B_setup()

    return {
        "A_x": _A_in["x"],
        "A_wqkv": _A_in["wqkv"],
        "A_wo": _A_in["wo"],
        "B_x": _B_in["x"],
        "B_W_gate": _B_in["W_gate"],
        "B_W_up": _B_in["W_up"],
        "B_W_down": _B_in["W_down"],
    }

def reference(A_x, A_wqkv, A_wo, B_x, B_W_gate, B_W_up, B_W_down):
    def _A_ref(x, wqkv, wo):
        B, S, D = x.shape
        H = 16; Dh = D // H
        qkv = (lambda x, *d: x.permute(*d))((x @ wqkv).reshape(B, S, 3, H, Dh), 2, 0, 3, 1, 4)
        q, k, v = qkv[0], qkv[1], qkv[2]
        scale = Dh ** -0.5
        scores = torch.einsum("bhqd,bhkd->bhqk", q, k) * scale
        p = _softmax(scores, axis=-1)
        o = torch.einsum("bhqk,bhkd->bhqd", p, v)
        return (lambda x, *d: x.permute(*d))(o, 0, 2, 1, 3).reshape(B, S, D) @ wo

    def _B_ref(x, W_gate, W_up, W_down):
        gate = torch.einsum("bsd,df->bsf", x, W_gate)
        up = torch.einsum("bsd,df->bsf", x, W_up)
        gate = gate * (lambda x, dt: x.to(dt))(gate > 0, gate.dtype)
        h = gate * up
        return torch.einsum("bsf,fd->bsd", h, W_down)

    x = A_x
    h = x + _A_ref(_layernorm(x, axis=-1), A_wqkv, A_wo)
    h2 = h + _B_ref(_layernorm(h, axis=-1), B_W_gate, B_W_up, B_W_down)
    return h2
```

```asm
; @launch grid=(256,1,1) block=(512,1,1) lds=163840
.amdgcn_target "amdgcn-amd-amdhsa--gfx950"
.text
.globl sequential_preLN__softmax_full_mha__glu_gated_reglu__prompt_kernel
.p2align 8
.type sequential_preLN__softmax_full_mha__glu_gated_reglu__prompt_kernel,@function
sequential_preLN__softmax_full_mha__glu_gated_reglu__prompt_kernel:
    s_cmp_ge_u32 s2, 256
    s_cbranch_scc1 L_end
    s_load_dwordx16 s[64:79], s[0:1], 0
    s_load_dwordx4 s[80:83], s[0:1], 64
    s_getpc_b64 s[6:7]
    s_lshr_b32 s5, s2, 3
    s_and_b32 s5, s5, 7
    s_lshl_b32 s5, s5, 13
    v_lshl_add_u32 v1, v0, 4, s5
    v_min_u32 v1, L_end-sequential_preLN__softmax_full_mha__glu_gated_reglu__prompt_kernel-16, v1
    s_and_b32 s6, s6, 0xffffff00
    global_load_dwordx4 v[252:255], v1, s[6:7]
    v_lshrrev_b32 v1, 6, v0
    s_nop 0
    v_readfirstlane_b32 s3, v1
    v_and_b32 v1, 63, v0
    s_and_b32 s5, s2, 7
    s_lshr_b32 s6, s2, 3
    s_and_b32 s4, s3, 3
    s_lshr_b32 s52, s5, 1
    s_lshl_b32 s52, s52, 2
    s_and_b32 s53, s6, 3
    s_add_u32 s52, s52, s53
    s_and_b32 s53, s5, 1
    s_lshl_b32 s53, s53, 3
    s_lshr_b32 s54, s6, 2
    s_add_u32 s53, s53, s54
    s_lshl_b32 s54, s52, 2
    s_add_u32 s54, s54, s4
    s_and_b32 s55, s53, 1
    s_lshl_b32 s55, s55, 3
    s_mov_b32 s10, 0x1c0000
    s_mov_b32 s11, 0x00020000
    s_mov_b32 s14, 0x126000
    s_mov_b32 s15, 0x00020000
    v_lshrrev_b32 v2, 3, v1
    v_mul_u32_u24 v2, 896, v2
    v_lshrrev_b32 v3, 4, v1
    v_and_b32 v9, 7, v1
    v_xor_b32 v3, v3, v9
    v_lshl_add_u32 v2, v3, 4, v2
    v_xor_b32 v3, 64, v2
    s_mul_i32 s56, s54, 28672
    s_lshl_b32 s57, s4, 12
    v_add_u32 v9, 0, v1
    v_mul_u32_u24 v10, 43691, v9
    v_lshrrev_b32 v10, 19, v10
    v_mul_u32_u24 v11, 12, v10
    v_sub_u32 v11, v9, v11
    v_min_u32 v11, 10, v11
    v_mul_u32_u24 v10, 2688, v10
    v_lshl_add_u32 v16, v11, 4, v10
    v_add_u32 v9, 64, v1
    v_mul_u32_u24 v10, 43691, v9
    v_lshrrev_b32 v10, 19, v10
    v_mul_u32_u24 v11, 12, v10
    v_sub_u32 v11, v9, v11
    v_min_u32 v11, 10, v11
    v_mul_u32_u24 v10, 2688, v10
    v_lshl_add_u32 v17, v11, 4, v10
    v_add_u32 v9, 128, v1
    v_mul_u32_u24 v10, 43691, v9
    v_lshrrev_b32 v10, 19, v10
    v_mul_u32_u24 v11, 12, v10
    v_sub_u32 v11, v9, v11
    v_min_u32 v11, 10, v11
    v_mul_u32_u24 v10, 2688, v10
    v_lshl_add_u32 v18, v11, 4, v10
    s_mul_i32 s58, s53, 168
    s_sub_u32 s58, s58, s55
    s_mul_i32 s59, s4, 43008
    s_add_u32 s58, s58, s59
    s_mul_i32 s59, s4, 3072
    s_add_u32 s59, s59, 16384
    s_and_b32 s46, s6, 3
    s_mul_i32 s46, s46, 0
    s_lshr_b32 s47, s6, 2
    s_and_b32 s47, s47, 3
    s_mul_i32 s47, s47, 2
    s_add_u32 s46, s46, s47
    s_mul_i32 s47, s5, 2
    s_add_u32 s46, s46, s47
    s_mul_i32 s47, s46, 9363
    s_lshr_b32 s47, s47, 16
    s_mul_i32 s47, s47, 7
    s_sub_u32 s46, s46, s47
    s_mov_b32 s47, 0
    s_waitcnt lgkmcnt(0)
    s_mov_b64 s[8:9], s[64:65]
    s_mov_b64 s[12:13], s[66:67]
    s_cmp_lt_u32 s3, 4
    s_cbranch_scc1 L_compute
    s_lshl_b32 s60, s46, 7
    s_add_u32 s60, s60, s56
    s_add_u32 m0, s57, s47
    s_mul_i32 s61, s46, 172032
    buffer_load_dwordx4 v2, s[8:11], s60 offen lds
    s_add_u32 m0, m0, 1024
    s_add_u32 s60, s60, 7168
    buffer_load_dwordx4 v3, s[8:11], s60 offen lds
    s_add_u32 m0, m0, 1024
    s_add_u32 s60, s60, 7168
    buffer_load_dwordx4 v2, s[8:11], s60 offen lds
    s_add_u32 m0, m0, 1024
    s_add_u32 s60, s60, 7168
    buffer_load_dwordx4 v3, s[8:11], s60 offen lds
    s_add_u32 m0, s59, s47
    s_add_u32 s61, s61, s58
    buffer_load_dwordx4 v16, s[12:15], s61 offen lds
    s_add_u32 m0, m0, 1024
    s_nop 0
    buffer_load_dwordx4 v17, s[12:15], s61 offen lds
    s_add_u32 m0, m0, 1024
    s_nop 0
    buffer_load_dwordx4 v18, s[12:15], s61 offen lds
    s_add_u32 s46, s46, 1
    s_cmp_eq_u32 s46, 7
    s_cselect_b32 s46, 0, s46
    s_add_u32 s47, s47, 28672
    s_cmp_eq_u32 s47, 143360
    s_cselect_b32 s47, 0, s47
    s_add_u32 s46, s46, 1
    s_cmp_eq_u32 s46, 7
    s_cselect_b32 s46, 0, s46
    s_add_u32 s47, s47, 28672
    s_cmp_eq_u32 s47, 143360
    s_cselect_b32 s47, 0, s47
    s_mov_b32 s18, 0x62000
    s_mov_b32 s19, 0x00020000
    s_mov_b32 s22, 0x10000000
    s_mov_b32 s23, 0x00020000
    s_mov_b32 s26, 0x188000
    s_mov_b32 s27, 0x00020000
    s_mov_b32 s30, 0x188000
    s_mov_b32 s31, 0x00020000
    s_mov_b32 s34, 0x188000
    s_mov_b32 s35, 0x00020000
    s_mov_b32 s38, 0x1c0000
    s_mov_b32 s39, 0x00020000
    s_mov_b32 s42, 0x100
    s_mov_b32 s43, 0x00020000
    s_mov_b64 s[16:17], s[68:69]
    s_mov_b64 s[24:25], s[72:73]
    s_mov_b64 s[28:29], s[74:75]
    s_mov_b64 s[32:33], s[76:77]
    s_mov_b64 s[36:37], s[78:79]
    s_mov_b64 s[40:41], s[80:81]
    s_mov_b64 s[20:21], s[82:83]
    v_and_b32 v12, 31, v1
    v_lshrrev_b32 v13, 5, v1
    v_mov_b32 v15, 0x3f803f80
    s_cmp_lg_u32 s3, 4
    s_cbranch_scc1 L_h_nononce
    s_cmp_lg_u32 s2, 0
    s_cbranch_scc1 L_h_nononce
    s_memrealtime s[44:45]
    s_waitcnt lgkmcnt(0)
    s_or_b32 s45, s45, 0x80000000
    v_mov_b32 v10, s44
    v_mov_b32 v11, s45
    v_mov_b32 v9, 0
    s_mov_b64 exec, 1
    buffer_store_dwordx2 v[10:11], v9, s[40:43], 0 offen sc0 sc1
    s_mov_b64 exec, -1
L_h_nononce:
    v_and_b32 v9, 15, v1
    v_lshrrev_b32 v10, 1, v9
    v_lshrrev_b32 v11, 4, v1
    v_xor_b32 v10, v10, v11
    v_lshlrev_b32 v10, 4, v10
    v_lshl_add_u32 v10, v9, 7, v10
    v_add_u32 v4, s57, v10
    v_xor_b32 v5, 64, v4
    v_lshlrev_b32 v14, 2, v11
    v_add_u32 v14, 163328, v14
    v_mov_b32 v10, 0
    ds_write_b32 v14, v10
    s_and_b32 s63, s3, 1
    s_lshl_b32 s60, s4, 7
    v_lshl_add_u32 v8, v12, 2, s60
    v_add_u32 v19, 162816, v8
    v_add_u32 v8, 159744, v8
    s_lshl_b32 s60, s4, 8
    s_add_u32 s60, s60, 161792
    v_lshl_add_u32 v9, v9, 2, s60
    s_setprio 3
    v_mov_b32 v88, v15
    v_mov_b32 v89, v15
    v_mov_b32 v90, v15
    v_mov_b32 v91, v15
    s_waitcnt vmcnt(0)
    s_waitcnt lgkmcnt(0)
    s_barrier
    ds_read_b128 v[96:99], v4 offset:0
    ds_read_b128 v[100:103], v4 offset:2048
    ds_read_b128 v[104:107], v5 offset:0
    ds_read_b128 v[108:111], v5 offset:2048
    s_lshl_b32 s60, s46, 7
    s_add_u32 s60, s60, s56
    s_add_u32 m0, s57, s47
    s_mul_i32 s61, s46, 172032
    buffer_load_dwordx4 v2, s[8:11], s60 offen lds
    s_add_u32 m0, m0, 1024
    s_add_u32 s60, s60, 7168
    buffer_load_dwordx4 v3, s[8:11], s60 offen lds
    s_add_u32 m0, m0, 1024
    s_add_u32 s60, s60, 7168
    buffer_load_dwordx4 v2, s[8:11], s60 offen lds
    s_add_u32 m0, m0, 1024
    s_add_u32 s60, s60, 7168
    buffer_load_dwordx4 v3, s[8:11], s60 offen lds
    s_add_u32 m0, s59, s47
    s_add_u32 s61, s61, s58
    buffer_load_dwordx4 v16, s[12:15], s61 offen lds
    s_add_u32 m0, m0, 1024
    s_nop 0
    buffer_load_dwordx4 v17, s[12:15], s61 offen lds
    s_add_u32 m0, m0, 1024
    s_nop 0
    buffer_load_dwordx4 v18, s[12:15], s61 offen lds
    s_add_u32 s46, s46, 1
    s_cmp_eq_u32 s46, 7
    s_cselect_b32 s46, 0, s46
    s_add_u32 s47, s47, 28672
    s_cmp_eq_u32 s47, 143360
    s_cselect_b32 s47, 0, s47
    s_waitcnt lgkmcnt(0)
    s_barrier
    v_add_u32 v4, 0x7000, v4
    v_add_u32 v5, 0x7000, v5
    ds_read_b128 v[112:115], v4 offset:0
    ds_read_b128 v[116:119], v4 offset:2048
    ds_read_b128 v[120:123], v5 offset:0
    ds_read_b128 v[124:127], v5 offset:2048
    s_lshl_b32 s60, s46, 7
    s_add_u32 s60, s60, s56
    s_add_u32 m0, s57, s47
    s_mul_i32 s61, s46, 172032
    buffer_load_dwordx4 v2, s[8:11], s60 offen lds
    s_add_u32 m0, m0, 1024
    s_add_u32 s60, s60, 7168
    buffer_load_dwordx4 v3, s[8:11], s60 offen lds
    s_add_u32 m0, m0, 1024
    s_add_u32 s60, s60, 7168
    buffer_load_dwordx4 v2, s[8:11], s60 offen lds
    s_add_u32 m0, m0, 1024
    s_add_u32 s60, s60, 7168
    buffer_load_dwordx4 v3, s[8:11], s60 offen lds
    s_add_u32 m0, s59, s47
    s_add_u32 s61, s61, s58
    buffer_load_dwordx4 v16, s[12:15], s61 offen lds
    s_add_u32 m0, m0, 1024
    s_nop 0
    buffer_load_dwordx4 v17, s[12:15], s61 offen lds
    s_add_u32 m0, m0, 1024
    s_nop 0
    buffer_load_dwordx4 v18, s[12:15], s61 offen lds
    s_add_u32 s46, s46, 1
    s_cmp_eq_u32 s46, 7
    s_cselect_b32 s46, 0, s46
    s_add_u32 s47, s47, 28672
    s_cmp_eq_u32 s47, 143360
    s_cselect_b32 s47, 0, s47
    s_lshl_b32 s60, s46, 7
    s_add_u32 s60, s60, s56
    s_add_u32 m0, s57, s47
    s_mul_i32 s61, s46, 172032
    buffer_load_dwordx4 v2, s[8:11], s60 offen lds
    s_add_u32 m0, m0, 1024
    s_add_u32 s60, s60, 7168
    buffer_load_dwordx4 v3, s[8:11], s60 offen lds
    s_add_u32 m0, m0, 1024
    s_add_u32 s60, s60, 7168
    buffer_load_dwordx4 v2, s[8:11], s60 offen lds
    s_add_u32 m0, m0, 1024
    s_add_u32 s60, s60, 7168
    buffer_load_dwordx4 v3, s[8:11], s60 offen lds
    s_add_u32 m0, s59, s47
    s_add_u32 s61, s61, s58
    buffer_load_dwordx4 v16, s[12:15], s61 offen lds
    s_add_u32 m0, m0, 1024
    s_nop 0
    buffer_load_dwordx4 v17, s[12:15], s61 offen lds
    s_add_u32 m0, m0, 1024
    s_nop 0
    buffer_load_dwordx4 v18, s[12:15], s61 offen lds
    s_add_u32 s46, s46, 1
    s_cmp_eq_u32 s46, 7
    s_cselect_b32 s46, 0, s46
    s_add_u32 s47, s47, 28672
    s_cmp_eq_u32 s47, 143360
    s_cselect_b32 s47, 0, s47
    v_mfma_f32_16x16x32_bf16 v[68:71], v[96:99], v[96:99], 0
    v_mfma_f32_16x16x32_bf16 v[76:79], v[88:91], v[96:99], 0
    v_mfma_f32_16x16x32_bf16 v[72:75], v[100:103], v[100:103], 0
    v_mfma_f32_16x16x32_bf16 v[80:83], v[88:91], v[100:103], 0
    v_mfma_f32_16x16x32_bf16 v[68:71], v[104:107], v[104:107], v[68:71]
    v_mfma_f32_16x16x32_bf16 v[76:79], v[88:91], v[104:107], v[76:79]
    v_mfma_f32_16x16x32_bf16 v[72:75], v[108:111], v[108:111], v[72:75]
    v_mfma_f32_16x16x32_bf16 v[80:83], v[88:91], v[108:111], v[80:83]
    s_waitcnt vmcnt(14)
    s_waitcnt lgkmcnt(0)
    s_barrier
    v_add_u32 v4, 0x7000, v4
    v_add_u32 v5, 0x7000, v5
    ds_read_b128 v[96:99], v4 offset:0
    ds_read_b128 v[100:103], v4 offset:2048
    ds_read_b128 v[104:107], v5 offset:0
    ds_read_b128 v[108:111], v5 offset:2048
    s_lshl_b32 s60, s46, 7
    s_add_u32 s60, s60, s56
    s_add_u32 m0, s57, s47
    s_mul_i32 s61, s46, 172032
    buffer_load_dwordx4 v2, s[8:11], s60 offen lds
    s_add_u32 m0, m0, 1024
    s_add_u32 s60, s60, 7168
    buffer_load_dwordx4 v3, s[8:11], s60 offen lds
    s_add_u32 m0, m0, 1024
    s_add_u32 s60, s60, 7168
    buffer_load_dwordx4 v2, s[8:11], s60 offen lds
    s_add_u32 m0, m0, 1024
    s_add_u32 s60, s60, 7168
    buffer_load_dwordx4 v3, s[8:11], s60 offen lds
    s_add_u32 m0, s59, s47
    s_add_u32 s61, s61, s58
    buffer_load_dwordx4 v16, s[12:15], s61 offen lds
    s_add_u32 m0, m0, 1024
    s_nop 0
    buffer_load_dwordx4 v17, s[12:15], s61 offen lds
    s_add_u32 m0, m0, 1024
    s_nop 0
    buffer_load_dwordx4 v18, s[12:15], s61 offen lds
    s_add_u32 s46, s46, 1
    s_cmp_eq_u32 s46, 7
    s_cselect_b32 s46, 0, s46
    s_add_u32 s47, s47, 28672
    s_cmp_eq_u32 s47, 143360
    s_cselect_b32 s47, 0, s47
    v_mfma_f32_16x16x32_bf16 v[68:71], v[112:115], v[112:115], v[68:71]
    v_mfma_f32_16x16x32_bf16 v[76:79], v[88:91], v[112:115], v[76:79]
    v_mfma_f32_16x16x32_bf16 v[72:75], v[116:119], v[116:119], v[72:75]
    v_mfma_f32_16x16x32_bf16 v[80:83], v[88:91], v[116:119], v[80:83]
    v_mfma_f32_16x16x32_bf16 v[68:71], v[120:123], v[120:123], v[68:71]
    v_mfma_f32_16x16x32_bf16 v[76:79], v[88:91], v[120:123], v[76:79]
    v_mfma_f32_16x16x32_bf16 v[72:75], v[124:127], v[124:127], v[72:75]
    v_mfma_f32_16x16x32_bf16 v[80:83], v[88:91], v[124:127], v[80:83]
    s_waitcnt vmcnt(14)
    s_waitcnt lgkmcnt(0)
    s_barrier
    v_add_u32 v4, 0x7000, v4
    v_add_u32 v5, 0x7000, v5
    ds_read_b128 v[112:115], v4 offset:0
    ds_read_b128 v[116:119], v4 offset:2048
    ds_read_b128 v[120:123], v5 offset:0
    ds_read_b128 v[124:127], v5 offset:2048
    s_lshl_b32 s60, s46, 7
    s_add_u32 s60, s60, s56
    s_add_u32 m0, s57, s47
    s_mul_i32 s61, s46, 172032
    buffer_load_dwordx4 v2, s[8:11], s60 offen lds
    s_add_u32 m0, m0, 1024
    s_add_u32 s60, s60, 7168
    buffer_load_dwordx4 v3, s[8:11], s60 offen lds
    s_add_u32 m0, m0, 1024
    s_add_u32 s60, s60, 7168
    buffer_load_dwordx4 v2, s[8:11], s60 offen lds
    s_add_u32 m0, m0, 1024
    s_add_u32 s60, s60, 7168
    buffer_load_dwordx4 v3, s[8:11], s60 offen lds
    s_add_u32 m0, s59, s47
    s_add_u32 s61, s61, s58
    buffer_load_dwordx4 v16, s[12:15], s61 offen lds
    s_add_u32 m0, m0, 1024
    s_nop 0
    buffer_load_dwordx4 v17, s[12:15], s61 offen lds
    s_add_u32 m0, m0, 1024
    s_nop 0
    buffer_load_dwordx4 v18, s[12:15], s61 offen lds
    s_add_u32 s46, s46, 1
    s_cmp_eq_u32 s46, 7
    s_cselect_b32 s46, 0, s46
    s_add_u32 s47, s47, 28672
    s_cmp_eq_u32 s47, 143360
    s_cselect_b32 s47, 0, s47
    v_mfma_f32_16x16x32_bf16 v[68:71], v[96:99], v[96:99], v[68:71]
    v_mfma_f32_16x16x32_bf16 v[76:79], v[88:91], v[96:99], v[76:79]
    v_mfma_f32_16x16x32_bf16 v[72:75], v[100:103], v[100:103], v[72:75]
    v_mfma_f32_16x16x32_bf16 v[80:83], v[88:91], v[100:103], v[80:83]
    v_mfma_f32_16x16x32_bf16 v[68:71], v[104:107], v[104:107], v[68:71]
    v_mfma_f32_16x16x32_bf16 v[76:79], v[88:91], v[104:107], v[76:79]
    v_mfma_f32_16x16x32_bf16 v[72:75], v[108:111], v[108:111], v[72:75]
    v_mfma_f32_16x16x32_bf16 v[80:83], v[88:91], v[108:111], v[80:83]
    s_waitcnt vmcnt(14)
    s_waitcnt lgkmcnt(0)
    s_barrier
    v_add_u32 v4, 0x7000, v4
    v_add_u32 v5, 0x7000, v5
    ds_read_b128 v[96:99], v4 offset:0
    ds_read_b128 v[100:103], v4 offset:2048
    ds_read_b128 v[104:107], v5 offset:0
    ds_read_b128 v[108:111], v5 offset:2048
    v_mfma_f32_16x16x32_bf16 v[68:71], v[112:115], v[112:115], v[68:71]
    v_mfma_f32_16x16x32_bf16 v[76:79], v[88:91], v[112:115], v[76:79]
    v_mfma_f32_16x16x32_bf16 v[72:75], v[116:119], v[116:119], v[72:75]
    v_mfma_f32_16x16x32_bf16 v[80:83], v[88:91], v[116:119], v[80:83]
    v_mfma_f32_16x16x32_bf16 v[68:71], v[120:123], v[120:123], v[68:71]
    v_mfma_f32_16x16x32_bf16 v[76:79], v[88:91], v[120:123], v[76:79]
    v_mfma_f32_16x16x32_bf16 v[72:75], v[124:127], v[124:127], v[72:75]
    v_mfma_f32_16x16x32_bf16 v[80:83], v[88:91], v[124:127], v[80:83]
    s_waitcnt lgkmcnt(0)
    v_mfma_f32_16x16x32_bf16 v[68:71], v[96:99], v[96:99], v[68:71]
    v_mfma_f32_16x16x32_bf16 v[76:79], v[88:91], v[96:99], v[76:79]
    v_mfma_f32_16x16x32_bf16 v[72:75], v[100:103], v[100:103], v[72:75]
    v_mfma_f32_16x16x32_bf16 v[80:83], v[88:91], v[100:103], v[80:83]
    v_mfma_f32_16x16x32_bf16 v[68:71], v[104:107], v[104:107], v[68:71]
    v_mfma_f32_16x16x32_bf16 v[76:79], v[88:91], v[104:107], v[76:79]
    v_mfma_f32_16x16x32_bf16 v[72:75], v[108:111], v[108:111], v[72:75]
    v_mfma_f32_16x16x32_bf16 v[80:83], v[88:91], v[108:111], v[80:83]
    s_waitcnt vmcnt(7)
    s_waitcnt lgkmcnt(0)
    s_barrier
    v_add_u32 v4, 0xfffe4000, v4
    v_add_u32 v5, 0xfffe4000, v5
    ds_read_b128 v[112:115], v4 offset:0
    ds_read_b128 v[116:119], v4 offset:2048
    ds_read_b128 v[120:123], v5 offset:0
    ds_read_b128 v[124:127], v5 offset:2048
    s_waitcnt lgkmcnt(0)
    v_mfma_f32_16x16x32_bf16 v[68:71], v[112:115], v[112:115], v[68:71]
    v_mfma_f32_16x16x32_bf16 v[76:79], v[88:91], v[112:115], v[76:79]
    v_mfma_f32_16x16x32_bf16 v[72:75], v[116:119], v[116:119], v[72:75]
    v_mfma_f32_16x16x32_bf16 v[80:83], v[88:91], v[116:119], v[80:83]
    v_mfma_f32_16x16x32_bf16 v[68:71], v[120:123], v[120:123], v[68:71]
    v_mfma_f32_16x16x32_bf16 v[76:79], v[88:91], v[120:123], v[76:79]
    v_mfma_f32_16x16x32_bf16 v[72:75], v[124:127], v[124:127], v[72:75]
    v_mfma_f32_16x16x32_bf16 v[80:83], v[88:91], v[124:127], v[80:83]
    s_waitcnt vmcnt(0)
    s_waitcnt lgkmcnt(0)
    s_barrier
    v_add_u32 v4, 0x7000, v4
    v_add_u32 v5, 0x7000, v5
    ds_read_b128 v[96:99], v4 offset:0
    ds_read_b128 v[100:103], v4 offset:2048
    ds_read_b128 v[104:107], v5 offset:0
    ds_read_b128 v[108:111], v5 offset:2048
    s_waitcnt lgkmcnt(0)
    v_mfma_f32_16x16x32_bf16 v[68:71], v[96:99], v[96:99], v[68:71]
    v_mfma_f32_16x16x32_bf16 v[76:79], v[88:91], v[96:99], v[76:79]
    v_mfma_f32_16x16x32_bf16 v[72:75], v[100:103], v[100:103], v[72:75]
    v_mfma_f32_16x16x32_bf16 v[80:83], v[88:91], v[100:103], v[80:83]
    v_mfma_f32_16x16x32_bf16 v[68:71], v[104:107], v[104:107], v[68:71]
    v_mfma_f32_16x16x32_bf16 v[76:79], v[88:91], v[104:107], v[76:79]
    v_mfma_f32_16x16x32_bf16 v[72:75], v[108:111], v[108:111], v[72:75]
    v_mfma_f32_16x16x32_bf16 v[80:83], v[88:91], v[108:111], v[80:83]
    s_mov_b32 exec_lo, 0x200002
    s_mov_b32 exec_hi, 0x20000200
    s_nop 2
    v_mov_b32 v68, v69
    s_nop 0
    v_mov_b32 v72, v73
    s_mov_b32 exec_lo, 0x400004
    s_mov_b32 exec_hi, 0x40000400
    v_mov_b32 v68, v70
    v_mov_b32 v72, v74
    s_mov_b32 exec_lo, 0x800008
    s_mov_b32 exec_hi, 0x80000800
    v_mov_b32 v68, v71
    v_mov_b32 v72, v75
    s_mov_b32 exec_lo, 0xf0000f
    s_mov_b32 exec_hi, 0xf0000f00
    v_mul_f32 v76, 0x3b124925, v76
    v_mul_f32 v68, 0x3b124925, v68
    v_fma_f32 v68, -v76, v76, v68
    v_max_f32 v68, 0, v68
    v_add_f32 v68, 0x3727c5ac, v68
    v_rsq_f32 v68, v68
    ds_write_b32 v9, v76 offset:0
    s_nop 0
    ds_write_b32 v9, v68 offset:128
    v_mul_f32 v80, 0x3b124925, v80
    v_mul_f32 v72, 0x3b124925, v72
    v_fma_f32 v72, -v80, v80, v72
    v_max_f32 v72, 0, v72
    v_add_f32 v72, 0x3727c5ac, v72
    v_rsq_f32 v72, v72
    ds_write_b32 v9, v80 offset:64
    s_nop 0
    ds_write_b32 v9, v72 offset:192
    s_mov_b64 exec, -1
    s_barrier
    ds_read_b32 v64, v8 offset:0
    ds_read_b32 v65, v8 offset:512
    ds_read_b32 v66, v8 offset:1024
    ds_read_b32 v67, v8 offset:1536
    s_waitcnt lgkmcnt(0)
    v_add_f32 v64, v64, v65
    v_add_f32 v66, v66, v67
    v_add_f32 v64, v64, v66
    ds_write_b32 v19, v64
    s_waitcnt lgkmcnt(0)
    s_setprio 0
    s_barrier
    v_mov_b32 v9, 0
    s_mov_b32 s60, 0
L_h_nl:
    buffer_load_dwordx2 v[24:25], v9, s[40:43], 0 offen sc0 sc1
    s_add_u32 s60, s60, 1
    s_waitcnt vmcnt(0)
    v_readfirstlane_b32 s44, v24
    v_readfirstlane_b32 s45, v25
    s_cmp_gt_u32 s60, 40000
    s_cbranch_scc1 L_h_gotnonce
    s_cmp_eq_u32 s45, 0
    s_cbranch_scc1 L_h_nl
L_h_gotnonce:
    s_mul_i32 s60, s53, 3
    v_lshrrev_b32 v9, 4, v1
    v_add_u32 v9, s60, v9
    v_and_b32 v10, 15, v9
    v_lshrrev_b32 v9, 4, v9
    v_lshlrev_b32 v9, 8, v9
    v_lshl_add_u32 v9, v10, 10, v9
    v_and_b32 v10, 15, v1
    v_lshl_add_u32 v18, v10, 14, v9
    s_lshl_b32 s62, s52, 4
    s_add_u32 s62, s62, 6291456
    v_mov_b32 v27, 0
    s_lshl_b32 s60, s2, 10
    s_add_u32 s60, s60, 6291712
    v_lshl_add_u32 v17, v1, 4, s60
    s_lshr_b32 s61, s2, 4
    s_lshl_b32 s61, s61, 4
    s_add_u32 s60, s60, s61
    s_sub_u32 s60, s60, 256
    s_mov_b32 exec_lo, 0
    v_mov_b32 v17, s60
    s_mov_b32 exec_lo, -1
    s_lshl_b32 s47, s5, 2
    s_and_b32 s46, s6, 3
    s_add_u32 s47, s47, s46
    s_lshr_b32 s46, s6, 2
    s_and_b32 s56, s5, 1
    s_lshl_b32 s56, s56, 3
    s_and_b32 s57, s6, 7
    s_add_u32 s56, s56, s57
    s_lshr_b32 s57, s5, 1
    s_lshl_b32 s57, s57, 2
    s_lshr_b32 s60, s6, 3
    s_add_u32 s57, s57, s60
    v_lshlrev_b32 v2, 4, v1
    v_lshrrev_b32 v9, 3, v1
    v_mul_u32_u24 v9, 896, v9
    v_bfe_u32 v10, v1, 4, 1
    v_lshlrev_b32 v10, 2, v10
    v_and_b32 v11, 7, v1
    v_xor_b32 v10, v10, v11
    v_lshl_add_u32 v21, v10, 4, v9
    v_lshrrev_b32 v9, 4, v1
    v_mul_u32_u24 v9, 14336, v9
    v_and_b32 v10, 15, v1
    v_lshl_add_u32 v20, v10, 4, v9
    v_lshlrev_b32 v9, 3, v1
    v_mov_b32 v10, 0
    v_mov_b32 v11, 0
    v_add_u32 v9, 92416, v9
    ds_write_b64 v9, v[10:11]
    s_lshr_b32 s58, s4, 1
    s_and_b32 s59, s4, 1
    v_bfe_u32 v9, v1, 2, 2
    v_lshl_add_u32 v10, v13, 3, v9
    v_lshlrev_b32 v10, 7, v10
    v_lshrrev_b32 v9, 1, v9
    v_xor_b32 v9, s58, v9
    v_lshl_add_u32 v10, v9, 6, v10
    v_bfe_u32 v9, v1, 4, 1
    v_xor_b32 v9, s59, v9
    v_lshl_add_u32 v10, v9, 5, v10
    v_and_b32 v9, 1, v1
    v_lshl_add_u32 v10, v9, 4, v10
    v_bfe_u32 v9, v1, 1, 1
    v_lshl_add_u32 v4, v9, 3, v10
    s_and_b32 s60, s6, 3
    s_mul_i32 s60, s60, 1
    s_and_b32 s54, s46, 7
    s_mul_i32 s54, s54, 0
    s_add_u32 s54, s54, s60
    s_add_u32 s54, s54, 0
    s_mul_i32 s60, s5, 7
    s_lshr_b32 s60, s60, 1
    s_add_u32 s54, s54, s60
    s_cmp_ge_u32 s54, 28
    s_cselect_b32 s60, 28, 0
    s_sub_u32 s54, s54, s60
    s_cmp_ge_u32 s54, 28
    s_cselect_b32 s60, 28, 0
    s_sub_u32 s54, s54, s60
    s_cmp_ge_u32 s54, 28
    s_cselect_b32 s60, 28, 0
    s_sub_u32 s54, s54, s60
    s_lshl_b32 s60, s4, 14
    s_add_u32 s7, s60, 98304
    v_add_u32 v4, s7, v4
    v_xor_b32 v5, 64, v4
    s_mul_i32 s55, s4, 401408
    s_lshl_b32 s60, s46, 7
    s_add_u32 s55, s55, s60
    s_lshr_b32 s60, s6, 3
    s_mul_i32 s60, s60, 0
    s_and_b32 s63, s6, 7
    s_add_u32 s63, s63, s60
    s_cmp_ge_u32 s63, 7
    s_cselect_b32 s60, 7, 0
    s_sub_u32 s63, s63, s60
    s_lshl_b32 s58, s63, 6
    s_add_u32 s58, s58, s4
    s_mul_i32 s58, s58, 3584
    s_mul_i32 s59, s57, 224
    s_and_b32 s59, s59, 0xffffffc0
    s_add_u32 s58, s58, s59
    s_mul_i32 s59, s4, 1088
    s_mul_i32 s54, s54, 14336
    s_add_u32 s54, s54, s55
    s_add_u32 s49, s55, 401408
    s_mov_b32 s52, 99
    s_barrier
    s_cmp_lg_u32 s3, 4
    s_cbranch_scc1 L_h2_npub
    ds_read_b32 v26, v14
    s_mov_b32 exec_hi, 0xffff
    s_waitcnt lgkmcnt(0)
    buffer_store_dwordx4 v[24:27], v18, s[20:23], s62 offen sc1
    s_mov_b32 exec_hi, -1
L_h2_npub:
    s_cmp_lg_u32 s3, 4
    s_cbranch_scc1 L_h2_np
    s_mov_b32 exec_lo, 0xffffffff
    s_mov_b32 exec_hi, 0x1
    s_mov_b32 s60, 0
L_poll_A:
    buffer_load_dwordx4 v[28:31], v17, s[20:23], 0 offen sc1
    s_add_u32 s60, s60, 1
    s_waitcnt vmcnt(0)
    v_cmp_ne_u64 vcc, s[44:45], v[28:29]
    s_cmp_gt_u32 s60, 40000
    s_cbranch_scc1 L_polld_A
    s_cbranch_vccnz L_poll_A
L_polld_A:
    s_mov_b64 exec, -1
    s_nop 4
    v_mov_b32 v32, v30
    s_nop 1
    v_max_u32_dpp v32, v32, v32 row_shr:1 row_mask:0xf bank_mask:0xf
    s_nop 1
    v_max_u32_dpp v32, v32, v32 row_shr:2 row_mask:0xf bank_mask:0xf
    s_nop 1
    v_max_u32_dpp v32, v32, v32 row_shr:4 row_mask:0xf bank_mask:0xf
    s_nop 1
    v_max_u32_dpp v32, v32, v32 row_shr:8 row_mask:0xf bank_mask:0xf
    v_sqrt_f32 v32, v32
    v_mov_b32 v9, 97280
    v_mul_f32 v32, 0x3f810000, v32
    v_mov_b32 v33, 0
    s_mov_b64 exec, 0x8000
    ds_write_b32 v9, v33
    ds_write_b32 v9, v32 offset:4
    s_mov_b64 exec, -1
    s_waitcnt lgkmcnt(0)
L_h2_np:
    s_barrier
    s_barrier
L_h2_notf2:
    v_lshlrev_b32 v7, 12, v1
    s_lshl_b32 s53, s57, 8
    s_lshl_b32 s61, s52, 3
    s_add_u32 s53, s53, s61
    s_add_u32 s53, s53, 6684672
    s_cmp_ge_u32 s6, 28
    s_cbranch_scc1 L_h2_nowo
L_h2_act:
    s_add_u32 m0, s7, 0
    s_add_u32 s60, s54, 7168
    buffer_load_dwordx4 v21, s[32:35], s54 offen lds
    s_add_u32 m0, m0, 1024
    s_add_u32 s54, s54, 14336
    buffer_load_dwordx4 v21, s[32:35], s60 offen lds
    s_cmp_eq_u32 s54, s49
    s_cselect_b32 s54, s55, s54
    s_add_u32 m0, s7, 2048
    s_add_u32 s60, s54, 7168
    buffer_load_dwordx4 v21, s[32:35], s54 offen lds
    s_add_u32 m0, m0, 1024
    s_add_u32 s54, s54, 14336
    buffer_load_dwordx4 v21, s[32:35], s60 offen lds
    s_cmp_eq_u32 s54, s49
    s_cselect_b32 s54, s55, s54
    s_add_u32 m0, s7, 4096
    s_add_u32 s60, s54, 7168
    buffer_load_dwordx4 v21, s[32:35], s54 offen lds
    s_add_u32 m0, m0, 1024
    s_add_u32 s54, s54, 14336
    buffer_load_dwordx4 v21, s[32:35], s60 offen lds
    s_cmp_eq_u32 s54, s49
    s_cselect_b32 s54, s55, s54
    s_waitcnt vmcnt(4)
    ds_read_b64_tr_b16 v[88:89], v4 offset:0
    ds_read_b64_tr_b16 v[90:91], v4 offset:512
    ds_read_b64_tr_b16 v[92:93], v5 offset:0
    ds_read_b64_tr_b16 v[94:95], v5 offset:512
    s_add_u32 m0, s7, 6144
    s_add_u32 s60, s54, 7168
    buffer_load_dwordx4 v21, s[32:35], s54 offen lds
    s_add_u32 m0, m0, 1024
    s_add_u32 s54, s54, 14336
    buffer_load_dwordx4 v21, s[32:35], s60 offen lds
    s_cmp_eq_u32 s54, s49
    s_cselect_b32 s54, s55, s54
    s_waitcnt vmcnt(4)
    ds_read_b64_tr_b16 v[96:97], v4 offset:2048
    ds_read_b64_tr_b16 v[98:99], v4 offset:2560
    ds_read_b64_tr_b16 v[100:101], v5 offset:2048
    ds_read_b64_tr_b16 v[102:103], v5 offset:2560
    s_add_u32 m0, s7, 8192
    s_add_u32 s60, s54, 7168
    buffer_load_dwordx4 v21, s[32:35], s54 offen lds
    s_add_u32 m0, m0, 1024
    s_add_u32 s54, s54, 14336
    buffer_load_dwordx4 v21, s[32:35], s60 offen lds
    s_cmp_eq_u32 s54, s49
    s_cselect_b32 s54, s55, s54
    s_waitcnt vmcnt(4)
    ds_read_b64_tr_b16 v[104:105], v4 offset:4096
    ds_read_b64_tr_b16 v[106:107], v4 offset:4608
    ds_read_b64_tr_b16 v[108:109], v5 offset:4096
    ds_read_b64_tr_b16 v[110:111], v5 offset:4608
    s_add_u32 m0, s7, 10240
    s_add_u32 s60, s54, 7168
    buffer_load_dwordx4 v21, s[32:35], s54 offen lds
    s_add_u32 m0, m0, 1024
    s_add_u32 s54, s54, 14336
    buffer_load_dwordx4 v21, s[32:35], s60 offen lds
    s_cmp_eq_u32 s54, s49
    s_cselect_b32 s54, s55, s54
    s_waitcnt vmcnt(4)
    ds_read_b64_tr_b16 v[112:113], v4 offset:6144
    ds_read_b64_tr_b16 v[114:115], v4 offset:6656
    ds_read_b64_tr_b16 v[116:117], v5 offset:6144
    ds_read_b64_tr_b16 v[118:119], v5 offset:6656
    s_add_u32 m0, s7, 12288
    s_add_u32 s60, s54, 7168
    buffer_load_dwordx4 v21, s[32:35], s54 offen lds
    s_add_u32 m0, m0, 1024
    s_add_u32 s54, s54, 14336
    buffer_load_dwordx4 v21, s[32:35], s60 offen lds
    s_cmp_eq_u32 s54, s49
    s_cselect_b32 s54, s55, s54
    s_waitcnt vmcnt(4)
    ds_read_b64_tr_b16 v[120:121], v4 offset:8192
    ds_read_b64_tr_b16 v[122:123], v4 offset:8704
    ds_read_b64_tr_b16 v[124:125], v5 offset:8192
    ds_read_b64_tr_b16 v[126:127], v5 offset:8704
    s_add_u32 m0, s7, 14336
    s_add_u32 s60, s54, 7168
    buffer_load_dwordx4 v21, s[32:35], s54 offen lds
    s_add_u32 m0, m0, 1024
    s_add_u32 s54, s54, 14336
    buffer_load_dwordx4 v21, s[32:35], s60 offen lds
    s_cmp_eq_u32 s54, s49
    s_cselect_b32 s54, s55, s54
    s_waitcnt vmcnt(4)
    ds_read_b64_tr_b16 v[128:129], v4 offset:10240
    ds_read_b64_tr_b16 v[130:131], v4 offset:10752
    ds_read_b64_tr_b16 v[132:133], v5 offset:10240
    ds_read_b64_tr_b16 v[134:135], v5 offset:10752
    s_waitcnt lgkmcnt(8)
    s_add_u32 m0, s7, 0
    s_add_u32 s60, s54, 7168
    buffer_load_dwordx4 v21, s[32:35], s54 offen lds
    s_add_u32 m0, m0, 1024
    s_add_u32 s54, s54, 14336
    buffer_load_dwordx4 v21, s[32:35], s60 offen lds
    s_cmp_eq_u32 s54, s49
    s_cselect_b32 s54, s55, s54
    s_waitcnt vmcnt(4)
    ds_read_b64_tr_b16 v[136:137], v4 offset:12288
    ds_read_b64_tr_b16 v[138:139], v4 offset:12800
    ds_read_b64_tr_b16 v[140:141], v5 offset:12288
    ds_read_b64_tr_b16 v[142:143], v5 offset:12800
    s_waitcnt lgkmcnt(8)
    s_add_u32 m0, s7, 2048
    s_add_u32 s60, s54, 7168
    buffer_load_dwordx4 v21, s[32:35], s54 offen lds
    s_add_u32 m0, m0, 1024
    s_add_u32 s54, s54, 14336
    buffer_load_dwordx4 v21, s[32:35], s60 offen lds
    s_cmp_eq_u32 s54, s49
    s_cselect_b32 s54, s55, s54
    s_waitcnt vmcnt(4)
    ds_read_b64_tr_b16 v[144:145], v4 offset:14336
    ds_read_b64_tr_b16 v[146:147], v4 offset:14848
    ds_read_b64_tr_b16 v[148:149], v5 offset:14336
    ds_read_b64_tr_b16 v[150:151], v5 offset:14848
    s_waitcnt lgkmcnt(8)
    s_add_u32 m0, s7, 4096
    s_add_u32 s60, s54, 7168
    buffer_load_dwordx4 v21, s[32:35], s54 offen lds
    s_add_u32 m0, m0, 1024
    s_add_u32 s54, s54, 14336
    buffer_load_dwordx4 v21, s[32:35], s60 offen lds
    s_cmp_eq_u32 s54, s49
    s_cselect_b32 s54, s55, s54
    s_waitcnt vmcnt(4)
    ds_read_b64_tr_b16 v[152:153], v4 offset:0
    ds_read_b64_tr_b16 v[154:155], v4 offset:512
    ds_read_b64_tr_b16 v[156:157], v5 offset:0
    ds_read_b64_tr_b16 v[158:159], v5 offset:512
    s_waitcnt lgkmcnt(8)
    s_add_u32 m0, s7, 6144
    s_add_u32 s60, s54, 7168
    buffer_load_dwordx4 v21, s[32:35], s54 offen lds
    s_add_u32 m0, m0, 1024
    s_add_u32 s54, s54, 14336
    buffer_load_dwordx4 v21, s[32:35], s60 offen lds
    s_cmp_eq_u32 s54, s49
    s_cselect_b32 s54, s55, s54
    s_waitcnt vmcnt(4)
    ds_read_b64_tr_b16 v[160:161], v4 offset:2048
    ds_read_b64_tr_b16 v[162:163], v4 offset:2560
    ds_read_b64_tr_b16 v[164:165], v5 offset:2048
    ds_read_b64_tr_b16 v[166:167], v5 offset:2560
    s_waitcnt lgkmcnt(8)
    s_add_u32 m0, s7, 8192
    s_add_u32 s60, s54, 7168
    buffer_load_dwordx4 v21, s[32:35], s54 offen lds
    s_add_u32 m0, m0, 1024
    s_add_u32 s54, s54, 14336
    buffer_load_dwordx4 v21, s[32:35], s60 offen lds
    s_cmp_eq_u32 s54, s49
    s_cselect_b32 s54, s55, s54
    s_waitcnt vmcnt(4)
    ds_read_b64_tr_b16 v[168:169], v4 offset:4096
    ds_read_b64_tr_b16 v[170:171], v4 offset:4608
    ds_read_b64_tr_b16 v[172:173], v5 offset:4096
    ds_read_b64_tr_b16 v[174:175], v5 offset:4608
    s_waitcnt lgkmcnt(8)
    s_add_u32 m0, s7, 10240
    s_add_u32 s60, s54, 7168
    buffer_load_dwordx4 v21, s[32:35], s54 offen lds
    s_add_u32 m0, m0, 1024
    s_add_u32 s54, s54, 14336
    buffer_load_dwordx4 v21, s[32:35], s60 offen lds
    s_cmp_eq_u32 s54, s49
    s_cselect_b32 s54, s55, s54
    s_waitcnt vmcnt(4)
    ds_read_b64_tr_b16 v[176:177], v4 offset:6144
    ds_read_b64_tr_b16 v[178:179], v4 offset:6656
    ds_read_b64_tr_b16 v[180:181], v5 offset:6144
    ds_read_b64_tr_b16 v[182:183], v5 offset:6656
    s_waitcnt lgkmcnt(8)
    s_add_u32 m0, s7, 12288
    s_add_u32 s60, s54, 7168
    buffer_load_dwordx4 v21, s[32:35], s54 offen lds
    s_add_u32 m0, m0, 1024
    s_add_u32 s54, s54, 14336
    buffer_load_dwordx4 v21, s[32:35], s60 offen lds
    s_cmp_eq_u32 s54, s49
    s_cselect_b32 s54, s55, s54
    s_waitcnt vmcnt(4)
    ds_read_b64_tr_b16 v[184:185], v4 offset:8192
    ds_read_b64_tr_b16 v[186:187], v4 offset:8704
    ds_read_b64_tr_b16 v[188:189], v5 offset:8192
    ds_read_b64_tr_b16 v[190:191], v5 offset:8704
    s_waitcnt lgkmcnt(8)
    s_add_u32 m0, s7, 14336
    s_add_u32 s60, s54, 7168
    buffer_load_dwordx4 v21, s[32:35], s54 offen lds
    s_add_u32 m0, m0, 1024
    s_add_u32 s54, s54, 14336
    buffer_load_dwordx4 v21, s[32:35], s60 offen lds
    s_cmp_eq_u32 s54, s49
    s_cselect_b32 s54, s55, s54
    s_waitcnt vmcnt(4)
    ds_read_b64_tr_b16 v[192:193], v4 offset:10240
    ds_read_b64_tr_b16 v[194:195], v4 offset:10752
    ds_read_b64_tr_b16 v[196:197], v5 offset:10240
    ds_read_b64_tr_b16 v[198:199], v5 offset:10752
    s_waitcnt lgkmcnt(8)
    s_add_u32 m0, s7, 0
    s_add_u32 s60, s54, 7168
    buffer_load_dwordx4 v21, s[32:35], s54 offen lds
    s_add_u32 m0, m0, 1024
    s_add_u32 s54, s54, 14336
    buffer_load_dwordx4 v21, s[32:35], s60 offen lds
    s_cmp_eq_u32 s54, s49
    s_cselect_b32 s54, s55, s54
    s_waitcnt vmcnt(4)
    ds_read_b64_tr_b16 v[200:201], v4 offset:12288
    ds_read_b64_tr_b16 v[202:203], v4 offset:12800
    ds_read_b64_tr_b16 v[204:205], v5 offset:12288
    ds_read_b64_tr_b16 v[206:207], v5 offset:12800
    s_waitcnt lgkmcnt(8)
    s_add_u32 m0, s7, 2048
    s_add_u32 s60, s54, 7168
    buffer_load_dwordx4 v21, s[32:35], s54 offen lds
    s_add_u32 m0, m0, 1024
    s_add_u32 s54, s54, 14336
    buffer_load_dwordx4 v21, s[32:35], s60 offen lds
    s_cmp_eq_u32 s54, s49
    s_cselect_b32 s54, s55, s54
    s_waitcnt vmcnt(4)
    ds_read_b64_tr_b16 v[208:209], v4 offset:14336
    ds_read_b64_tr_b16 v[210:211], v4 offset:14848
    ds_read_b64_tr_b16 v[212:213], v5 offset:14336
    ds_read_b64_tr_b16 v[214:215], v5 offset:14848
    s_waitcnt lgkmcnt(8)
    s_add_u32 m0, s7, 4096
    s_add_u32 s60, s54, 7168
    buffer_load_dwordx4 v21, s[32:35], s54 offen lds
    s_add_u32 m0, m0, 1024
    s_add_u32 s54, s54, 14336
    buffer_load_dwordx4 v21, s[32:35], s60 offen lds
    s_cmp_eq_u32 s54, s49
    s_cselect_b32 s54, s55, s54
    s_waitcnt vmcnt(4)
    ds_read_b64_tr_b16 v[216:217], v4 offset:0
    ds_read_b64_tr_b16 v[218:219], v4 offset:512
    ds_read_b64_tr_b16 v[220:221], v5 offset:0
    ds_read_b64_tr_b16 v[222:223], v5 offset:512
    s_mul_i32 s50, s4, 100352
    s_lshl_b32 s60, s46, 7
    s_add_u32 s50, s50, s60
    s_mul_i32 s51, s4, 14336
    s_add_u32 s51, s51, 35072
    s_and_b32 s62, s6, 3
    s_mul_i32 s62, s62, 7
    s_lshr_b32 s62, s62, 1
    s_lshl_b32 s60, s62, 10
    s_add_u32 m0, s60, s51
    s_mul_i32 s60, s62, 7168
    s_add_u32 s60, s60, s50
    buffer_load_dwordx4 v21, s[16:19], s60 offen lds
    s_add_u32 s62, s62, 1
    s_cmp_eq_u32 s62, 14
    s_cselect_b32 s62, 0, s62
    s_lshl_b32 s60, s62, 10
    s_add_u32 m0, s60, s51
    s_mul_i32 s60, s62, 7168
    s_add_u32 s60, s60, s50
    buffer_load_dwordx4 v21, s[16:19], s60 offen lds
    s_add_u32 s62, s62, 1
    s_cmp_eq_u32 s62, 14
    s_cselect_b32 s62, 0, s62
    s_waitcnt vmcnt(4)
    ds_read_b64_tr_b16 v[224:225], v4 offset:2048
    ds_read_b64_tr_b16 v[226:227], v4 offset:2560
    ds_read_b64_tr_b16 v[228:229], v5 offset:2048
    ds_read_b64_tr_b16 v[230:231], v5 offset:2560
    s_lshl_b32 s60, s62, 10
    s_add_u32 m0, s60, s51
    s_mul_i32 s60, s62, 7168
    s_add_u32 s60, s60, s50
    buffer_load_dwordx4 v21, s[16:19], s60 offen lds
    s_add_u32 s62, s62, 1
    s_cmp_eq_u32 s62, 14
    s_cselect_b32 s62, 0, s62
    s_lshl_b32 s60, s62, 10
    s_add_u32 m0, s60, s51
    s_mul_i32 s60, s62, 7168
    s_add_u32 s60, s60, s50
    buffer_load_dwordx4 v21, s[16:19], s60 offen lds
    s_add_u32 s62, s62, 1
    s_cmp_eq_u32 s62, 14
    s_cselect_b32 s62, 0, s62
    s_waitcnt vmcnt(4)
    ds_read_b64_tr_b16 v[232:233], v4 offset:4096
    ds_read_b64_tr_b16 v[234:235], v4 offset:4608
    ds_read_b64_tr_b16 v[236:237], v5 offset:4096
    ds_read_b64_tr_b16 v[238:239], v5 offset:4608
    s_lshl_b32 s60, s62, 10
    s_add_u32 m0, s60, s51
    s_mul_i32 s60, s62, 7168
    s_add_u32 s60, s60, s50
    buffer_load_dwordx4 v21, s[16:19], s60 offen lds
    s_add_u32 s62, s62, 1
    s_cmp_eq_u32 s62, 14
    s_cselect_b32 s62, 0, s62
    s_lshl_b32 s60, s62, 10
    s_add_u32 m0, s60, s51
    s_mul_i32 s60, s62, 7168
    s_add_u32 s60, s60, s50
    buffer_load_dwordx4 v21, s[16:19], s60 offen lds
    s_add_u32 s62, s62, 1
    s_cmp_eq_u32 s62, 14
    s_cselect_b32 s62, 0, s62
    s_waitcnt vmcnt(4)
    s_lshl_b32 s60, s62, 10
    s_add_u32 m0, s60, s51
    s_mul_i32 s60, s62, 7168
    s_add_u32 s60, s60, s50
    buffer_load_dwordx4 v21, s[16:19], s60 offen lds
    s_add_u32 s62, s62, 1
    s_cmp_eq_u32 s62, 14
    s_cselect_b32 s62, 0, s62
    s_lshl_b32 s60, s62, 10
    s_add_u32 m0, s60, s51
    s_mul_i32 s60, s62, 7168
    s_add_u32 s60, s60, s50
    buffer_load_dwordx4 v21, s[16:19], s60 offen lds
    s_add_u32 s62, s62, 1
    s_cmp_eq_u32 s62, 14
    s_cselect_b32 s62, 0, s62
    s_waitcnt vmcnt(4)
    s_lshl_b32 s60, s62, 10
    s_add_u32 m0, s60, s51
    s_mul_i32 s60, s62, 7168
    s_add_u32 s60, s60, s50
    buffer_load_dwordx4 v21, s[16:19], s60 offen lds
    s_add_u32 s62, s62, 1
    s_cmp_eq_u32 s62, 14
    s_cselect_b32 s62, 0, s62
    s_lshl_b32 s60, s62, 10
    s_add_u32 m0, s60, s51
    s_mul_i32 s60, s62, 7168
    s_add_u32 s60, s60, s50
    buffer_load_dwordx4 v21, s[16:19], s60 offen lds
    s_add_u32 s62, s62, 1
    s_cmp_eq_u32 s62, 14
    s_cselect_b32 s62, 0, s62
    s_waitcnt vmcnt(4)
    s_lshl_b32 s60, s62, 10
    s_add_u32 m0, s60, s51
    s_mul_i32 s60, s62, 7168
    s_add_u32 s60, s60, s50
    buffer_load_dwordx4 v21, s[16:19], s60 offen lds
    s_add_u32 s62, s62, 1
    s_cmp_eq_u32 s62, 14
    s_cselect_b32 s62, 0, s62
    s_lshl_b32 s60, s62, 10
    s_add_u32 m0, s60, s51
    s_mul_i32 s60, s62, 7168
    s_add_u32 s60, s60, s50
    buffer_load_dwordx4 v21, s[16:19], s60 offen lds
    s_add_u32 s62, s62, 1
    s_cmp_eq_u32 s62, 14
    s_cselect_b32 s62, 0, s62
    s_waitcnt vmcnt(4)
    s_lshl_b32 s60, s62, 10
    s_add_u32 m0, s60, s51
    s_mul_i32 s60, s62, 7168
    s_add_u32 s60, s60, s50
    buffer_load_dwordx4 v21, s[16:19], s60 offen lds
    s_add_u32 s62, s62, 1
    s_cmp_eq_u32 s62, 14
    s_cselect_b32 s62, 0, s62
    s_lshl_b32 s60, s62, 10
    s_add_u32 m0, s60, s51
    s_mul_i32 s60, s62, 7168
    s_add_u32 s60, s60, s50
    buffer_load_dwordx4 v21, s[16:19], s60 offen lds
    s_add_u32 s62, s62, 1
    s_cmp_eq_u32 s62, 14
    s_cselect_b32 s62, 0, s62
    s_waitcnt vmcnt(4)
L_h2_nowo:
    s_lshl_b32 s60, s56, 4
    s_add_u32 s60, s60, s57
    s_lshl_b32 s60, s60, 8
    s_add_u32 s60, s60, 6684672
    v_lshl_add_u32 v17, v1, 3, s60
    s_mov_b32 m0, s59
    s_add_u32 s59, s59, 8736
    buffer_load_dwordx4 v20, s[24:27], s58 offen lds
    s_add_u32 m0, m0, 4384
    s_add_u32 s60, s58, 57344
    buffer_load_dwordx4 v20, s[28:31], s58 offen lds
    s_sub_u32 s61, s60, 1605632
    s_cmp_ge_u32 s60, 1605632
    s_cselect_b32 s58, s61, s60
    s_waitcnt vmcnt(3)
    s_mov_b32 m0, s59
    s_add_u32 s59, s59, 8736
    buffer_load_dwordx4 v20, s[24:27], s58 offen lds
    s_add_u32 m0, m0, 4384
    s_add_u32 s60, s58, 57344
    buffer_load_dwordx4 v20, s[28:31], s58 offen lds
    s_sub_u32 s61, s60, 1605632
    s_cmp_ge_u32 s60, 1605632
    s_cselect_b32 s58, s61, s60
    s_waitcnt vmcnt(3)
    s_mov_b32 m0, s59
    s_add_u32 s59, s59, 8736
    buffer_load_dwordx4 v20, s[24:27], s58 offen lds
    s_add_u32 m0, m0, 4384
    s_add_u32 s60, s58, 57344
    buffer_load_dwordx4 v20, s[28:31], s58 offen lds
    s_sub_u32 s61, s60, 1605632
    s_cmp_ge_u32 s60, 1605632
    s_cselect_b32 s58, s61, s60
    s_waitcnt vmcnt(3)
    s_mov_b32 m0, s59
    s_add_u32 s59, s59, 8736
    buffer_load_dwordx4 v20, s[24:27], s58 offen lds
    s_add_u32 m0, m0, 4384
    s_add_u32 s60, s58, 57344
    buffer_load_dwordx4 v20, s[28:31], s58 offen lds
    s_sub_u32 s61, s60, 1605632
    s_cmp_ge_u32 s60, 1605632
    s_cselect_b32 s58, s61, s60
    s_waitcnt vmcnt(3)
    s_and_b32 s52, s2, 15
    s_lshr_b32 s53, s2, 4
    s_mov_b32 s62, 0
    s_waitcnt lgkmcnt(0)
    v_lshlrev_b32 v9, 7, v1
    s_lshl_b32 s60, s53, 11
    s_lshl_b32 s61, s52, 3
    s_add_u32 s60, s60, s61
    s_add_u32 s60, s60, 6553600
    v_add_u32 v19, s60, v9
    s_lshl_b32 s61, s4, 2
    s_lshl_b32 s50, 15, s61
    s_and_b32 s50, s50, 0x7f7f
    s_mov_b32 s51, 0
    v_mov_b32 v9, 97280
L_h2_again:
    s_barrier
    s_waitcnt vmcnt(0)
    s_barrier
    s_barrier
    ds_read_b32 v10, v9
    s_waitcnt lgkmcnt(0)
    v_readfirstlane_b32 s60, v10
    s_nop 0
    s_andn2_b32 s60, s60, s62
    s_cmp_lg_u32 s60, 0
    s_barrier
    s_cbranch_scc1 L_h2_redo
    s_mov_b64 exec, s[50:51]
    buffer_store_dwordx2 v[24:25], v19, s[20:23], 0 offen sc1
    s_mov_b64 exec, -1
    s_mov_b32 m0, s59
    s_add_u32 s59, s59, 8736
    buffer_load_dwordx4 v20, s[24:27], s58 offen lds
    s_add_u32 m0, m0, 4384
    s_add_u32 s60, s58, 57344
    buffer_load_dwordx4 v20, s[28:31], s58 offen lds
    s_sub_u32 s61, s60, 1605632
    s_cmp_ge_u32 s60, 1605632
    s_cselect_b32 s58, s61, s60
    s_mov_b32 m0, s59
    s_add_u32 s59, s59, 8736
    buffer_load_dwordx4 v20, s[24:27], s58 offen lds
    s_add_u32 m0, m0, 4384
    s_add_u32 s60, s58, 57344
    buffer_load_dwordx4 v20, s[28:31], s58 offen lds
    s_sub_u32 s61, s60, 1605632
    s_cmp_ge_u32 s60, 1605632
    s_cselect_b32 s58, s61, s60
    s_mov_b32 m0, s59
    s_add_u32 s59, s59, 8736
    buffer_load_dwordx4 v20, s[24:27], s58 offen lds
    s_add_u32 m0, m0, 4384
    s_add_u32 s60, s58, 57344
    buffer_load_dwordx4 v20, s[28:31], s58 offen lds
    s_sub_u32 s61, s60, 1605632
    s_cmp_ge_u32 s60, 1605632
    s_cselect_b32 s58, s61, s60
    s_mov_b32 m0, s59
    s_add_u32 s59, s59, 8736
    buffer_load_dwordx4 v20, s[24:27], s58 offen lds
    s_add_u32 m0, m0, 4384
    s_add_u32 s60, s58, 57344
    buffer_load_dwordx4 v20, s[28:31], s58 offen lds
    s_sub_u32 s61, s60, 1605632
    s_cmp_ge_u32 s60, 1605632
    s_cselect_b32 s58, s61, s60
    s_mov_b32 m0, s59
    s_add_u32 s59, s59, 8736
    buffer_load_dwordx4 v20, s[24:27], s58 offen lds
    s_add_u32 m0, m0, 4384
    s_add_u32 s60, s58, 57344
    buffer_load_dwordx4 v20, s[28:31], s58 offen lds
    s_sub_u32 s61, s60, 1605632
    s_cmp_ge_u32 s60, 1605632
    s_cselect_b32 s58, s61, s60
    s_mov_b32 m0, s59
    s_add_u32 s59, s59, 8736
    buffer_load_dwordx4 v20, s[24:27], s58 offen lds
    s_add_u32 m0, m0, 4384
    s_add_u32 s60, s58, 57344
    buffer_load_dwordx4 v20, s[28:31], s58 offen lds
    s_sub_u32 s61, s60, 1605632
    s_cmp_ge_u32 s60, 1605632
    s_cselect_b32 s58, s61, s60
    s_mov_b32 m0, s59
    s_add_u32 s59, s59, 8736
    buffer_load_dwordx4 v20, s[24:27], s58 offen lds
    s_add_u32 m0, m0, 4384
    s_add_u32 s60, s58, 57344
    buffer_load_dwordx4 v20, s[28:31], s58 offen lds
    s_sub_u32 s61, s60, 1605632
    s_cmp_ge_u32 s60, 1605632
    s_cselect_b32 s58, s61, s60
    s_cmp_ge_u32 s6, 28
    s_cbranch_scc1 L_h3_skip
    s_and_b32 s52, s4, 1
    s_lshr_b32 s53, s4, 1
    s_lshl_b32 s62, s47, 1
    s_add_u32 s62, s62, s52
    s_lshl_b32 s62, s62, 15
    s_lshl_b32 s53, s53, 10
    s_add_u32 s62, s62, s53
    s_add_u32 s62, s62, 7340032
    s_lshl_b32 s52, s52, 15
    s_add_u32 s52, s52, s53
    s_add_u32 s52, s52, 98304
    s_and_b32 s53, s46, 0
    s_lshl_b32 s53, s53, 12
    s_cmp_lg_u32 s3, 4
    s_cbranch_scc1 L_h3_np
    s_lshl_b32 s60, s47, 3
    s_add_u32 s60, s60, s46
    s_lshl_b32 s60, s60, 7
    s_add_u32 s60, s60, 6553600
    v_lshl_add_u32 v17, v1, 3, s60
    s_mov_b32 exec_lo, 0xffff
    s_mov_b32 exec_hi, 0x0
    s_mov_b32 s60, 0
L_poll_B:
    buffer_load_dwordx2 v[10:11], v17, s[20:23], 0 offen sc1
    s_add_u32 s60, s60, 1
    s_waitcnt vmcnt(0)
    v_cmp_ne_u64 vcc, s[44:45], v[10:11]
    s_cmp_gt_u32 s60, 40000
    s_cbranch_scc1 L_polld_B
    s_cbranch_vccnz L_poll_B
L_polld_B:
    s_mov_b64 exec, -1
L_h3_np:
    s_barrier
    s_mov_b32 m0, s52
    s_mov_b32 s61, 0
L_h3_o:
    s_add_u32 s60, s53, s62
    buffer_load_dwordx4 v2, s[20:23], s60 offen sc1 lds
    s_add_u32 m0, m0, 2048
    s_add_u32 s53, s53, 2048
    s_and_b32 s53, s53, 0x7fff
    s_add_u32 s61, s61, 1
    s_cmp_lt_u32 s61, 16
    s_cbranch_scc1 L_h3_o
    s_waitcnt vmcnt(12)
    s_barrier
    s_waitcnt vmcnt(8)
    s_barrier
    s_waitcnt vmcnt(4)
    s_barrier
    s_waitcnt vmcnt(0)
    s_barrier
L_h3_skip:
    v_lshlrev_b32 v9, 7, v1
    s_lshr_b32 s60, s47, 1
    s_lshl_b32 s60, s60, 11
    s_and_b32 s61, s47, 1
    s_mul_i32 s61, s61, 7
    s_add_u32 s61, s61, s46
    s_lshl_b32 s61, s61, 3
    s_add_u32 s60, s60, s61
    s_add_u32 s60, s60, 6586368
    v_add_u32 v19, s60, v9
    s_lshl_b32 s61, s4, 2
    s_lshl_b32 s50, 15, s61
    s_and_b32 s50, s50, 0xffff
    s_mov_b32 s51, 0
    s_cmp_ge_u32 s6, 28
    s_barrier
    s_cbranch_scc1 L_pub_C
    s_mov_b64 exec, s[50:51]
    buffer_store_dwordx2 v[24:25], v19, s[20:23], 0 offen sc1
    s_mov_b64 exec, -1
L_pub_C:
    s_cmp_lg_u32 s3, 4
    s_cbranch_scc1 L_h4_np
    s_lshl_b32 s60, s56, 4
    s_add_u32 s60, s60, s57
    s_lshl_b32 s60, s60, 7
    s_add_u32 s60, s60, 6586368
    v_lshl_add_u32 v17, v1, 3, s60
    s_mov_b32 exec_lo, 0x3fff
    s_mov_b32 exec_hi, 0x0
    s_mov_b32 s60, 0
L_poll_C:
    buffer_load_dwordx2 v[10:11], v17, s[20:23], 0 offen sc1
    s_add_u32 s60, s60, 1
    s_waitcnt vmcnt(0)
    v_cmp_ne_u64 vcc, s[44:45], v[10:11]
    s_cmp_gt_u32 s60, 40000
    s_cbranch_scc1 L_polld_C
    s_cbranch_vccnz L_poll_C
L_polld_C:
    s_mov_b64 exec, -1
L_h4_np:
    s_waitcnt vmcnt(0)
    s_barrier
    s_mov_b32 m0, s59
    s_add_u32 s59, s59, 8736
    buffer_load_dwordx4 v20, s[24:27], s58 offen lds
    s_add_u32 m0, m0, 4384
    s_add_u32 s60, s58, 57344
    buffer_load_dwordx4 v20, s[28:31], s58 offen lds
    s_sub_u32 s61, s60, 1605632
    s_cmp_ge_u32 s60, 1605632
    s_cselect_b32 s58, s61, s60
    s_waitcnt vmcnt(4)
    s_mov_b32 m0, s59
    s_add_u32 s59, s59, 8736
    buffer_load_dwordx4 v20, s[24:27], s58 offen lds
    s_add_u32 m0, m0, 4384
    s_add_u32 s60, s58, 57344
    buffer_load_dwordx4 v20, s[28:31], s58 offen lds
    s_sub_u32 s61, s60, 1605632
    s_cmp_ge_u32 s60, 1605632
    s_cselect_b32 s58, s61, s60
    s_waitcnt vmcnt(4)
    s_mov_b32 m0, s59
    s_add_u32 s59, s59, 8736
    buffer_load_dwordx4 v20, s[24:27], s58 offen lds
    s_add_u32 m0, m0, 4384
    s_add_u32 s60, s58, 57344
    buffer_load_dwordx4 v20, s[28:31], s58 offen lds
    s_sub_u32 s61, s60, 1605632
    s_cmp_ge_u32 s60, 1605632
    s_cselect_b32 s58, s61, s60
    s_waitcnt vmcnt(4)
    s_mov_b32 m0, s59
    s_add_u32 s59, s59, 8736
    buffer_load_dwordx4 v20, s[24:27], s58 offen lds
    s_add_u32 m0, m0, 4384
    s_add_u32 s60, s58, 57344
    buffer_load_dwordx4 v20, s[28:31], s58 offen lds
    s_sub_u32 s61, s60, 1605632
    s_cmp_ge_u32 s60, 1605632
    s_cselect_b32 s58, s61, s60
    s_waitcnt vmcnt(4)
    s_mov_b32 m0, s59
    s_add_u32 s59, s59, 8736
    buffer_load_dwordx4 v20, s[24:27], s58 offen lds
    s_add_u32 m0, m0, 4384
    s_add_u32 s60, s58, 57344
    buffer_load_dwordx4 v20, s[28:31], s58 offen lds
    s_sub_u32 s61, s60, 1605632
    s_cmp_ge_u32 s60, 1605632
    s_cselect_b32 s58, s61, s60
    s_waitcnt vmcnt(4)
    s_mov_b32 m0, s59
    s_add_u32 s59, s59, 8736
    buffer_load_dwordx4 v20, s[24:27], s58 offen lds
    s_add_u32 m0, m0, 4384
    s_add_u32 s60, s58, 57344
    buffer_load_dwordx4 v20, s[28:31], s58 offen lds
    s_sub_u32 s61, s60, 1605632
    s_cmp_ge_u32 s60, 1605632
    s_cselect_b32 s58, s61, s60
    s_waitcnt vmcnt(4)
    s_mov_b32 m0, s59
    s_add_u32 s59, s59, 8736
    buffer_load_dwordx4 v20, s[24:27], s58 offen lds
    s_add_u32 m0, m0, 4384
    s_add_u32 s60, s58, 57344
    buffer_load_dwordx4 v20, s[28:31], s58 offen lds
    s_sub_u32 s61, s60, 1605632
    s_cmp_ge_u32 s60, 1605632
    s_cselect_b32 s58, s61, s60
    s_waitcnt vmcnt(4)
    s_sub_u32 s59, s59, 157248
    s_waitcnt vmcnt(0)
    s_barrier
    s_mov_b32 m0, s59
    s_add_u32 s59, s59, 8736
    buffer_load_dwordx4 v20, s[24:27], s58 offen lds
    s_add_u32 m0, m0, 4384
    s_add_u32 s60, s58, 57344
    buffer_load_dwordx4 v20, s[28:31], s58 offen lds
    s_sub_u32 s61, s60, 1605632
    s_cmp_ge_u32 s60, 1605632
    s_cselect_b32 s58, s61, s60
    s_mov_b32 m0, s59
    s_add_u32 s59, s59, 8736
    buffer_load_dwordx4 v20, s[24:27], s58 offen lds
    s_add_u32 m0, m0, 4384
    s_add_u32 s60, s58, 57344
    buffer_load_dwordx4 v20, s[28:31], s58 offen lds
    s_sub_u32 s61, s60, 1605632
    s_cmp_ge_u32 s60, 1605632
    s_cselect_b32 s58, s61, s60
    s_mov_b32 m0, s59
    s_add_u32 s59, s59, 8736
    buffer_load_dwordx4 v20, s[24:27], s58 offen lds
    s_add_u32 m0, m0, 4384
    s_add_u32 s60, s58, 57344
    buffer_load_dwordx4 v20, s[28:31], s58 offen lds
    s_sub_u32 s61, s60, 1605632
    s_cmp_ge_u32 s60, 1605632
    s_cselect_b32 s58, s61, s60
    s_mov_b32 m0, s59
    s_add_u32 s59, s59, 8736
    buffer_load_dwordx4 v20, s[24:27], s58 offen lds
    s_add_u32 m0, m0, 4384
    s_add_u32 s60, s58, 57344
    buffer_load_dwordx4 v20, s[28:31], s58 offen lds
    s_sub_u32 s61, s60, 1605632
    s_cmp_ge_u32 s60, 1605632
    s_cselect_b32 s58, s61, s60
    s_mov_b32 m0, s59
    s_add_u32 s59, s59, 8736
    buffer_load_dwordx4 v20, s[24:27], s58 offen lds
    s_add_u32 m0, m0, 4384
    s_add_u32 s60, s58, 57344
    buffer_load_dwordx4 v20, s[28:31], s58 offen lds
    s_sub_u32 s61, s60, 1605632
    s_cmp_ge_u32 s60, 1605632
    s_cselect_b32 s58, s61, s60
    s_mov_b32 m0, s59
    s_add_u32 s59, s59, 8736
    buffer_load_dwordx4 v20, s[24:27], s58 offen lds
    s_add_u32 m0, m0, 4384
    s_add_u32 s60, s58, 57344
    buffer_load_dwordx4 v20, s[28:31], s58 offen lds
    s_sub_u32 s61, s60, 1605632
    s_cmp_ge_u32 s60, 1605632
    s_cselect_b32 s58, s61, s60
    s_mov_b32 m0, s59
    s_add_u32 s59, s59, 8736
    buffer_load_dwordx4 v20, s[24:27], s58 offen lds
    s_add_u32 m0, m0, 4384
    s_add_u32 s60, s58, 57344
    buffer_load_dwordx4 v20, s[28:31], s58 offen lds
    s_sub_u32 s61, s60, 1605632
    s_cmp_ge_u32 s60, 1605632
    s_cselect_b32 s58, s61, s60
    s_mov_b32 m0, s59
    s_add_u32 s59, s59, 8736
    buffer_load_dwordx4 v20, s[24:27], s58 offen lds
    s_add_u32 m0, m0, 4384
    s_add_u32 s60, s58, 57344
    buffer_load_dwordx4 v20, s[28:31], s58 offen lds
    s_sub_u32 s61, s60, 1605632
    s_cmp_ge_u32 s60, 1605632
    s_cselect_b32 s58, s61, s60
    s_mov_b32 m0, s59
    s_add_u32 s59, s59, 8736
    buffer_load_dwordx4 v20, s[24:27], s58 offen lds
    s_add_u32 m0, m0, 4384
    s_add_u32 s60, s58, 57344
    buffer_load_dwordx4 v20, s[28:31], s58 offen lds
    s_sub_u32 s61, s60, 1605632
    s_cmp_ge_u32 s60, 1605632
    s_cselect_b32 s58, s61, s60
    s_mov_b32 m0, s59
    s_add_u32 s59, s59, 8736
    buffer_load_dwordx4 v20, s[24:27], s58 offen lds
    s_add_u32 m0, m0, 4384
    s_add_u32 s60, s58, 57344
    buffer_load_dwordx4 v20, s[28:31], s58 offen lds
    s_sub_u32 s61, s60, 1605632
    s_cmp_ge_u32 s60, 1605632
    s_cselect_b32 s58, s61, s60
    s_waitcnt vmcnt(12)
    s_barrier
    s_waitcnt vmcnt(0)
    s_barrier
    s_cmp_ge_u32 s6, 28
    s_cbranch_scc1 L_h4_nowd
    s_mul_i32 s60, s4, 18432
    s_add_u32 s7, s60, 87360
    s_add_u32 m0, s7, 0
    s_add_u32 s60, s54, 7168
    buffer_load_dwordx4 v21, s[32:35], s54 offen lds
    s_add_u32 m0, m0, 1024
    s_add_u32 s54, s54, 14336
    buffer_load_dwordx4 v21, s[32:35], s60 offen lds
    s_cmp_eq_u32 s54, s49
    s_cselect_b32 s54, s55, s54
    s_add_u32 m0, s7, 2048
    s_add_u32 s60, s54, 7168
    buffer_load_dwordx4 v21, s[32:35], s54 offen lds
    s_add_u32 m0, m0, 1024
    s_add_u32 s54, s54, 14336
    buffer_load_dwordx4 v21, s[32:35], s60 offen lds
    s_cmp_eq_u32 s54, s49
    s_cselect_b32 s54, s55, s54
    s_add_u32 m0, s7, 4096
    s_add_u32 s60, s54, 7168
    buffer_load_dwordx4 v21, s[32:35], s54 offen lds
    s_add_u32 m0, m0, 1024
    s_add_u32 s54, s54, 14336
    buffer_load_dwordx4 v21, s[32:35], s60 offen lds
    s_cmp_eq_u32 s54, s49
    s_cselect_b32 s54, s55, s54
    s_add_u32 m0, s7, 6144
    s_add_u32 s60, s54, 7168
    buffer_load_dwordx4 v21, s[32:35], s54 offen lds
    s_add_u32 m0, m0, 1024
    s_add_u32 s54, s54, 14336
    buffer_load_dwordx4 v21, s[32:35], s60 offen lds
    s_cmp_eq_u32 s54, s49
    s_cselect_b32 s54, s55, s54
    s_add_u32 m0, s7, 8192
    s_add_u32 s60, s54, 7168
    buffer_load_dwordx4 v21, s[32:35], s54 offen lds
    s_add_u32 m0, m0, 1024
    s_add_u32 s54, s54, 14336
    buffer_load_dwordx4 v21, s[32:35], s60 offen lds
    s_cmp_eq_u32 s54, s49
    s_cselect_b32 s54, s55, s54
    s_add_u32 m0, s7, 10240
    s_add_u32 s60, s54, 7168
    buffer_load_dwordx4 v21, s[32:35], s54 offen lds
    s_add_u32 m0, m0, 1024
    s_add_u32 s54, s54, 14336
    buffer_load_dwordx4 v21, s[32:35], s60 offen lds
    s_cmp_eq_u32 s54, s49
    s_cselect_b32 s54, s55, s54
    s_add_u32 m0, s7, 12288
    s_add_u32 s60, s54, 7168
    buffer_load_dwordx4 v21, s[32:35], s54 offen lds
    s_add_u32 m0, m0, 1024
    s_add_u32 s54, s54, 14336
    buffer_load_dwordx4 v21, s[32:35], s60 offen lds
    s_cmp_eq_u32 s54, s49
    s_cselect_b32 s54, s55, s54
    s_add_u32 m0, s7, 14336
    s_add_u32 s60, s54, 7168
    buffer_load_dwordx4 v21, s[32:35], s54 offen lds
    s_add_u32 m0, m0, 1024
    s_add_u32 s54, s54, 14336
    buffer_load_dwordx4 v21, s[32:35], s60 offen lds
    s_cmp_eq_u32 s54, s49
    s_cselect_b32 s54, s55, s54
    s_add_u32 m0, s7, 16384
    s_add_u32 s60, s54, 7168
    buffer_load_dwordx4 v21, s[32:35], s54 offen lds
    s_add_u32 m0, m0, 1024
    s_add_u32 s54, s54, 14336
    buffer_load_dwordx4 v21, s[32:35], s60 offen lds
    s_cmp_eq_u32 s54, s49
    s_cselect_b32 s54, s55, s54
L_h4_nowd:
    v_lshlrev_b32 v9, 7, v1
    s_lshl_b32 s60, s56, 11
    s_lshl_b32 s61, s57, 3
    s_add_u32 s60, s60, s61
    s_add_u32 s60, s60, 6619136
    v_add_u32 v19, s60, v9
    s_lshl_b32 s61, s4, 2
    s_lshl_b32 s50, 15, s61
    s_and_b32 s50, s50, 0x7f7f
    s_mov_b32 s51, 0
    s_waitcnt vmcnt(0)
    s_barrier
    s_mov_b64 exec, s[50:51]
    buffer_store_dwordx2 v[24:25], v19, s[20:23], 0 offen sc1
    s_mov_b64 exec, -1
    s_cmp_ge_u32 s6, 28
    s_cbranch_scc1 L_p5_skip_h
    s_lshr_b32 s52, s3, 2
    s_lshl_b32 s54, s47, 1
    s_add_u32 s53, s54, s52
    s_lshl_b32 s63, s46, 2
    s_add_u32 s63, s63, s4
    s_mul_i32 s62, s53, 28672
    s_lshl_b32 s61, s63, 10
    s_add_u32 s62, s62, s61
    s_add_u32 s62, s62, 9437184
    buffer_load_dwordx4 v[240:243], v2, s[20:23], s62 offen sc1
    v_mul_u32_u24 v3, 896, v12
    v_lshl_add_u32 v3, v13, 4, v3
    s_mul_i32 s62, s53, 28672
    s_lshl_b32 s61, s63, 5
    s_add_u32 s62, s62, s61
    s_mul_i32 s7, s4, 38912
    v_add_u32 v8, s7, v2
    s_cmp_lg_u32 s3, 4
    s_cbranch_scc1 L_h5_np
    s_lshl_b32 s60, s47, 3
    s_add_u32 s60, s60, s46
    s_lshl_b32 s60, s60, 7
    s_add_u32 s60, s60, 6619136
    v_lshl_add_u32 v17, v1, 3, s60
    s_mov_b32 exec_lo, 0xffff
    s_mov_b32 exec_hi, 0x0
    s_mov_b32 s60, 0
L_poll_D:
    buffer_load_dwordx2 v[10:11], v17, s[20:23], 0 offen sc1
    s_add_u32 s60, s60, 1
    s_waitcnt vmcnt(0)
    v_cmp_ne_u64 vcc, s[44:45], v[10:11]
    s_cmp_gt_u32 s60, 40000
    s_cbranch_scc1 L_polld_D
    s_cbranch_vccnz L_poll_D
L_polld_D:
    s_mov_b64 exec, -1
L_h5_np:
    s_setprio 0
    s_barrier
    s_barrier
    ds_read_b128 v[16:19], v8 offset:0
    ds_read_b128 v[20:23], v8 offset:1024
    ds_read_b128 v[248:251], v8 offset:2048
    ds_read_b128 v[252:255], v8 offset:3072
    s_waitcnt lgkmcnt(2)
    v_mfma_f32_32x32x16_bf16 v[24:39], v[88:91], v[16:19], 0
    v_mfma_f32_32x32x16_bf16 v[40:55], v[92:95], v[16:19], 0
    v_mfma_f32_32x32x16_bf16 v[56:71], v[88:91], v[20:23], 0
    v_mfma_f32_32x32x16_bf16 v[72:87], v[92:95], v[20:23], 0
    s_waitcnt lgkmcnt(0)
    v_mfma_f32_32x32x16_bf16 v[24:39], v[96:99], v[248:251], v[24:39]
    v_mfma_f32_32x32x16_bf16 v[40:55], v[100:103], v[248:251], v[40:55]
    v_mfma_f32_32x32x16_bf16 v[56:71], v[96:99], v[252:255], v[56:71]
    v_mfma_f32_32x32x16_bf16 v[72:87], v[100:103], v[252:255], v[72:87]
    s_barrier
    ds_read_b128 v[16:19], v8 offset:4096
    ds_read_b128 v[20:23], v8 offset:5120
    ds_read_b128 v[248:251], v8 offset:6144
    ds_read_b128 v[252:255], v8 offset:7168
    s_waitcnt lgkmcnt(2)
    v_mfma_f32_32x32x16_bf16 v[24:39], v[104:107], v[16:19], v[24:39]
    v_mfma_f32_32x32x16_bf16 v[40:55], v[108:111], v[16:19], v[40:55]
    v_mfma_f32_32x32x16_bf16 v[56:71], v[104:107], v[20:23], v[56:71]
    v_mfma_f32_32x32x16_bf16 v[72:87], v[108:111], v[20:23], v[72:87]
    ds_read_b128 v[16:19], v8 offset:8192
    ds_read_b128 v[20:23], v8 offset:9216
    s_waitcnt lgkmcnt(2)
    v_mfma_f32_32x32x16_bf16 v[24:39], v[112:115], v[248:251], v[24:39]
    v_mfma_f32_32x32x16_bf16 v[40:55], v[116:119], v[248:251], v[40:55]
    v_mfma_f32_32x32x16_bf16 v[56:71], v[112:115], v[252:255], v[56:71]
    v_mfma_f32_32x32x16_bf16 v[72:87], v[116:119], v[252:255], v[72:87]
    s_waitcnt lgkmcnt(0)
    v_mfma_f32_32x32x16_bf16 v[24:39], v[120:123], v[16:19], v[24:39]
    v_mfma_f32_32x32x16_bf16 v[40:55], v[124:127], v[16:19], v[40:55]
    v_mfma_f32_32x32x16_bf16 v[56:71], v[120:123], v[20:23], v[56:71]
    v_mfma_f32_32x32x16_bf16 v[72:87], v[124:127], v[20:23], v[72:87]
    s_barrier
    ds_read_b128 v[248:251], v8 offset:10240
    ds_read_b128 v[252:255], v8 offset:11264
    ds_read_b128 v[16:19], v8 offset:12288
    ds_read_b128 v[20:23], v8 offset:13312
    s_waitcnt lgkmcnt(2)
    v_mfma_f32_32x32x16_bf16 v[24:39], v[128:131], v[248:251], v[24:39]
    v_mfma_f32_32x32x16_bf16 v[40:55], v[132:135], v[248:251], v[40:55]
    v_mfma_f32_32x32x16_bf16 v[56:71], v[128:131], v[252:255], v[56:71]
    v_mfma_f32_32x32x16_bf16 v[72:87], v[132:135], v[252:255], v[72:87]
    ds_read_b128 v[248:251], v8 offset:14336
    ds_read_b128 v[252:255], v8 offset:15360
    s_waitcnt lgkmcnt(2)
    v_mfma_f32_32x32x16_bf16 v[24:39], v[136:139], v[16:19], v[24:39]
    v_mfma_f32_32x32x16_bf16 v[40:55], v[140:143], v[16:19], v[40:55]
    v_mfma_f32_32x32x16_bf16 v[56:71], v[136:139], v[20:23], v[56:71]
    v_mfma_f32_32x32x16_bf16 v[72:87], v[140:143], v[20:23], v[72:87]
    s_waitcnt lgkmcnt(0)
    v_mfma_f32_32x32x16_bf16 v[24:39], v[144:147], v[248:251], v[24:39]
    v_mfma_f32_32x32x16_bf16 v[40:55], v[148:151], v[248:251], v[40:55]
    v_mfma_f32_32x32x16_bf16 v[56:71], v[144:147], v[252:255], v[56:71]
    v_mfma_f32_32x32x16_bf16 v[72:87], v[148:151], v[252:255], v[72:87]
    s_xor_b32 s60, s4, 1
    s_mul_i32 s60, s60, 38912
    v_add_u32 v105, s60, v2
    s_xor_b32 s60, s4, 2
    s_mul_i32 s60, s60, 38912
    v_add_u32 v106, s60, v2
    s_xor_b32 s60, s4, 3
    s_mul_i32 s60, s60, 38912
    v_add_u32 v107, s60, v2
    s_xor_b32 s60, s4, 0
    s_mul_i32 s60, s60, 38912
    v_add_u32 v108, s60, v2
    s_xor_b32 s60, s4, 1
    s_mul_i32 s60, s60, 38912
    v_add_u32 v109, s60, v2
    s_xor_b32 s60, s4, 2
    s_mul_i32 s60, s60, 38912
    v_add_u32 v110, s60, v2
    s_xor_b32 s60, s4, 3
    s_mul_i32 s60, s60, 38912
    v_add_u32 v111, s60, v2
    s_barrier
    ds_read_b128 v[16:19], v8 offset:16384
    ds_read_b128 v[20:23], v8 offset:17408
    ds_read_b128 v[248:251], v8 offset:18432
    ds_read_b128 v[252:255], v8 offset:19456
    s_waitcnt lgkmcnt(2)
    v_mfma_f32_32x32x16_bf16 v[24:39], v[152:155], v[16:19], v[24:39]
    v_mfma_f32_32x32x16_bf16 v[40:55], v[156:159], v[16:19], v[40:55]
    v_mfma_f32_32x32x16_bf16 v[56:71], v[152:155], v[20:23], v[56:71]
    v_mfma_f32_32x32x16_bf16 v[72:87], v[156:159], v[20:23], v[72:87]
    ds_read_b128 v[16:19], v8 offset:20480
    ds_read_b128 v[20:23], v8 offset:21504
    s_waitcnt lgkmcnt(2)
    v_mfma_f32_32x32x16_bf16 v[24:39], v[160:163], v[248:251], v[24:39]
    v_mfma_f32_32x32x16_bf16 v[40:55], v[164:167], v[248:251], v[40:55]
    v_mfma_f32_32x32x16_bf16 v[56:71], v[160:163], v[252:255], v[56:71]
    v_mfma_f32_32x32x16_bf16 v[72:87], v[164:167], v[252:255], v[72:87]
    s_waitcnt lgkmcnt(0)
    v_mfma_f32_32x32x16_bf16 v[24:39], v[168:171], v[16:19], v[24:39]
    v_mfma_f32_32x32x16_bf16 v[40:55], v[172:175], v[16:19], v[40:55]
    v_mfma_f32_32x32x16_bf16 v[56:71], v[168:171], v[20:23], v[56:71]
    v_mfma_f32_32x32x16_bf16 v[72:87], v[172:175], v[20:23], v[72:87]
    s_barrier
    ds_read_b128 v[248:251], v8 offset:22528
    ds_read_b128 v[252:255], v8 offset:23552
    ds_read_b128 v[16:19], v8 offset:24576
    ds_read_b128 v[20:23], v8 offset:25600
    s_waitcnt lgkmcnt(2)
    v_mfma_f32_32x32x16_bf16 v[24:39], v[176:179], v[248:251], v[24:39]
    v_mfma_f32_32x32x16_bf16 v[40:55], v[180:183], v[248:251], v[40:55]
    v_mfma_f32_32x32x16_bf16 v[56:71], v[176:179], v[252:255], v[56:71]
    v_mfma_f32_32x32x16_bf16 v[72:87], v[180:183], v[252:255], v[72:87]
    ds_read_b128 v[248:251], v8 offset:26624
    ds_read_b128 v[252:255], v8 offset:27648
    s_waitcnt lgkmcnt(2)
    v_mfma_f32_32x32x16_bf16 v[24:39], v[184:187], v[16:19], v[24:39]
    v_mfma_f32_32x32x16_bf16 v[40:55], v[188:191], v[16:19], v[40:55]
    v_mfma_f32_32x32x16_bf16 v[56:71], v[184:187], v[20:23], v[56:71]
    v_mfma_f32_32x32x16_bf16 v[72:87], v[188:191], v[20:23], v[72:87]
    ds_read_b128 v[16:19], v8 offset:28672
    ds_read_b128 v[20:23], v8 offset:29696
    s_waitcnt lgkmcnt(2)
    v_mfma_f32_32x32x16_bf16 v[24:39], v[192:195], v[248:251], v[24:39]
    v_mfma_f32_32x32x16_bf16 v[40:55], v[196:199], v[248:251], v[40:55]
    v_mfma_f32_32x32x16_bf16 v[56:71], v[192:195], v[252:255], v[56:71]
    v_mfma_f32_32x32x16_bf16 v[72:87], v[196:199], v[252:255], v[72:87]
    s_waitcnt lgkmcnt(0)
    v_mfma_f32_32x32x16_bf16 v[24:39], v[200:203], v[16:19], v[24:39]
    v_mfma_f32_32x32x16_bf16 v[40:55], v[204:207], v[16:19], v[40:55]
    v_mfma_f32_32x32x16_bf16 v[56:71], v[200:203], v[20:23], v[56:71]
    v_mfma_f32_32x32x16_bf16 v[72:87], v[204:207], v[20:23], v[72:87]
    s_barrier
    ds_read_b128 v[248:251], v8 offset:30720
    ds_read_b128 v[252:255], v8 offset:31744
    ds_read_b128 v[16:19], v8 offset:32768
    ds_read_b128 v[20:23], v8 offset:33792
    s_waitcnt lgkmcnt(2)
    v_mfma_f32_32x32x16_bf16 v[24:39], v[208:211], v[248:251], v[24:39]
    v_mfma_f32_32x32x16_bf16 v[40:55], v[212:215], v[248:251], v[40:55]
    v_mfma_f32_32x32x16_bf16 v[56:71], v[208:211], v[252:255], v[56:71]
    v_mfma_f32_32x32x16_bf16 v[72:87], v[212:215], v[252:255], v[72:87]
    ds_read_b128 v[248:251], v8 offset:34816
    ds_read_b128 v[252:255], v8 offset:35840
    s_waitcnt lgkmcnt(2)
    v_mfma_f32_32x32x16_bf16 v[24:39], v[216:219], v[16:19], v[24:39]
    v_mfma_f32_32x32x16_bf16 v[40:55], v[220:223], v[16:19], v[40:55]
    v_mfma_f32_32x32x16_bf16 v[56:71], v[216:219], v[20:23], v[56:71]
    v_mfma_f32_32x32x16_bf16 v[72:87], v[220:223], v[20:23], v[72:87]
    ds_read_b128 v[16:19], v8 offset:36864
    ds_read_b128 v[20:23], v8 offset:37888
    s_waitcnt lgkmcnt(2)
    v_mfma_f32_32x32x16_bf16 v[24:39], v[224:227], v[248:251], v[24:39]
    v_mfma_f32_32x32x16_bf16 v[40:55], v[228:231], v[248:251], v[40:55]
    v_mfma_f32_32x32x16_bf16 v[56:71], v[224:227], v[252:255], v[56:71]
    v_mfma_f32_32x32x16_bf16 v[72:87], v[228:231], v[252:255], v[72:87]
    s_waitcnt lgkmcnt(0)
    v_mfma_f32_32x32x16_bf16 v[24:39], v[232:235], v[16:19], v[24:39]
    v_mfma_f32_32x32x16_bf16 v[40:55], v[236:239], v[16:19], v[40:55]
    v_mfma_f32_32x32x16_bf16 v[56:71], v[232:235], v[20:23], v[56:71]
    v_mfma_f32_32x32x16_bf16 v[72:87], v[236:239], v[20:23], v[72:87]
    s_waitcnt vmcnt(0)
    s_nop 7
    ds_write_b128 v8, v[32:35] offset:14336
    ds_write_b128 v8, v[36:39] offset:15360
    ds_write_b128 v8, v[40:43] offset:16384
    ds_write_b128 v8, v[44:47] offset:17408
    ds_write_b128 v8, v[48:51] offset:18432
    ds_write_b128 v8, v[52:55] offset:19456
    ds_write_b128 v8, v[56:59] offset:20480
    ds_write_b128 v8, v[60:63] offset:21504
    ds_write_b128 v8, v[64:67] offset:22528
    ds_write_b128 v8, v[68:71] offset:23552
    ds_write_b128 v8, v[72:75] offset:24576
    ds_write_b128 v8, v[76:79] offset:25600
    ds_write_b128 v8, v[80:83] offset:26624
    ds_write_b128 v8, v[84:87] offset:27648
    v_lshlrev_b32 v96, 16, v240
    v_and_b32 v97, 0xffff0000, v240
    v_lshlrev_b32 v98, 16, v241
    v_and_b32 v99, 0xffff0000, v241
    v_lshlrev_b32 v100, 16, v242
    v_and_b32 v101, 0xffff0000, v242
    v_lshlrev_b32 v102, 16, v243
    v_and_b32 v103, 0xffff0000, v243
    v_pk_add_f32 v[24:25], v[24:25], v[96:97]
    v_pk_add_f32 v[26:27], v[26:27], v[98:99]
    v_pk_add_f32 v[28:29], v[28:29], v[100:101]
    v_pk_add_f32 v[30:31], v[30:31], v[102:103]
    s_waitcnt lgkmcnt(0)
    s_barrier
    ds_read_b128 v[32:35], v105 offset:14336
    ds_read_b128 v[36:39], v105 offset:15360
    ds_read_b128 v[40:43], v106 offset:16384
    ds_read_b128 v[44:47], v106 offset:17408
    ds_read_b128 v[48:51], v107 offset:18432
    ds_read_b128 v[52:55], v107 offset:19456
    ds_read_b128 v[56:59], v108 offset:6144
    ds_read_b128 v[60:63], v108 offset:7168
    ds_read_b128 v[64:67], v109 offset:8192
    ds_read_b128 v[68:71], v109 offset:9216
    ds_read_b128 v[72:75], v110 offset:10240
    ds_read_b128 v[76:79], v110 offset:11264
    ds_read_b128 v[80:83], v111 offset:12288
    ds_read_b128 v[84:87], v111 offset:13312
    s_waitcnt lgkmcnt(12)
    v_pk_add_f32 v[24:25], v[24:25], v[32:33]
    v_pk_add_f32 v[26:27], v[26:27], v[34:35]
    v_pk_add_f32 v[28:29], v[28:29], v[36:37]
    v_pk_add_f32 v[30:31], v[30:31], v[38:39]
    s_waitcnt lgkmcnt(10)
    v_pk_add_f32 v[24:25], v[24:25], v[40:41]
    v_pk_add_f32 v[26:27], v[26:27], v[42:43]
    v_pk_add_f32 v[28:29], v[28:29], v[44:45]
    v_pk_add_f32 v[30:31], v[30:31], v[46:47]
    s_waitcnt lgkmcnt(8)
    v_pk_add_f32 v[24:25], v[24:25], v[48:49]
    v_pk_add_f32 v[26:27], v[26:27], v[50:51]
    v_pk_add_f32 v[28:29], v[28:29], v[52:53]
    v_pk_add_f32 v[30:31], v[30:31], v[54:55]
    s_waitcnt lgkmcnt(6)
    v_pk_add_f32 v[24:25], v[24:25], v[56:57]
    v_pk_add_f32 v[26:27], v[26:27], v[58:59]
    v_pk_add_f32 v[28:29], v[28:29], v[60:61]
    v_pk_add_f32 v[30:31], v[30:31], v[62:63]
    s_waitcnt lgkmcnt(4)
    v_pk_add_f32 v[24:25], v[24:25], v[64:65]
    v_pk_add_f32 v[26:27], v[26:27], v[66:67]
    v_pk_add_f32 v[28:29], v[28:29], v[68:69]
    v_pk_add_f32 v[30:31], v[30:31], v[70:71]
    s_waitcnt lgkmcnt(2)
    v_pk_add_f32 v[24:25], v[24:25], v[72:73]
    v_pk_add_f32 v[26:27], v[26:27], v[74:75]
    v_pk_add_f32 v[28:29], v[28:29], v[76:77]
    v_pk_add_f32 v[30:31], v[30:31], v[78:79]
    s_waitcnt lgkmcnt(0)
    v_pk_add_f32 v[24:25], v[24:25], v[80:81]
    v_pk_add_f32 v[26:27], v[26:27], v[82:83]
    v_pk_add_f32 v[28:29], v[28:29], v[84:85]
    v_pk_add_f32 v[30:31], v[30:31], v[86:87]
    v_cvt_pk_bf16_f32 v96, v24, v25
    v_cvt_pk_bf16_f32 v97, v26, v27
    v_cvt_pk_bf16_f32 v98, v28, v29
    v_cvt_pk_bf16_f32 v99, v30, v31
    buffer_store_dwordx4 v[96:99], v3, s[36:39], s62 offen
L_p5_skip_h:
    s_endpgm
L_h2_redo:
    s_mov_b32 s62, 1
    s_barrier
    s_barrier
    s_branch L_h2_again
L_compute:
    s_mov_b32 s18, 0x62000
    s_mov_b32 s19, 0x00020000
    s_mov_b32 s22, 0x10000000
    s_mov_b32 s23, 0x00020000
    s_mov_b32 s26, 0x188000
    s_mov_b32 s27, 0x00020000
    s_mov_b32 s30, 0x188000
    s_mov_b32 s31, 0x00020000
    s_mov_b32 s34, 0x188000
    s_mov_b32 s35, 0x00020000
    s_mov_b32 s38, 0x1c0000
    s_mov_b32 s39, 0x00020000
    s_mov_b32 s42, 0x100
    s_mov_b32 s43, 0x00020000
    s_mov_b64 s[16:17], s[68:69]
    s_mov_b64 s[24:25], s[72:73]
    s_mov_b64 s[28:29], s[74:75]
    s_mov_b64 s[32:33], s[76:77]
    s_mov_b64 s[36:37], s[78:79]
    s_mov_b64 s[40:41], s[80:81]
    s_mov_b64 s[20:21], s[82:83]
    v_and_b32 v12, 31, v1
    v_lshrrev_b32 v13, 5, v1
    v_mov_b32 v15, 0x3f803f80
    v_bfe_u32 v14, v12, 1, 3
    v_xor_b32 v14, v14, v13
    v_lshlrev_b32 v14, 4, v14
    v_lshl_add_u32 v14, v12, 7, v14
    s_lshl_b32 s61, s4, 5
    v_xor_b32 v14, s61, v14
    v_add_u32 v4, s57, v14
    v_xor_b32 v5, 32, v4
    v_xor_b32 v6, 64, v4
    v_xor_b32 v7, 96, v4
    v_bfe_u32 v9, v1, 4, 1
    v_bfe_u32 v10, v1, 2, 2
    v_lshl_add_u32 v10, v13, 3, v10
    v_mul_u32_u24 v10, 192, v10
    v_lshl_add_u32 v10, v9, 5, v10
    v_and_b32 v11, 3, v1
    v_lshl_add_u32 v10, v11, 3, v10
    s_xor_b32 s61, s4, 0
    s_mul_i32 s61, s61, 3072
    s_add_u32 s61, s61, s55
    s_add_u32 s61, s61, 16384
    v_add_u32 v128, s61, v10
    s_xor_b32 s61, s4, 1
    s_mul_i32 s61, s61, 3072
    s_add_u32 s61, s61, s55
    s_add_u32 s61, s61, 16384
    v_add_u32 v129, s61, v10
    s_xor_b32 s61, s4, 2
    s_mul_i32 s61, s61, 3072
    s_add_u32 s61, s61, s55
    s_add_u32 s61, s61, 16384
    v_add_u32 v130, s61, v10
    s_xor_b32 s61, s4, 3
    s_mul_i32 s61, s61, 3072
    s_add_u32 s61, s61, s55
    s_add_u32 s61, s61, 16384
    v_add_u32 v131, s61, v10
    s_add_u32 s46, s46, 1
    s_cmp_eq_u32 s46, 7
    s_cselect_b32 s46, 0, s46
    s_add_u32 s47, s47, 28672
    s_cmp_eq_u32 s47, 143360
    s_cselect_b32 s47, 0, s47
    s_lshl_b32 s60, s46, 7
    s_add_u32 s60, s60, s56
    s_add_u32 m0, s57, s47
    s_mul_i32 s61, s46, 172032
    buffer_load_dwordx4 v2, s[8:11], s60 offen lds
    s_add_u32 m0, m0, 1024
    s_add_u32 s60, s60, 7168
    buffer_load_dwordx4 v3, s[8:11], s60 offen lds
    s_add_u32 m0, m0, 1024
    s_add_u32 s60, s60, 7168
    buffer_load_dwordx4 v2, s[8:11], s60 offen lds
    s_add_u32 m0, m0, 1024
    s_add_u32 s60, s60, 7168
    buffer_load_dwordx4 v3, s[8:11], s60 offen lds
    s_add_u32 m0, s59, s47
    s_add_u32 s61, s61, s58
    buffer_load_dwordx4 v16, s[12:15], s61 offen lds
    s_add_u32 m0, m0, 1024
    s_nop 0
    buffer_load_dwordx4 v17, s[12:15], s61 offen lds
    s_add_u32 m0, m0, 1024
    s_nop 0
    buffer_load_dwordx4 v18, s[12:15], s61 offen lds
    s_add_u32 s46, s46, 1
    s_cmp_eq_u32 s46, 7
    s_cselect_b32 s46, 0, s46
    s_add_u32 s47, s47, 28672
    s_cmp_eq_u32 s47, 143360
    s_cselect_b32 s47, 0, s47
    s_cmp_lg_u32 s3, 0
    s_cbranch_scc1 L_p1_nofp
    s_lshl_b32 s60, s2, 10
    s_add_u32 s60, s60, 6291456
    v_lshl_add_u32 v9, v1, 7, s60
    s_lshl_b32 s60, s5, 2
    s_and_b32 s61, s6, 3
    s_add_u32 s60, s60, s61
    s_lshl_b32 s60, s60, 3
    s_lshr_b32 s61, s6, 2
    s_add_u32 s60, s60, s61
    s_lshl_b32 s60, s60, 7
    s_add_u32 s61, s60, 6553600
    v_writelane_b32 v9, s61, 6
    s_add_u32 s61, s60, 6619136
    v_writelane_b32 v9, s61, 7
    s_lshl_b32 s61, s2, 7
    s_add_u32 s61, s61, 6586368
    v_writelane_b32 v9, s61, 8
    s_mov_b64 exec, 0x1ff
    buffer_load_dword v251, v9, s[20:23], 0 offen sc1
    s_mov_b64 exec, -1
L_p1_nofp:
    v_mov_b32 v124, 0
    v_mov_b32 v125, 0
    v_mov_b32 v126, 0
    v_mov_b32 v127, 0
    s_mov_b32 exec_lo, 0x20001
    s_mov_b32 exec_hi, 0x20001
    v_mov_b32 v124, v15
    v_mov_b32 v125, v15
    v_mov_b32 v126, v15
    v_mov_b32 v127, v15
    s_mov_b64 exec, -1
    s_lshl_b32 s60, s4, 9
    s_add_u32 s60, s60, 159744
    v_lshl_add_u32 v132, v1, 2, s60
    v_lshlrev_b32 v2, 4, v1
    s_lshl_b32 s56, s4, 8
    s_add_u32 s56, s56, 161792
    v_lshl_add_u32 v133, v12, 2, s56
    v_lshl_add_u32 v134, v13, 4, s56
    v_lshlrev_b32 v135, 4, v13
    v_add_u32 v135, 162816, v135
    v_lshlrev_b32 v136, 2, v12
    v_add_u32 v136, 162816, v136
    v_mov_b32 v14, 163328
    v_mov_b32 v228, -1
    v_mov_b32 v229, 0
    v_mov_b32 v230, 0
    v_mov_b32 v231, -1
    v_mov_b32 v232, 0
    s_mov_b32 exec_lo, 0
    v_mov_b32 v228, 0
    v_mov_b32 v229, v15
    v_mov_b32 v230, 0xffff
    s_mov_b32 exec_lo, 0xf0000000
    s_mov_b32 exec_hi, 0xf0000000
    v_mov_b32 v231, 0
    s_mov_b32 exec_lo, 0x10000000
    s_mov_b32 exec_hi, 0x10000000
    v_mov_b32 v232, v15
    s_mov_b64 exec, -1
    s_mul_i32 s60, s53, 3
    s_add_u32 s61, s60, 0
    s_and_b32 s62, s61, 15
    s_lshl_b32 s62, s62, 6
    s_add_u32 s62, s62, s54
    s_lshl_b32 s57, s62, 11
    s_lshl_b32 s62, s62, 12
    s_add_u32 s62, s62, 2097152
    s_cmp_ge_u32 s61, 16
    s_cselect_b32 s57, s62, s57
    s_add_u32 s62, s62, 2048
    s_cmp_ge_u32 s61, 32
    s_cselect_b32 s57, s62, s57
    s_add_u32 s61, s60, 1
    s_and_b32 s62, s61, 15
    s_lshl_b32 s62, s62, 6
    s_add_u32 s62, s62, s54
    s_lshl_b32 s58, s62, 11
    s_lshl_b32 s62, s62, 12
    s_add_u32 s62, s62, 2097152
    s_cmp_ge_u32 s61, 16
    s_cselect_b32 s58, s62, s58
    s_add_u32 s62, s62, 2048
    s_cmp_ge_u32 s61, 32
    s_cselect_b32 s58, s62, s58
    s_add_u32 s61, s60, 2
    s_and_b32 s62, s61, 15
    s_lshl_b32 s62, s62, 6
    s_add_u32 s62, s62, s54
    s_lshl_b32 s59, s62, 11
    s_lshl_b32 s62, s62, 12
    s_add_u32 s62, s62, 2097152
    s_cmp_ge_u32 s61, 16
    s_cselect_b32 s59, s62, s59
    s_add_u32 s62, s62, 2048
    s_cmp_ge_u32 s61, 32
    s_cselect_b32 s59, s62, s59
    s_cmp_eq_u32 s53, 10
    s_cbranch_scc1 L_p1_v1
    s_cmp_gt_u32 s53, 10
    s_cbranch_scc1 L_p1_v2
L_p1_v0:
    s_barrier
    ds_read_b128 v[100:103], v4 offset:0
    ds_read_b64_tr_b16 v[64:65], v128 offset:0
    ds_read_b64_tr_b16 v[66:67], v128 offset:768
    ds_read_b64_tr_b16 v[68:69], v128 offset:56
    ds_read_b64_tr_b16 v[70:71], v128 offset:824
    ds_read_b64_tr_b16 v[72:73], v128 offset:112
    ds_read_b64_tr_b16 v[74:75], v128 offset:880
    ds_read_b128 v[104:107], v5 offset:0
    ds_read_b64_tr_b16 v[76:77], v129 offset:0
    ds_read_b64_tr_b16 v[78:79], v129 offset:768
    ds_read_b64_tr_b16 v[80:81], v129 offset:56
    ds_read_b64_tr_b16 v[82:83], v129 offset:824
    ds_read_b64_tr_b16 v[84:85], v129 offset:112
    ds_read_b64_tr_b16 v[86:87], v129 offset:880
    s_waitcnt lgkmcnt(7)
    v_mfma_f32_32x32x16_bf16 v[16:31], v[64:67], v[100:103], 0
    ds_read_b128 v[108:111], v6 offset:0
    ds_read_b64_tr_b16 v[88:89], v130 offset:0
    ds_read_b64_tr_b16 v[90:91], v130 offset:768
    v_mfma_f32_32x32x16_bf16 v[32:47], v[68:71], v[100:103], 0
    ds_read_b64_tr_b16 v[92:93], v130 offset:56
    ds_read_b64_tr_b16 v[94:95], v130 offset:824
    v_mfma_f32_32x32x16_bf16 v[48:63], v[72:75], v[100:103], 0
    ds_read_b64_tr_b16 v[96:97], v130 offset:112
    ds_read_b64_tr_b16 v[98:99], v130 offset:880
    v_mfma_f32_16x16x32_bf16 v[112:115], v[124:127], v[64:67], 0
    v_mfma_f32_16x16x32_bf16 v[116:119], v[124:127], v[68:71], 0
    v_mfma_f32_16x16x32_bf16 v[120:123], v[124:127], v[72:75], 0
    s_waitcnt lgkmcnt(7)
    v_mfma_f32_32x32x16_bf16 v[16:31], v[76:79], v[104:107], v[16:31]
    ds_read_b128 v[100:103], v7 offset:0
    ds_read_b64_tr_b16 v[64:65], v131 offset:0
    ds_read_b64_tr_b16 v[66:67], v131 offset:768
    v_mfma_f32_32x32x16_bf16 v[32:47], v[80:83], v[104:107], v[32:47]
    ds_read_b64_tr_b16 v[68:69], v131 offset:56
    ds_read_b64_tr_b16 v[70:71], v131 offset:824
    v_mfma_f32_32x32x16_bf16 v[48:63], v[84:87], v[104:107], v[48:63]
    ds_read_b64_tr_b16 v[72:73], v131 offset:112
    ds_read_b64_tr_b16 v[74:75], v131 offset:880
    s_waitcnt vmcnt(0)
    s_barrier
    s_waitcnt lgkmcnt(7)
    v_mfma_f32_32x32x16_bf16 v[16:31], v[88:91], v[108:111], v[16:31]
    ds_read_b128 v[104:107], v4 offset:28672
    ds_read_b64_tr_b16 v[76:77], v128 offset:28672
    ds_read_b64_tr_b16 v[78:79], v128 offset:29440
    v_mfma_f32_32x32x16_bf16 v[32:47], v[92:95], v[108:111], v[32:47]
    ds_read_b64_tr_b16 v[80:81], v128 offset:28728
    ds_read_b64_tr_b16 v[82:83], v128 offset:29496
    v_mfma_f32_32x32x16_bf16 v[48:63], v[96:99], v[108:111], v[48:63]
    ds_read_b64_tr_b16 v[84:85], v128 offset:28784
    ds_read_b64_tr_b16 v[86:87], v128 offset:29552
    s_waitcnt lgkmcnt(7)
    v_mfma_f32_32x32x16_bf16 v[16:31], v[64:67], v[100:103], v[16:31]
    ds_read_b128 v[108:111], v5 offset:28672
    ds_read_b64_tr_b16 v[88:89], v129 offset:28672
    ds_read_b64_tr_b16 v[90:91], v129 offset:29440
    v_mfma_f32_32x32x16_bf16 v[32:47], v[68:71], v[100:103], v[32:47]
    ds_read_b64_tr_b16 v[92:93], v129 offset:28728
    ds_read_b64_tr_b16 v[94:95], v129 offset:29496
    v_mfma_f32_32x32x16_bf16 v[48:63], v[72:75], v[100:103], v[48:63]
    ds_read_b64_tr_b16 v[96:97], v129 offset:28784
    ds_read_b64_tr_b16 v[98:99], v129 offset:29552
    s_waitcnt lgkmcnt(7)
    v_mfma_f32_32x32x16_bf16 v[16:31], v[76:79], v[104:107], v[16:31]
    ds_read_b128 v[100:103], v6 offset:28672
    ds_read_b64_tr_b16 v[64:65], v130 offset:28672
    ds_read_b64_tr_b16 v[66:67], v130 offset:29440
    v_mfma_f32_32x32x16_bf16 v[32:47], v[80:83], v[104:107], v[32:47]
    ds_read_b64_tr_b16 v[68:69], v130 offset:28728
    ds_read_b64_tr_b16 v[70:71], v130 offset:29496
    v_mfma_f32_32x32x16_bf16 v[48:63], v[84:87], v[104:107], v[48:63]
    ds_read_b64_tr_b16 v[72:73], v130 offset:28784
    ds_read_b64_tr_b16 v[74:75], v130 offset:29552
    v_mfma_f32_16x16x32_bf16 v[112:115], v[124:127], v[76:79], v[112:115]
    v_mfma_f32_16x16x32_bf16 v[116:119], v[124:127], v[80:83], v[116:119]
    v_mfma_f32_16x16x32_bf16 v[120:123], v[124:127], v[84:87], v[120:123]
    s_waitcnt lgkmcnt(7)
    v_mfma_f32_32x32x16_bf16 v[16:31], v[88:91], v[108:111], v[16:31]
    ds_read_b128 v[104:107], v7 offset:28672
    ds_read_b64_tr_b16 v[76:77], v131 offset:28672
    ds_read_b64_tr_b16 v[78:79], v131 offset:29440
    v_mfma_f32_32x32x16_bf16 v[32:47], v[92:95], v[108:111], v[32:47]
    ds_read_b64_tr_b16 v[80:81], v131 offset:28728
    ds_read_b64_tr_b16 v[82:83], v131 offset:29496
    v_mfma_f32_32x32x16_bf16 v[48:63], v[96:99], v[108:111], v[48:63]
    ds_read_b64_tr_b16 v[84:85], v131 offset:28784
    ds_read_b64_tr_b16 v[86:87], v131 offset:29552
    s_barrier
    v_add_u32 v4, 0xe000, v4
    v_add_u32 v5, 0xe000, v5
    v_add_u32 v6, 0xe000, v6
    v_add_u32 v7, 0xe000, v7
    v_add_u32 v128, 0xe000, v128
    v_add_u32 v129, 0xe000, v129
    v_add_u32 v130, 0xe000, v130
    v_add_u32 v131, 0xe000, v131
    s_waitcnt lgkmcnt(7)
    v_mfma_f32_32x32x16_bf16 v[16:31], v[64:67], v[100:103], v[16:31]
    ds_read_b128 v[108:111], v4 offset:0
    ds_read_b64_tr_b16 v[88:89], v128 offset:0
    ds_read_b64_tr_b16 v[90:91], v128 offset:768
    v_mfma_f32_32x32x16_bf16 v[32:47], v[68:71], v[100:103], v[32:47]
    ds_read_b64_tr_b16 v[92:93], v128 offset:56
    ds_read_b64_tr_b16 v[94:95], v128 offset:824
    v_mfma_f32_32x32x16_bf16 v[48:63], v[72:75], v[100:103], v[48:63]
    ds_read_b64_tr_b16 v[96:97], v128 offset:112
    ds_read_b64_tr_b16 v[98:99], v128 offset:880
    s_waitcnt lgkmcnt(7)
    v_mfma_f32_32x32x16_bf16 v[16:31], v[76:79], v[104:107], v[16:31]
    ds_read_b128 v[100:103], v5 offset:0
    ds_read_b64_tr_b16 v[64:65], v129 offset:0
    ds_read_b64_tr_b16 v[66:67], v129 offset:768
    v_mfma_f32_32x32x16_bf16 v[32:47], v[80:83], v[104:107], v[32:47]
    ds_read_b64_tr_b16 v[68:69], v129 offset:56
    ds_read_b64_tr_b16 v[70:71], v129 offset:824
    v_mfma_f32_32x32x16_bf16 v[48:63], v[84:87], v[104:107], v[48:63]
    ds_read_b64_tr_b16 v[72:73], v129 offset:112
    ds_read_b64_tr_b16 v[74:75], v129 offset:880
    s_waitcnt lgkmcnt(7)
    v_mfma_f32_32x32x16_bf16 v[16:31], v[88:91], v[108:111], v[16:31]
    ds_read_b128 v[104:107], v6 offset:0
    ds_read_b64_tr_b16 v[76:77], v130 offset:0
    ds_read_b64_tr_b16 v[78:79], v130 offset:768
    v_mfma_f32_32x32x16_bf16 v[32:47], v[92:95], v[108:111], v[32:47]
    ds_read_b64_tr_b16 v[80:81], v130 offset:56
    ds_read_b64_tr_b16 v[82:83], v130 offset:824
    v_mfma_f32_32x32x16_bf16 v[48:63], v[96:99], v[108:111], v[48:63]
    ds_read_b64_tr_b16 v[84:85], v130 offset:112
    ds_read_b64_tr_b16 v[86:87], v130 offset:880
    v_mfma_f32_16x16x32_bf16 v[112:115], v[124:127], v[88:91], v[112:115]
    v_mfma_f32_16x16x32_bf16 v[116:119], v[124:127], v[92:95], v[116:119]
    v_mfma_f32_16x16x32_bf16 v[120:123], v[124:127], v[96:99], v[120:123]
    s_waitcnt lgkmcnt(7)
    v_mfma_f32_32x32x16_bf16 v[16:31], v[64:67], v[100:103], v[16:31]
    ds_read_b128 v[108:111], v7 offset:0
    ds_read_b64_tr_b16 v[88:89], v131 offset:0
    ds_read_b64_tr_b16 v[90:91], v131 offset:768
    v_mfma_f32_32x32x16_bf16 v[32:47], v[68:71], v[100:103], v[32:47]
    ds_read_b64_tr_b16 v[92:93], v131 offset:56
    ds_read_b64_tr_b16 v[94:95], v131 offset:824
    v_mfma_f32_32x32x16_bf16 v[48:63], v[72:75], v[100:103], v[48:63]
    ds_read_b64_tr_b16 v[96:97], v131 offset:112
    ds_read_b64_tr_b16 v[98:99], v131 offset:880
    s_barrier
    s_waitcnt lgkmcnt(7)
    v_mfma_f32_32x32x16_bf16 v[16:31], v[76:79], v[104:107], v[16:31]
    ds_read_b128 v[100:103], v4 offset:28672
    ds_read_b64_tr_b16 v[64:65], v128 offset:28672
    ds_read_b64_tr_b16 v[66:67], v128 offset:29440
    v_mfma_f32_32x32x16_bf16 v[32:47], v[80:83], v[104:107], v[32:47]
    ds_read_b64_tr_b16 v[68:69], v128 offset:28728
    ds_read_b64_tr_b16 v[70:71], v128 offset:29496
    v_mfma_f32_32x32x16_bf16 v[48:63], v[84:87], v[104:107], v[48:63]
    ds_read_b64_tr_b16 v[72:73], v128 offset:28784
    ds_read_b64_tr_b16 v[74:75], v128 offset:29552
    s_waitcnt lgkmcnt(7)
    v_mfma_f32_32x32x16_bf16 v[16:31], v[88:91], v[108:111], v[16:31]
    ds_read_b128 v[104:107], v5 offset:28672
    ds_read_b64_tr_b16 v[76:77], v129 offset:28672
    ds_read_b64_tr_b16 v[78:79], v129 offset:29440
    v_mfma_f32_32x32x16_bf16 v[32:47], v[92:95], v[108:111], v[32:47]
    ds_read_b64_tr_b16 v[80:81], v129 offset:28728
    ds_read_b64_tr_b16 v[82:83], v129 offset:29496
    v_mfma_f32_32x32x16_bf16 v[48:63], v[96:99], v[108:111], v[48:63]
    ds_read_b64_tr_b16 v[84:85], v129 offset:28784
    ds_read_b64_tr_b16 v[86:87], v129 offset:29552
    s_waitcnt lgkmcnt(7)
    v_mfma_f32_32x32x16_bf16 v[16:31], v[64:67], v[100:103], v[16:31]
    ds_read_b128 v[108:111], v6 offset:28672
    ds_read_b64_tr_b16 v[88:89], v130 offset:28672
    ds_read_b64_tr_b16 v[90:91], v130 offset:29440
    v_mfma_f32_32x32x16_bf16 v[32:47], v[68:71], v[100:103], v[32:47]
    ds_read_b64_tr_b16 v[92:93], v130 offset:28728
    ds_read_b64_tr_b16 v[94:95], v130 offset:29496
    v_mfma_f32_32x32x16_bf16 v[48:63], v[72:75], v[100:103], v[48:63]
    ds_read_b64_tr_b16 v[96:97], v130 offset:28784
    ds_read_b64_tr_b16 v[98:99], v130 offset:29552
    v_mfma_f32_16x16x32_bf16 v[112:115], v[124:127], v[64:67], v[112:115]
    v_mfma_f32_16x16x32_bf16 v[116:119], v[124:127], v[68:71], v[116:119]
    v_mfma_f32_16x16x32_bf16 v[120:123], v[124:127], v[72:75], v[120:123]
    s_waitcnt lgkmcnt(7)
    v_mfma_f32_32x32x16_bf16 v[16:31], v[76:79], v[104:107], v[16:31]
    ds_read_b128 v[100:103], v7 offset:28672
    ds_read_b64_tr_b16 v[64:65], v131 offset:28672
    ds_read_b64_tr_b16 v[66:67], v131 offset:29440
    v_mfma_f32_32x32x16_bf16 v[32:47], v[80:83], v[104:107], v[32:47]
    ds_read_b64_tr_b16 v[68:69], v131 offset:28728
    ds_read_b64_tr_b16 v[70:71], v131 offset:29496
    v_mfma_f32_32x32x16_bf16 v[48:63], v[84:87], v[104:107], v[48:63]
    ds_read_b64_tr_b16 v[72:73], v131 offset:28784
    ds_read_b64_tr_b16 v[74:75], v131 offset:29552
    s_barrier
    v_add_u32 v4, 0xe000, v4
    v_add_u32 v5, 0xe000, v5
    v_add_u32 v6, 0xe000, v6
    v_add_u32 v7, 0xe000, v7
    v_add_u32 v128, 0xe000, v128
    v_add_u32 v129, 0xe000, v129
    v_add_u32 v130, 0xe000, v130
    v_add_u32 v131, 0xe000, v131
    s_waitcnt lgkmcnt(7)
    v_mfma_f32_32x32x16_bf16 v[16:31], v[88:91], v[108:111], v[16:31]
    ds_read_b128 v[104:107], v4 offset:0
    ds_read_b64_tr_b16 v[76:77], v128 offset:0
    ds_read_b64_tr_b16 v[78:79], v128 offset:768
    v_mfma_f32_32x32x16_bf16 v[32:47], v[92:95], v[108:111], v[32:47]
    ds_read_b64_tr_b16 v[80:81], v128 offset:56
    ds_read_b64_tr_b16 v[82:83], v128 offset:824
    v_mfma_f32_32x32x16_bf16 v[48:63], v[96:99], v[108:111], v[48:63]
    ds_read_b64_tr_b16 v[84:85], v128 offset:112
    ds_read_b64_tr_b16 v[86:87], v128 offset:880
    s_waitcnt lgkmcnt(7)
    v_mfma_f32_32x32x16_bf16 v[16:31], v[64:67], v[100:103], v[16:31]
    ds_read_b128 v[108:111], v5 offset:0
    ds_read_b64_tr_b16 v[88:89], v129 offset:0
    ds_read_b64_tr_b16 v[90:91], v129 offset:768
    v_mfma_f32_32x32x16_bf16 v[32:47], v[68:71], v[100:103], v[32:47]
    ds_read_b64_tr_b16 v[92:93], v129 offset:56
    ds_read_b64_tr_b16 v[94:95], v129 offset:824
    v_mfma_f32_32x32x16_bf16 v[48:63], v[72:75], v[100:103], v[48:63]
    ds_read_b64_tr_b16 v[96:97], v129 offset:112
    ds_read_b64_tr_b16 v[98:99], v129 offset:880
    s_waitcnt lgkmcnt(7)
    v_mfma_f32_32x32x16_bf16 v[16:31], v[76:79], v[104:107], v[16:31]
    ds_read_b128 v[100:103], v6 offset:0
    ds_read_b64_tr_b16 v[64:65], v130 offset:0
    ds_read_b64_tr_b16 v[66:67], v130 offset:768
    v_mfma_f32_32x32x16_bf16 v[32:47], v[80:83], v[104:107], v[32:47]
    ds_read_b64_tr_b16 v[68:69], v130 offset:56
    ds_read_b64_tr_b16 v[70:71], v130 offset:824
    v_mfma_f32_32x32x16_bf16 v[48:63], v[84:87], v[104:107], v[48:63]
    ds_read_b64_tr_b16 v[72:73], v130 offset:112
    ds_read_b64_tr_b16 v[74:75], v130 offset:880
    v_mfma_f32_16x16x32_bf16 v[112:115], v[124:127], v[76:79], v[112:115]
    v_mfma_f32_16x16x32_bf16 v[116:119], v[124:127], v[80:83], v[116:119]
    v_mfma_f32_16x16x32_bf16 v[120:123], v[124:127], v[84:87], v[120:123]
    s_waitcnt lgkmcnt(7)
    v_mfma_f32_32x32x16_bf16 v[16:31], v[88:91], v[108:111], v[16:31]
    ds_read_b128 v[104:107], v7 offset:0
    ds_read_b64_tr_b16 v[76:77], v131 offset:0
    ds_read_b64_tr_b16 v[78:79], v131 offset:768
    v_mfma_f32_32x32x16_bf16 v[32:47], v[92:95], v[108:111], v[32:47]
    ds_read_b64_tr_b16 v[80:81], v131 offset:56
    ds_read_b64_tr_b16 v[82:83], v131 offset:824
    v_mfma_f32_32x32x16_bf16 v[48:63], v[96:99], v[108:111], v[48:63]
    ds_read_b64_tr_b16 v[84:85], v131 offset:112
    ds_read_b64_tr_b16 v[86:87], v131 offset:880
    s_barrier
    v_add_u32 v4, 0xfffe4000, v4
    v_add_u32 v5, 0xfffe4000, v5
    v_add_u32 v6, 0xfffe4000, v6
    v_add_u32 v7, 0xfffe4000, v7
    v_add_u32 v128, 0xfffe4000, v128
    v_add_u32 v129, 0xfffe4000, v129
    v_add_u32 v130, 0xfffe4000, v130
    v_add_u32 v131, 0xfffe4000, v131
    s_waitcnt lgkmcnt(7)
    v_mfma_f32_32x32x16_bf16 v[16:31], v[64:67], v[100:103], v[16:31]
    ds_read_b128 v[108:111], v4 offset:0
    ds_read_b64_tr_b16 v[88:89], v128 offset:0
    ds_read_b64_tr_b16 v[90:91], v128 offset:768
    v_mfma_f32_32x32x16_bf16 v[32:47], v[68:71], v[100:103], v[32:47]
    ds_read_b64_tr_b16 v[92:93], v128 offset:56
    ds_read_b64_tr_b16 v[94:95], v128 offset:824
    v_mfma_f32_32x32x16_bf16 v[48:63], v[72:75], v[100:103], v[48:63]
    ds_read_b64_tr_b16 v[96:97], v128 offset:112
    ds_read_b64_tr_b16 v[98:99], v128 offset:880
    s_waitcnt lgkmcnt(7)
    v_mfma_f32_32x32x16_bf16 v[16:31], v[76:79], v[104:107], v[16:31]
    ds_read_b128 v[100:103], v5 offset:0
    ds_read_b64_tr_b16 v[64:65], v129 offset:0
    ds_read_b64_tr_b16 v[66:67], v129 offset:768
    v_mfma_f32_32x32x16_bf16 v[32:47], v[80:83], v[104:107], v[32:47]
    ds_read_b64_tr_b16 v[68:69], v129 offset:56
    ds_read_b64_tr_b16 v[70:71], v129 offset:824
    v_mfma_f32_32x32x16_bf16 v[48:63], v[84:87], v[104:107], v[48:63]
    ds_read_b64_tr_b16 v[72:73], v129 offset:112
    ds_read_b64_tr_b16 v[74:75], v129 offset:880
    s_waitcnt lgkmcnt(7)
    v_mfma_f32_32x32x16_bf16 v[16:31], v[88:91], v[108:111], v[16:31]
    ds_read_b128 v[104:107], v6 offset:0
    ds_read_b64_tr_b16 v[76:77], v130 offset:0
    ds_read_b64_tr_b16 v[78:79], v130 offset:768
    v_mfma_f32_32x32x16_bf16 v[32:47], v[92:95], v[108:111], v[32:47]
    ds_read_b64_tr_b16 v[80:81], v130 offset:56
    ds_read_b64_tr_b16 v[82:83], v130 offset:824
    v_mfma_f32_32x32x16_bf16 v[48:63], v[96:99], v[108:111], v[48:63]
    ds_read_b64_tr_b16 v[84:85], v130 offset:112
    ds_read_b64_tr_b16 v[86:87], v130 offset:880
    v_mfma_f32_16x16x32_bf16 v[112:115], v[124:127], v[88:91], v[112:115]
    v_mfma_f32_16x16x32_bf16 v[116:119], v[124:127], v[92:95], v[116:119]
    v_mfma_f32_16x16x32_bf16 v[120:123], v[124:127], v[96:99], v[120:123]
    s_waitcnt lgkmcnt(7)
    v_mfma_f32_32x32x16_bf16 v[16:31], v[64:67], v[100:103], v[16:31]
    ds_read_b128 v[108:111], v7 offset:0
    ds_read_b64_tr_b16 v[88:89], v131 offset:0
    ds_read_b64_tr_b16 v[90:91], v131 offset:768
    v_mfma_f32_32x32x16_bf16 v[32:47], v[68:71], v[100:103], v[32:47]
    ds_read_b64_tr_b16 v[92:93], v131 offset:56
    ds_read_b64_tr_b16 v[94:95], v131 offset:824
    v_mfma_f32_32x32x16_bf16 v[48:63], v[72:75], v[100:103], v[48:63]
    ds_read_b64_tr_b16 v[96:97], v131 offset:112
    ds_read_b64_tr_b16 v[98:99], v131 offset:880
    s_barrier
    s_waitcnt lgkmcnt(7)
    v_mfma_f32_32x32x16_bf16 v[16:31], v[76:79], v[104:107], v[16:31]
    ds_read_b128 v[100:103], v4 offset:28672
    ds_read_b64_tr_b16 v[64:65], v128 offset:28672
    ds_read_b64_tr_b16 v[66:67], v128 offset:29440
    v_mfma_f32_32x32x16_bf16 v[32:47], v[80:83], v[104:107], v[32:47]
    ds_read_b64_tr_b16 v[68:69], v128 offset:28728
    ds_read_b64_tr_b16 v[70:71], v128 offset:29496
    v_mfma_f32_32x32x16_bf16 v[48:63], v[84:87], v[104:107], v[48:63]
    ds_read_b64_tr_b16 v[72:73], v128 offset:28784
    ds_read_b64_tr_b16 v[74:75], v128 offset:29552
    s_waitcnt lgkmcnt(7)
    v_mfma_f32_32x32x16_bf16 v[16:31], v[88:91], v[108:111], v[16:31]
    ds_read_b128 v[104:107], v5 offset:28672
    ds_read_b64_tr_b16 v[76:77], v129 offset:28672
    ds_read_b64_tr_b16 v[78:79], v129 offset:29440
    v_mfma_f32_32x32x16_bf16 v[32:47], v[92:95], v[108:111], v[32:47]
    ds_read_b64_tr_b16 v[80:81], v129 offset:28728
    ds_read_b64_tr_b16 v[82:83], v129 offset:29496
    v_mfma_f32_32x32x16_bf16 v[48:63], v[96:99], v[108:111], v[48:63]
    ds_read_b64_tr_b16 v[84:85], v129 offset:28784
    ds_read_b64_tr_b16 v[86:87], v129 offset:29552
    s_waitcnt lgkmcnt(7)
    v_mfma_f32_32x32x16_bf16 v[16:31], v[64:67], v[100:103], v[16:31]
    ds_read_b128 v[108:111], v6 offset:28672
    ds_read_b64_tr_b16 v[88:89], v130 offset:28672
    ds_read_b64_tr_b16 v[90:91], v130 offset:29440
    v_mfma_f32_32x32x16_bf16 v[32:47], v[68:71], v[100:103], v[32:47]
    ds_read_b64_tr_b16 v[92:93], v130 offset:28728
    ds_read_b64_tr_b16 v[94:95], v130 offset:29496
    v_mfma_f32_32x32x16_bf16 v[48:63], v[72:75], v[100:103], v[48:63]
    ds_read_b64_tr_b16 v[96:97], v130 offset:28784
    ds_read_b64_tr_b16 v[98:99], v130 offset:29552
    v_mfma_f32_16x16x32_bf16 v[112:115], v[124:127], v[64:67], v[112:115]
    v_mfma_f32_16x16x32_bf16 v[116:119], v[124:127], v[68:71], v[116:119]
    v_mfma_f32_16x16x32_bf16 v[120:123], v[124:127], v[72:75], v[120:123]
    s_waitcnt lgkmcnt(7)
    v_mfma_f32_32x32x16_bf16 v[16:31], v[76:79], v[104:107], v[16:31]
    ds_read_b128 v[100:103], v7 offset:28672
    ds_read_b64_tr_b16 v[64:65], v131 offset:28672
    ds_read_b64_tr_b16 v[66:67], v131 offset:29440
    v_mfma_f32_32x32x16_bf16 v[32:47], v[80:83], v[104:107], v[32:47]
    ds_read_b64_tr_b16 v[68:69], v131 offset:28728
    ds_read_b64_tr_b16 v[70:71], v131 offset:29496
    v_mfma_f32_32x32x16_bf16 v[48:63], v[84:87], v[104:107], v[48:63]
    ds_read_b64_tr_b16 v[72:73], v131 offset:28784
    ds_read_b64_tr_b16 v[74:75], v131 offset:29552
    s_mov_b64 exec, 0xffff
    ds_write_b32 v132, v112 offset:0
    ds_write_b32 v132, v113 offset:64
    ds_write_b32 v132, v116 offset:128
    ds_write_b32 v132, v117 offset:192
    ds_write_b32 v132, v120 offset:256
    ds_write_b32 v132, v121 offset:320
    s_mov_b64 exec, -1
    s_waitcnt lgkmcnt(13)
    v_mfma_f32_32x32x16_bf16 v[16:31], v[88:91], v[108:111], v[16:31]
    v_mfma_f32_32x32x16_bf16 v[32:47], v[92:95], v[108:111], v[32:47]
    v_mfma_f32_32x32x16_bf16 v[48:63], v[96:99], v[108:111], v[48:63]
    s_waitcnt lgkmcnt(0)
    s_barrier
    v_mfma_f32_32x32x16_bf16 v[16:31], v[64:67], v[100:103], v[16:31]
    v_mfma_f32_32x32x16_bf16 v[32:47], v[68:71], v[100:103], v[32:47]
    v_mfma_f32_32x32x16_bf16 v[48:63], v[72:75], v[100:103], v[48:63]
    s_cmp_lt_u32 s53, 5
    s_cbranch_scc1 L_p1_eQQQ
    s_cmp_eq_u32 s53, 5
    s_cbranch_scc1 L_p1_eQKK
L_p1_eKKK:
    s_barrier
    ds_read_b32 v10, v133
    ds_read_b32 v11, v133 offset:128
    ds_read_b128 v[140:143], v135 offset:0
    ds_read_b128 v[144:147], v135 offset:32
    ds_read_b128 v[148:151], v135 offset:64
    ds_read_b128 v[152:155], v135 offset:96
    ds_read_b128 v[156:159], v135 offset:128
    ds_read_b128 v[160:163], v135 offset:160
    ds_read_b128 v[164:167], v135 offset:192
    ds_read_b128 v[168:171], v135 offset:224
    ds_read_b128 v[172:175], v135 offset:256
    ds_read_b128 v[176:179], v135 offset:288
    ds_read_b128 v[180:183], v135 offset:320
    ds_read_b128 v[184:187], v135 offset:352
    s_waitcnt lgkmcnt(12)
    v_mov_b32 v196, v11
    v_mul_f32_e64 v198, -v10, v196
    v_mov_b32 v197, v196
    v_mov_b32 v199, v198
    v_pk_mul_f32 v[16:17], v[16:17], v[196:197]
    v_pk_mul_f32 v[18:19], v[18:19], v[196:197]
    v_pk_mul_f32 v[20:21], v[20:21], v[196:197]
    v_pk_mul_f32 v[22:23], v[22:23], v[196:197]
    v_pk_mul_f32 v[24:25], v[24:25], v[196:197]
    v_pk_mul_f32 v[26:27], v[26:27], v[196:197]
    v_pk_mul_f32 v[28:29], v[28:29], v[196:197]
    v_pk_mul_f32 v[30:31], v[30:31], v[196:197]
    s_waitcnt lgkmcnt(8)
    v_pk_fma_f32 v[16:17], v[140:141], v[198:199], v[16:17]
    v_pk_fma_f32 v[18:19], v[142:143], v[198:199], v[18:19]
    v_pk_fma_f32 v[20:21], v[144:145], v[198:199], v[20:21]
    v_pk_fma_f32 v[22:23], v[146:147], v[198:199], v[22:23]
    v_pk_fma_f32 v[24:25], v[148:149], v[198:199], v[24:25]
    v_pk_fma_f32 v[26:27], v[150:151], v[198:199], v[26:27]
    v_pk_fma_f32 v[28:29], v[152:153], v[198:199], v[28:29]
    v_pk_fma_f32 v[30:31], v[154:155], v[198:199], v[30:31]
    v_cvt_pk_bf16_f32 v204, v16, v17
    v_cvt_pk_bf16_f32 v205, v18, v19
    v_cvt_pk_bf16_f32 v206, v20, v21
    v_cvt_pk_bf16_f32 v207, v22, v23
    buffer_store_dwordx4 v[204:207], v2, s[20:23], s57 offen offset:0 sc1
    v_cvt_pk_bf16_f32 v208, v24, v25
    v_cvt_pk_bf16_f32 v209, v26, v27
    v_cvt_pk_bf16_f32 v210, v28, v29
    v_cvt_pk_bf16_f32 v211, v30, v31
    v_and_b32 v211, v211, v228
    v_and_or_b32 v210, v210, v228, v229
    buffer_store_dwordx4 v[208:211], v2, s[20:23], s57 offen offset:1024 sc1
    v_pk_mul_f32 v[32:33], v[32:33], v[196:197]
    v_dot2_f32_bf16 v234, v204, v204, 0
    v_pk_mul_f32 v[34:35], v[34:35], v[196:197]
    v_dot2_f32_bf16 v235, v205, v205, 0
    v_pk_mul_f32 v[36:37], v[36:37], v[196:197]
    v_dot2_f32_bf16 v234, v206, v206, v234
    v_pk_mul_f32 v[38:39], v[38:39], v[196:197]
    v_dot2_f32_bf16 v235, v207, v207, v235
    v_pk_mul_f32 v[40:41], v[40:41], v[196:197]
    v_dot2_f32_bf16 v234, v208, v208, v234
    v_pk_mul_f32 v[42:43], v[42:43], v[196:197]
    v_dot2_f32_bf16 v235, v209, v209, v235
    v_pk_mul_f32 v[44:45], v[44:45], v[196:197]
    v_dot2_f32_bf16 v234, v210, v210, v234
    v_pk_mul_f32 v[46:47], v[46:47], v[196:197]
    v_dot2_f32_bf16 v235, v211, v211, v235
    s_waitcnt lgkmcnt(0)
    v_pk_fma_f32 v[32:33], v[156:157], v[198:199], v[32:33]
    v_pk_fma_f32 v[34:35], v[158:159], v[198:199], v[34:35]
    v_add_f32 v234, v234, v235
    v_pk_fma_f32 v[36:37], v[160:161], v[198:199], v[36:37]
    v_mov_b32 v235, v234
    v_pk_fma_f32 v[38:39], v[162:163], v[198:199], v[38:39]
    v_pk_fma_f32 v[40:41], v[164:165], v[198:199], v[40:41]
    v_permlane32_swap_b32 v234, v235
    v_pk_fma_f32 v[42:43], v[166:167], v[198:199], v[42:43]
    v_add_f32 v234, v234, v235
    v_pk_fma_f32 v[44:45], v[168:169], v[198:199], v[44:45]
    ds_max_u32 v14, v234 offset:0
    v_pk_fma_f32 v[46:47], v[170:171], v[198:199], v[46:47]
    v_cvt_pk_bf16_f32 v212, v32, v33
    v_cvt_pk_bf16_f32 v213, v34, v35
    v_cvt_pk_bf16_f32 v214, v36, v37
    v_cvt_pk_bf16_f32 v215, v38, v39
    buffer_store_dwordx4 v[212:215], v2, s[20:23], s58 offen offset:0 sc1
    v_cvt_pk_bf16_f32 v216, v40, v41
    v_cvt_pk_bf16_f32 v217, v42, v43
    v_cvt_pk_bf16_f32 v218, v44, v45
    v_cvt_pk_bf16_f32 v219, v46, v47
    v_and_b32 v219, v219, v228
    v_and_or_b32 v218, v218, v228, v229
    buffer_store_dwordx4 v[216:219], v2, s[20:23], s58 offen offset:1024 sc1
    v_pk_mul_f32 v[48:49], v[48:49], v[196:197]
    v_dot2_f32_bf16 v236, v212, v212, 0
    v_pk_mul_f32 v[50:51], v[50:51], v[196:197]
    v_dot2_f32_bf16 v237, v213, v213, 0
    v_pk_mul_f32 v[52:53], v[52:53], v[196:197]
    v_dot2_f32_bf16 v236, v214, v214, v236
    v_pk_mul_f32 v[54:55], v[54:55], v[196:197]
    v_dot2_f32_bf16 v237, v215, v215, v237
    v_pk_mul_f32 v[56:57], v[56:57], v[196:197]
    v_dot2_f32_bf16 v236, v216, v216, v236
    v_pk_mul_f32 v[58:59], v[58:59], v[196:197]
    v_dot2_f32_bf16 v237, v217, v217, v237
    v_pk_mul_f32 v[60:61], v[60:61], v[196:197]
    v_dot2_f32_bf16 v236, v218, v218, v236
    v_pk_mul_f32 v[62:63], v[62:63], v[196:197]
    v_dot2_f32_bf16 v237, v219, v219, v237
    v_pk_fma_f32 v[48:49], v[172:173], v[198:199], v[48:49]
    v_pk_fma_f32 v[50:51], v[174:175], v[198:199], v[50:51]
    s_nop 0
    v_add_f32 v236, v236, v237
    v_pk_fma_f32 v[52:53], v[176:177], v[198:199], v[52:53]
    v_mov_b32 v237, v236
    v_pk_fma_f32 v[54:55], v[178:179], v[198:199], v[54:55]
    v_pk_fma_f32 v[56:57], v[180:181], v[198:199], v[56:57]
    v_permlane32_swap_b32 v236, v237
    v_pk_fma_f32 v[58:59], v[182:183], v[198:199], v[58:59]
    v_add_f32 v236, v236, v237
    v_pk_fma_f32 v[60:61], v[184:185], v[198:199], v[60:61]
    ds_max_u32 v14, v236 offset:4
    v_pk_fma_f32 v[62:63], v[186:187], v[198:199], v[62:63]
    v_cvt_pk_bf16_f32 v220, v48, v49
    v_cvt_pk_bf16_f32 v221, v50, v51
    v_cvt_pk_bf16_f32 v222, v52, v53
    v_cvt_pk_bf16_f32 v223, v54, v55
    buffer_store_dwordx4 v[220:223], v2, s[20:23], s59 offen offset:0 sc1
    v_cvt_pk_bf16_f32 v224, v56, v57
    v_cvt_pk_bf16_f32 v225, v58, v59
    v_cvt_pk_bf16_f32 v226, v60, v61
    v_cvt_pk_bf16_f32 v227, v62, v63
    v_and_b32 v227, v227, v228
    v_and_or_b32 v226, v226, v228, v229
    buffer_store_dwordx4 v[224:227], v2, s[20:23], s59 offen offset:1024 sc1
    v_dot2_f32_bf16 v238, v220, v220, 0
    v_dot2_f32_bf16 v239, v221, v221, 0
    v_dot2_f32_bf16 v238, v222, v222, v238
    v_dot2_f32_bf16 v239, v223, v223, v239
    v_dot2_f32_bf16 v238, v224, v224, v238
    v_dot2_f32_bf16 v239, v225, v225, v239
    v_dot2_f32_bf16 v238, v226, v226, v238
    v_dot2_f32_bf16 v239, v227, v227, v239
    s_nop 2
    v_add_f32 v238, v238, v239
    v_mov_b32 v239, v238
    s_nop 1
    v_permlane32_swap_b32 v238, v239
    v_add_f32 v238, v238, v239
    ds_max_u32 v14, v238 offset:8
    s_branch L_p1_done
L_p1_eQQQ:
    s_barrier
    ds_read_b32 v10, v133
    ds_read_b32 v11, v133 offset:128
    ds_read_b128 v[140:143], v135 offset:0
    ds_read_b128 v[144:147], v135 offset:32
    ds_read_b128 v[148:151], v135 offset:64
    ds_read_b128 v[152:155], v135 offset:96
    ds_read_b128 v[156:159], v135 offset:128
    ds_read_b128 v[160:163], v135 offset:160
    ds_read_b128 v[164:167], v135 offset:192
    ds_read_b128 v[168:171], v135 offset:224
    ds_read_b128 v[172:175], v135 offset:256
    ds_read_b128 v[176:179], v135 offset:288
    ds_read_b128 v[180:183], v135 offset:320
    ds_read_b128 v[184:187], v135 offset:352
    s_waitcnt lgkmcnt(12)
    v_mul_f32 v188, 0x3e8b97f6, v11
    v_mul_f32_e64 v190, -v10, v188
    v_mov_b32 v189, v188
    v_mov_b32 v191, v190
    v_pk_mul_f32 v[16:17], v[16:17], v[188:189]
    v_pk_mul_f32 v[18:19], v[18:19], v[188:189]
    v_pk_mul_f32 v[20:21], v[20:21], v[188:189]
    v_pk_mul_f32 v[22:23], v[22:23], v[188:189]
    v_pk_mul_f32 v[24:25], v[24:25], v[188:189]
    v_pk_mul_f32 v[26:27], v[26:27], v[188:189]
    v_pk_mul_f32 v[28:29], v[28:29], v[188:189]
    v_pk_mul_f32 v[30:31], v[30:31], v[188:189]
    s_waitcnt lgkmcnt(8)
    v_pk_fma_f32 v[16:17], v[140:141], v[190:191], v[16:17]
    v_pk_fma_f32 v[18:19], v[142:143], v[190:191], v[18:19]
    v_pk_fma_f32 v[20:21], v[144:145], v[190:191], v[20:21]
    v_pk_fma_f32 v[22:23], v[146:147], v[190:191], v[22:23]
    v_pk_fma_f32 v[24:25], v[148:149], v[190:191], v[24:25]
    v_pk_fma_f32 v[26:27], v[150:151], v[190:191], v[26:27]
    v_pk_fma_f32 v[28:29], v[152:153], v[190:191], v[28:29]
    v_pk_fma_f32 v[30:31], v[154:155], v[190:191], v[30:31]
    v_cvt_pk_bf16_f32 v204, v16, v17
    v_cvt_pk_bf16_f32 v205, v18, v19
    v_cvt_pk_bf16_f32 v206, v20, v21
    v_cvt_pk_bf16_f32 v207, v22, v23
    buffer_store_dwordx4 v[204:207], v2, s[20:23], s57 offen offset:0 sc1
    v_cvt_pk_bf16_f32 v208, v24, v25
    v_cvt_pk_bf16_f32 v209, v26, v27
    v_cvt_pk_bf16_f32 v210, v28, v29
    v_cvt_pk_bf16_f32 v211, v30, v31
    v_and_b32 v211, v211, v228
    v_and_b32 v210, v210, v228
    v_pk_mul_f32 v[32:33], v[32:33], v[188:189]
    v_dot2_f32_bf16 v234, v204, v204, 0
    v_pk_mul_f32 v[34:35], v[34:35], v[188:189]
    v_dot2_f32_bf16 v235, v205, v205, 0
    v_pk_mul_f32 v[36:37], v[36:37], v[188:189]
    v_dot2_f32_bf16 v234, v206, v206, v234
    v_pk_mul_f32 v[38:39], v[38:39], v[188:189]
    v_dot2_f32_bf16 v235, v207, v207, v235
    v_pk_mul_f32 v[40:41], v[40:41], v[188:189]
    v_dot2_f32_bf16 v234, v208, v208, v234
    v_pk_mul_f32 v[42:43], v[42:43], v[188:189]
    v_dot2_f32_bf16 v235, v209, v209, v235
    v_pk_mul_f32 v[44:45], v[44:45], v[188:189]
    v_dot2_f32_bf16 v234, v210, v210, v234
    v_pk_mul_f32 v[46:47], v[46:47], v[188:189]
    v_dot2_f32_bf16 v235, v211, v211, v235
    s_waitcnt lgkmcnt(0)
    v_pk_fma_f32 v[32:33], v[156:157], v[190:191], v[32:33]
    v_pk_fma_f32 v[34:35], v[158:159], v[190:191], v[34:35]
    v_add_f32 v234, v234, v235
    v_pk_fma_f32 v[36:37], v[160:161], v[190:191], v[36:37]
    v_mov_b32 v235, v234
    v_pk_fma_f32 v[38:39], v[162:163], v[190:191], v[38:39]
    v_pk_fma_f32 v[40:41], v[164:165], v[190:191], v[40:41]
    v_permlane32_swap_b32 v234, v235
    v_pk_fma_f32 v[42:43], v[166:167], v[190:191], v[42:43]
    v_add_f32 v234, v234, v235
    v_pk_fma_f32 v[44:45], v[168:169], v[190:191], v[44:45]
    v_sqrt_f32 v234, v234
    v_pk_fma_f32 v[46:47], v[170:171], v[190:191], v[46:47]
    v_mul_f32 v234, 0x3f810000, v234
    v_cvt_pk_bf16_f32 v212, v32, v33
    v_add_u32 v234, 0xffff, v234
    v_cvt_pk_bf16_f32 v213, v34, v35
    v_lshrrev_b32 v234, 16, v234
    v_cvt_pk_bf16_f32 v214, v36, v37
    v_and_or_b32 v210, v234, v230, v210
    v_cvt_pk_bf16_f32 v215, v38, v39
    buffer_store_dwordx4 v[208:211], v2, s[20:23], s57 offen offset:1024 sc1
    buffer_store_dwordx4 v[212:215], v2, s[20:23], s58 offen offset:0 sc1
    v_cvt_pk_bf16_f32 v216, v40, v41
    v_cvt_pk_bf16_f32 v217, v42, v43
    v_cvt_pk_bf16_f32 v218, v44, v45
    v_cvt_pk_bf16_f32 v219, v46, v47
    v_and_b32 v219, v219, v228
    v_and_b32 v218, v218, v228
    v_pk_mul_f32 v[48:49], v[48:49], v[188:189]
    v_dot2_f32_bf16 v236, v212, v212, 0
    v_pk_mul_f32 v[50:51], v[50:51], v[188:189]
    v_dot2_f32_bf16 v237, v213, v213, 0
    v_pk_mul_f32 v[52:53], v[52:53], v[188:189]
    v_dot2_f32_bf16 v236, v214, v214, v236
    v_pk_mul_f32 v[54:55], v[54:55], v[188:189]
    v_dot2_f32_bf16 v237, v215, v215, v237
    v_pk_mul_f32 v[56:57], v[56:57], v[188:189]
    v_dot2_f32_bf16 v236, v216, v216, v236
    v_pk_mul_f32 v[58:59], v[58:59], v[188:189]
    v_dot2_f32_bf16 v237, v217, v217, v237
    v_pk_mul_f32 v[60:61], v[60:61], v[188:189]
    v_dot2_f32_bf16 v236, v218, v218, v236
    v_pk_mul_f32 v[62:63], v[62:63], v[188:189]
    v_dot2_f32_bf16 v237, v219, v219, v237
    v_pk_fma_f32 v[48:49], v[172:173], v[190:191], v[48:49]
    v_pk_fma_f32 v[50:51], v[174:175], v[190:191], v[50:51]
    s_nop 0
    v_add_f32 v236, v236, v237
    v_pk_fma_f32 v[52:53], v[176:177], v[190:191], v[52:53]
    v_mov_b32 v237, v236
    v_pk_fma_f32 v[54:55], v[178:179], v[190:191], v[54:55]
    v_pk_fma_f32 v[56:57], v[180:181], v[190:191], v[56:57]
    v_permlane32_swap_b32 v236, v237
    v_pk_fma_f32 v[58:59], v[182:183], v[190:191], v[58:59]
    v_add_f32 v236, v236, v237
    v_pk_fma_f32 v[60:61], v[184:185], v[190:191], v[60:61]
    v_sqrt_f32 v236, v236
    v_pk_fma_f32 v[62:63], v[186:187], v[190:191], v[62:63]
    v_mul_f32 v236, 0x3f810000, v236
    v_cvt_pk_bf16_f32 v220, v48, v49
    v_add_u32 v236, 0xffff, v236
    v_cvt_pk_bf16_f32 v221, v50, v51
    v_lshrrev_b32 v236, 16, v236
    v_cvt_pk_bf16_f32 v222, v52, v53
    v_and_or_b32 v218, v236, v230, v218
    v_cvt_pk_bf16_f32 v223, v54, v55
    buffer_store_dwordx4 v[216:219], v2, s[20:23], s58 offen offset:1024 sc1
    buffer_store_dwordx4 v[220:223], v2, s[20:23], s59 offen offset:0 sc1
    v_cvt_pk_bf16_f32 v224, v56, v57
    v_cvt_pk_bf16_f32 v225, v58, v59
    v_cvt_pk_bf16_f32 v226, v60, v61
    v_cvt_pk_bf16_f32 v227, v62, v63
    v_and_b32 v227, v227, v228
    v_and_b32 v226, v226, v228
    v_dot2_f32_bf16 v238, v220, v220, 0
    v_dot2_f32_bf16 v239, v221, v221, 0
    v_dot2_f32_bf16 v238, v222, v222, v238
    v_dot2_f32_bf16 v239, v223, v223, v239
    v_dot2_f32_bf16 v238, v224, v224, v238
    v_dot2_f32_bf16 v239, v225, v225, v239
    v_dot2_f32_bf16 v238, v226, v226, v238
    v_dot2_f32_bf16 v239, v227, v227, v239
    s_nop 2
    v_add_f32 v238, v238, v239
    v_mov_b32 v239, v238
    s_nop 1
    v_permlane32_swap_b32 v238, v239
    v_add_f32 v238, v238, v239
    v_sqrt_f32 v238, v238
    s_nop 0
    v_mul_f32 v238, 0x3f810000, v238
    v_add_u32 v238, 0xffff, v238
    v_lshrrev_b32 v238, 16, v238
    v_and_or_b32 v226, v238, v230, v226
    buffer_store_dwordx4 v[224:227], v2, s[20:23], s59 offen offset:1024 sc1
    s_branch L_p1_done
L_p1_eQKK:
    s_barrier
    ds_read_b32 v10, v133
    ds_read_b32 v11, v133 offset:128
    ds_read_b128 v[140:143], v135 offset:0
    ds_read_b128 v[144:147], v135 offset:32
    ds_read_b128 v[148:151], v135 offset:64
    ds_read_b128 v[152:155], v135 offset:96
    ds_read_b128 v[156:159], v135 offset:128
    ds_read_b128 v[160:163], v135 offset:160
    ds_read_b128 v[164:167], v135 offset:192
    ds_read_b128 v[168:171], v135 offset:224
    ds_read_b128 v[172:175], v135 offset:256
    ds_read_b128 v[176:179], v135 offset:288
    ds_read_b128 v[180:183], v135 offset:320
    ds_read_b128 v[184:187], v135 offset:352
    s_waitcnt lgkmcnt(12)
    v_mov_b32 v196, v11
    v_mul_f32_e64 v198, -v10, v196
    v_mov_b32 v197, v196
    v_mov_b32 v199, v198
    v_mul_f32 v188, 0x3e8b97f6, v11
    v_mul_f32_e64 v190, -v10, v188
    v_mov_b32 v189, v188
    v_mov_b32 v191, v190
    v_pk_mul_f32 v[16:17], v[16:17], v[188:189]
    v_pk_mul_f32 v[18:19], v[18:19], v[188:189]
    v_pk_mul_f32 v[20:21], v[20:21], v[188:189]
    v_pk_mul_f32 v[22:23], v[22:23], v[188:189]
    v_pk_mul_f32 v[24:25], v[24:25], v[188:189]
    v_pk_mul_f32 v[26:27], v[26:27], v[188:189]
    v_pk_mul_f32 v[28:29], v[28:29], v[188:189]
    v_pk_mul_f32 v[30:31], v[30:31], v[188:189]
    s_waitcnt lgkmcnt(8)
    v_pk_fma_f32 v[16:17], v[140:141], v[190:191], v[16:17]
    v_pk_fma_f32 v[18:19], v[142:143], v[190:191], v[18:19]
    v_pk_fma_f32 v[20:21], v[144:145], v[190:191], v[20:21]
    v_pk_fma_f32 v[22:23], v[146:147], v[190:191], v[22:23]
    v_pk_fma_f32 v[24:25], v[148:149], v[190:191], v[24:25]
    v_pk_fma_f32 v[26:27], v[150:151], v[190:191], v[26:27]
    v_pk_fma_f32 v[28:29], v[152:153], v[190:191], v[28:29]
    v_pk_fma_f32 v[30:31], v[154:155], v[190:191], v[30:31]
    v_cvt_pk_bf16_f32 v204, v16, v17
    v_cvt_pk_bf16_f32 v205, v18, v19
    v_cvt_pk_bf16_f32 v206, v20, v21
    v_cvt_pk_bf16_f32 v207, v22, v23
    buffer_store_dwordx4 v[204:207], v2, s[20:23], s57 offen offset:0 sc1
    v_cvt_pk_bf16_f32 v208, v24, v25
    v_cvt_pk_bf16_f32 v209, v26, v27
    v_cvt_pk_bf16_f32 v210, v28, v29
    v_cvt_pk_bf16_f32 v211, v30, v31
    v_and_b32 v211, v211, v228
    v_and_b32 v210, v210, v228
    v_pk_mul_f32 v[32:33], v[32:33], v[196:197]
    v_dot2_f32_bf16 v234, v204, v204, 0
    v_pk_mul_f32 v[34:35], v[34:35], v[196:197]
    v_dot2_f32_bf16 v235, v205, v205, 0
    v_pk_mul_f32 v[36:37], v[36:37], v[196:197]
    v_dot2_f32_bf16 v234, v206, v206, v234
    v_pk_mul_f32 v[38:39], v[38:39], v[196:197]
    v_dot2_f32_bf16 v235, v207, v207, v235
    v_pk_mul_f32 v[40:41], v[40:41], v[196:197]
    v_dot2_f32_bf16 v234, v208, v208, v234
    v_pk_mul_f32 v[42:43], v[42:43], v[196:197]
    v_dot2_f32_bf16 v235, v209, v209, v235
    v_pk_mul_f32 v[44:45], v[44:45], v[196:197]
    v_dot2_f32_bf16 v234, v210, v210, v234
    v_pk_mul_f32 v[46:47], v[46:47], v[196:197]
    v_dot2_f32_bf16 v235, v211, v211, v235
    s_waitcnt lgkmcnt(0)
    v_pk_fma_f32 v[32:33], v[156:157], v[198:199], v[32:33]
    v_pk_fma_f32 v[34:35], v[158:159], v[198:199], v[34:35]
    v_add_f32 v234, v234, v235
    v_pk_fma_f32 v[36:37], v[160:161], v[198:199], v[36:37]
    v_mov_b32 v235, v234
    v_pk_fma_f32 v[38:39], v[162:163], v[198:199], v[38:39]
    v_pk_fma_f32 v[40:41], v[164:165], v[198:199], v[40:41]
    v_permlane32_swap_b32 v234, v235
    v_pk_fma_f32 v[42:43], v[166:167], v[198:199], v[42:43]
    v_add_f32 v234, v234, v235
    v_pk_fma_f32 v[44:45], v[168:169], v[198:199], v[44:45]
    v_sqrt_f32 v234, v234
    v_pk_fma_f32 v[46:47], v[170:171], v[198:199], v[46:47]
    v_mul_f32 v234, 0x3f810000, v234
    v_cvt_pk_bf16_f32 v212, v32, v33
    v_add_u32 v234, 0xffff, v234
    v_cvt_pk_bf16_f32 v213, v34, v35
    v_lshrrev_b32 v234, 16, v234
    v_cvt_pk_bf16_f32 v214, v36, v37
    v_and_or_b32 v210, v234, v230, v210
    v_cvt_pk_bf16_f32 v215, v38, v39
    buffer_store_dwordx4 v[208:211], v2, s[20:23], s57 offen offset:1024 sc1
    buffer_store_dwordx4 v[212:215], v2, s[20:23], s58 offen offset:0 sc1
    v_cvt_pk_bf16_f32 v216, v40, v41
    v_cvt_pk_bf16_f32 v217, v42, v43
    v_cvt_pk_bf16_f32 v218, v44, v45
    v_cvt_pk_bf16_f32 v219, v46, v47
    v_and_b32 v219, v219, v228
    v_and_or_b32 v218, v218, v228, v229
    buffer_store_dwordx4 v[216:219], v2, s[20:23], s58 offen offset:1024 sc1
    v_pk_mul_f32 v[48:49], v[48:49], v[196:197]
    v_dot2_f32_bf16 v236, v212, v212, 0
    v_pk_mul_f32 v[50:51], v[50:51], v[196:197]
    v_dot2_f32_bf16 v237, v213, v213, 0
    v_pk_mul_f32 v[52:53], v[52:53], v[196:197]
    v_dot2_f32_bf16 v236, v214, v214, v236
    v_pk_mul_f32 v[54:55], v[54:55], v[196:197]
    v_dot2_f32_bf16 v237, v215, v215, v237
    v_pk_mul_f32 v[56:57], v[56:57], v[196:197]
    v_dot2_f32_bf16 v236, v216, v216, v236
    v_pk_mul_f32 v[58:59], v[58:59], v[196:197]
    v_dot2_f32_bf16 v237, v217, v217, v237
    v_pk_mul_f32 v[60:61], v[60:61], v[196:197]
    v_dot2_f32_bf16 v236, v218, v218, v236
    v_pk_mul_f32 v[62:63], v[62:63], v[196:197]
    v_dot2_f32_bf16 v237, v219, v219, v237
    v_pk_fma_f32 v[48:49], v[172:173], v[198:199], v[48:49]
    v_pk_fma_f32 v[50:51], v[174:175], v[198:199], v[50:51]
    s_nop 0
    v_add_f32 v236, v236, v237
    v_pk_fma_f32 v[52:53], v[176:177], v[198:199], v[52:53]
    v_mov_b32 v237, v236
    v_pk_fma_f32 v[54:55], v[178:179], v[198:199], v[54:55]
    v_pk_fma_f32 v[56:57], v[180:181], v[198:199], v[56:57]
    v_permlane32_swap_b32 v236, v237
    v_pk_fma_f32 v[58:59], v[182:183], v[198:199], v[58:59]
    v_add_f32 v236, v236, v237
    v_pk_fma_f32 v[60:61], v[184:185], v[198:199], v[60:61]
    ds_max_u32 v14, v236 offset:4
    v_pk_fma_f32 v[62:63], v[186:187], v[198:199], v[62:63]
    v_cvt_pk_bf16_f32 v220, v48, v49
    v_cvt_pk_bf16_f32 v221, v50, v51
    v_cvt_pk_bf16_f32 v222, v52, v53
    v_cvt_pk_bf16_f32 v223, v54, v55
    buffer_store_dwordx4 v[220:223], v2, s[20:23], s59 offen offset:0 sc1
    v_cvt_pk_bf16_f32 v224, v56, v57
    v_cvt_pk_bf16_f32 v225, v58, v59
    v_cvt_pk_bf16_f32 v226, v60, v61
    v_cvt_pk_bf16_f32 v227, v62, v63
    v_and_b32 v227, v227, v228
    v_and_or_b32 v226, v226, v228, v229
    buffer_store_dwordx4 v[224:227], v2, s[20:23], s59 offen offset:1024 sc1
    v_dot2_f32_bf16 v238, v220, v220, 0
    v_dot2_f32_bf16 v239, v221, v221, 0
    v_dot2_f32_bf16 v238, v222, v222, v238
    v_dot2_f32_bf16 v239, v223, v223, v239
    v_dot2_f32_bf16 v238, v224, v224, v238
    v_dot2_f32_bf16 v239, v225, v225, v239
    v_dot2_f32_bf16 v238, v226, v226, v238
    v_dot2_f32_bf16 v239, v227, v227, v239
    s_nop 2
    v_add_f32 v238, v238, v239
    v_mov_b32 v239, v238
    s_nop 1
    v_permlane32_swap_b32 v238, v239
    v_add_f32 v238, v238, v239
    ds_max_u32 v14, v238 offset:8
    s_branch L_p1_done
L_p1_v1:
    s_barrier
    ds_read_b128 v[100:103], v4 offset:0
    ds_read_b64_tr_b16 v[64:65], v128 offset:0
    ds_read_b64_tr_b16 v[66:67], v128 offset:768
    ds_read_b64_tr_b16 v[68:69], v128 offset:56
    ds_read_b64_tr_b16 v[70:71], v128 offset:824
    ds_read_b64_tr_b16 v[72:73], v128 offset:112
    ds_read_b64_tr_b16 v[74:75], v128 offset:880
    ds_read_b128 v[104:107], v5 offset:0
    ds_read_b64_tr_b16 v[76:77], v129 offset:0
    ds_read_b64_tr_b16 v[78:79], v129 offset:768
    ds_read_b64_tr_b16 v[80:81], v129 offset:56
    ds_read_b64_tr_b16 v[82:83], v129 offset:824
    ds_read_b64_tr_b16 v[84:85], v129 offset:112
    ds_read_b64_tr_b16 v[86:87], v129 offset:880
    s_waitcnt lgkmcnt(7)
    v_mfma_f32_32x32x16_bf16 v[16:31], v[64:67], v[100:103], 0
    ds_read_b128 v[108:111], v6 offset:0
    ds_read_b64_tr_b16 v[88:89], v130 offset:0
    ds_read_b64_tr_b16 v[90:91], v130 offset:768
    v_mfma_f32_32x32x16_bf16 v[32:47], v[68:71], v[100:103], 0
    ds_read_b64_tr_b16 v[92:93], v130 offset:56
    ds_read_b64_tr_b16 v[94:95], v130 offset:824
    v_mfma_f32_32x32x16_bf16 v[48:63], v[100:103], v[72:75], 0
    ds_read_b64_tr_b16 v[96:97], v130 offset:112
    ds_read_b64_tr_b16 v[98:99], v130 offset:880
    v_mfma_f32_16x16x32_bf16 v[112:115], v[124:127], v[64:67], 0
    v_mfma_f32_16x16x32_bf16 v[116:119], v[124:127], v[68:71], 0
    v_mfma_f32_16x16x32_bf16 v[120:123], v[124:127], v[72:75], 0
    s_waitcnt lgkmcnt(7)
    v_mfma_f32_32x32x16_bf16 v[16:31], v[76:79], v[104:107], v[16:31]
    ds_read_b128 v[100:103], v7 offset:0
    ds_read_b64_tr_b16 v[64:65], v131 offset:0
    ds_read_b64_tr_b16 v[66:67], v131 offset:768
    v_mfma_f32_32x32x16_bf16 v[32:47], v[80:83], v[104:107], v[32:47]
    ds_read_b64_tr_b16 v[68:69], v131 offset:56
    ds_read_b64_tr_b16 v[70:71], v131 offset:824
    v_mfma_f32_32x32x16_bf16 v[48:63], v[104:107], v[84:87], v[48:63]
    ds_read_b64_tr_b16 v[72:73], v131 offset:112
    ds_read_b64_tr_b16 v[74:75], v131 offset:880
    s_waitcnt vmcnt(0)
    s_barrier
    s_waitcnt lgkmcnt(7)
    v_mfma_f32_32x32x16_bf16 v[16:31], v[88:91], v[108:111], v[16:31]
    ds_read_b128 v[104:107], v4 offset:28672
    ds_read_b64_tr_b16 v[76:77], v128 offset:28672
    ds_read_b64_tr_b16 v[78:79], v128 offset:29440
    v_mfma_f32_32x32x16_bf16 v[32:47], v[92:95], v[108:111], v[32:47]
    ds_read_b64_tr_b16 v[80:81], v128 offset:28728
    ds_read_b64_tr_b16 v[82:83], v128 offset:29496
    v_mfma_f32_32x32x16_bf16 v[48:63], v[108:111], v[96:99], v[48:63]
    ds_read_b64_tr_b16 v[84:85], v128 offset:28784
    ds_read_b64_tr_b16 v[86:87], v128 offset:29552
    s_waitcnt lgkmcnt(7)
    v_mfma_f32_32x32x16_bf16 v[16:31], v[64:67], v[100:103], v[16:31]
    ds_read_b128 v[108:111], v5 offset:28672
    ds_read_b64_tr_b16 v[88:89], v129 offset:28672
    ds_read_b64_tr_b16 v[90:91], v129 offset:29440
    v_mfma_f32_32x32x16_bf16 v[32:47], v[68:71], v[100:103], v[32:47]
    ds_read_b64_tr_b16 v[92:93], v129 offset:28728
    ds_read_b64_tr_b16 v[94:95], v129 offset:29496
    v_mfma_f32_32x32x16_bf16 v[48:63], v[100:103], v[72:75], v[48:63]
    ds_read_b64_tr_b16 v[96:97], v129 offset:28784
    ds_read_b64_tr_b16 v[98:99], v129 offset:29552
    s_waitcnt lgkmcnt(7)
    v_mfma_f32_32x32x16_bf16 v[16:31], v[76:79], v[104:107], v[16:31]
    ds_read_b128 v[100:103], v6 offset:28672
    ds_read_b64_tr_b16 v[64:65], v130 offset:28672
    ds_read_b64_tr_b16 v[66:67], v130 offset:29440
    v_mfma_f32_32x32x16_bf16 v[32:47], v[80:83], v[104:107], v[32:47]
    ds_read_b64_tr_b16 v[68:69], v130 offset:28728
    ds_read_b64_tr_b16 v[70:71], v130 offset:29496
    v_mfma_f32_32x32x16_bf16 v[48:63], v[104:107], v[84:87], v[48:63]
    ds_read_b64_tr_b16 v[72:73], v130 offset:28784
    ds_read_b64_tr_b16 v[74:75], v130 offset:29552
    v_mfma_f32_16x16x32_bf16 v[112:115], v[124:127], v[76:79], v[112:115]
    v_mfma_f32_16x16x32_bf16 v[116:119], v[124:127], v[80:83], v[116:119]
    v_mfma_f32_16x16x32_bf16 v[120:123], v[124:127], v[84:87], v[120:123]
    s_waitcnt lgkmcnt(7)
    v_mfma_f32_32x32x16_bf16 v[16:31], v[88:91], v[108:111], v[16:31]
    ds_read_b128 v[104:107], v7 offset:28672
    ds_read_b64_tr_b16 v[76:77], v131 offset:28672
    ds_read_b64_tr_b16 v[78:79], v131 offset:29440
    v_mfma_f32_32x32x16_bf16 v[32:47], v[92:95], v[108:111], v[32:47]
    ds_read_b64_tr_b16 v[80:81], v131 offset:28728
    ds_read_b64_tr_b16 v[82:83], v131 offset:29496
    v_mfma_f32_32x32x16_bf16 v[48:63], v[108:111], v[96:99], v[48:63]
    ds_read_b64_tr_b16 v[84:85], v131 offset:28784
    ds_read_b64_tr_b16 v[86:87], v131 offset:29552
    s_barrier
    v_add_u32 v4, 0xe000, v4
    v_add_u32 v5, 0xe000, v5
    v_add_u32 v6, 0xe000, v6
    v_add_u32 v7, 0xe000, v7
    v_add_u32 v128, 0xe000, v128
    v_add_u32 v129, 0xe000, v129
    v_add_u32 v130, 0xe000, v130
    v_add_u32 v131, 0xe000, v131
    s_waitcnt lgkmcnt(7)
    v_mfma_f32_32x32x16_bf16 v[16:31], v[64:67], v[100:103], v[16:31]
    ds_read_b128 v[108:111], v4 offset:0
    ds_read_b64_tr_b16 v[88:89], v128 offset:0
    ds_read_b64_tr_b16 v[90:91], v128 offset:768
    v_mfma_f32_32x32x16_bf16 v[32:47], v[68:71], v[100:103], v[32:47]
    ds_read_b64_tr_b16 v[92:93], v128 offset:56
    ds_read_b64_tr_b16 v[94:95], v128 offset:824
    v_mfma_f32_32x32x16_bf16 v[48:63], v[100:103], v[72:75], v[48:63]
    ds_read_b64_tr_b16 v[96:97], v128 offset:112
    ds_read_b64_tr_b16 v[98:99], v128 offset:880
    s_waitcnt lgkmcnt(7)
    v_mfma_f32_32x32x16_bf16 v[16:31], v[76:79], v[104:107], v[16:31]
    ds_read_b128 v[100:103], v5 offset:0
    ds_read_b64_tr_b16 v[64:65], v129 offset:0
    ds_read_b64_tr_b16 v[66:67], v129 offset:768
    v_mfma_f32_32x32x16_bf16 v[32:47], v[80:83], v[104:107], v[32:47]
    ds_read_b64_tr_b16 v[68:69], v129 offset:56
    ds_read_b64_tr_b16 v[70:71], v129 offset:824
    v_mfma_f32_32x32x16_bf16 v[48:63], v[104:107], v[84:87], v[48:63]
    ds_read_b64_tr_b16 v[72:73], v129 offset:112
    ds_read_b64_tr_b16 v[74:75], v129 offset:880
    s_waitcnt lgkmcnt(7)
    v_mfma_f32_32x32x16_bf16 v[16:31], v[88:91], v[108:111], v[16:31]
    ds_read_b128 v[104:107], v6 offset:0
    ds_read_b64_tr_b16 v[76:77], v130 offset:0
    ds_read_b64_tr_b16 v[78:79], v130 offset:768
    v_mfma_f32_32x32x16_bf16 v[32:47], v[92:95], v[108:111], v[32:47]
    ds_read_b64_tr_b16 v[80:81], v130 offset:56
    ds_read_b64_tr_b16 v[82:83], v130 offset:824
    v_mfma_f32_32x32x16_bf16 v[48:63], v[108:111], v[96:99], v[48:63]
    ds_read_b64_tr_b16 v[84:85], v130 offset:112
    ds_read_b64_tr_b16 v[86:87], v130 offset:880
    v_mfma_f32_16x16x32_bf16 v[112:115], v[124:127], v[88:91], v[112:115]
    v_mfma_f32_16x16x32_bf16 v[116:119], v[124:127], v[92:95], v[116:119]
    v_mfma_f32_16x16x32_bf16 v[120:123], v[124:127], v[96:99], v[120:123]
    s_waitcnt lgkmcnt(7)
    v_mfma_f32_32x32x16_bf16 v[16:31], v[64:67], v[100:103], v[16:31]
    ds_read_b128 v[108:111], v7 offset:0
    ds_read_b64_tr_b16 v[88:89], v131 offset:0
    ds_read_b64_tr_b16 v[90:91], v131 offset:768
    v_mfma_f32_32x32x16_bf16 v[32:47], v[68:71], v[100:103], v[32:47]
    ds_read_b64_tr_b16 v[92:93], v131 offset:56
    ds_read_b64_tr_b16 v[94:95], v131 offset:824
    v_mfma_f32_32x32x16_bf16 v[48:63], v[100:103], v[72:75], v[48:63]
    ds_read_b64_tr_b16 v[96:97], v131 offset:112
    ds_read_b64_tr_b16 v[98:99], v131 offset:880
    s_barrier
    s_waitcnt lgkmcnt(7)
    v_mfma_f32_32x32x16_bf16 v[16:31], v[76:79], v[104:107], v[16:31]
    ds_read_b128 v[100:103], v4 offset:28672
    ds_read_b64_tr_b16 v[64:65], v128 offset:28672
    ds_read_b64_tr_b16 v[66:67], v128 offset:29440
    v_mfma_f32_32x32x16_bf16 v[32:47], v[80:83], v[104:107], v[32:47]
    ds_read_b64_tr_b16 v[68:69], v128 offset:28728
    ds_read_b64_tr_b16 v[70:71], v128 offset:29496
    v_mfma_f32_32x32x16_bf16 v[48:63], v[104:107], v[84:87], v[48:63]
    ds_read_b64_tr_b16 v[72:73], v128 offset:28784
    ds_read_b64_tr_b16 v[74:75], v128 offset:29552
    s_waitcnt lgkmcnt(7)
    v_mfma_f32_32x32x16_bf16 v[16:31], v[88:91], v[108:111], v[16:31]
    ds_read_b128 v[104:107], v5 offset:28672
    ds_read_b64_tr_b16 v[76:77], v129 offset:28672
    ds_read_b64_tr_b16 v[78:79], v129 offset:29440
    v_mfma_f32_32x32x16_bf16 v[32:47], v[92:95], v[108:111], v[32:47]
    ds_read_b64_tr_b16 v[80:81], v129 offset:28728
    ds_read_b64_tr_b16 v[82:83], v129 offset:29496
    v_mfma_f32_32x32x16_bf16 v[48:63], v[108:111], v[96:99], v[48:63]
    ds_read_b64_tr_b16 v[84:85], v129 offset:28784
    ds_read_b64_tr_b16 v[86:87], v129 offset:29552
    s_waitcnt lgkmcnt(7)
    v_mfma_f32_32x32x16_bf16 v[16:31], v[64:67], v[100:103], v[16:31]
    ds_read_b128 v[108:111], v6 offset:28672
    ds_read_b64_tr_b16 v[88:89], v130 offset:28672
    ds_read_b64_tr_b16 v[90:91], v130 offset:29440
    v_mfma_f32_32x32x16_bf16 v[32:47], v[68:71], v[100:103], v[32:47]
    ds_read_b64_tr_b16 v[92:93], v130 offset:28728
    ds_read_b64_tr_b16 v[94:95], v130 offset:29496
    v_mfma_f32_32x32x16_bf16 v[48:63], v[100:103], v[72:75], v[48:63]
    ds_read_b64_tr_b16 v[96:97], v130 offset:28784
    ds_read_b64_tr_b16 v[98:99], v130 offset:29552
    v_mfma_f32_16x16x32_bf16 v[112:115], v[124:127], v[64:67], v[112:115]
    v_mfma_f32_16x16x32_bf16 v[116:119], v[124:127], v[68:71], v[116:119]
    v_mfma_f32_16x16x32_bf16 v[120:123], v[124:127], v[72:75], v[120:123]
    s_waitcnt lgkmcnt(7)
    v_mfma_f32_32x32x16_bf16 v[16:31], v[76:79], v[104:107], v[16:31]
    ds_read_b128 v[100:103], v7 offset:28672
    ds_read_b64_tr_b16 v[64:65], v131 offset:28672
    ds_read_b64_tr_b16 v[66:67], v131 offset:29440
    v_mfma_f32_32x32x16_bf16 v[32:47], v[80:83], v[104:107], v[32:47]
    ds_read_b64_tr_b16 v[68:69], v131 offset:28728
    ds_read_b64_tr_b16 v[70:71], v131 offset:29496
    v_mfma_f32_32x32x16_bf16 v[48:63], v[104:107], v[84:87], v[48:63]
    ds_read_b64_tr_b16 v[72:73], v131 offset:28784
    ds_read_b64_tr_b16 v[74:75], v131 offset:29552
    s_barrier
    v_add_u32 v4, 0xe000, v4
    v_add_u32 v5, 0xe000, v5
    v_add_u32 v6, 0xe000, v6
    v_add_u32 v7, 0xe000, v7
    v_add_u32 v128, 0xe000, v128
    v_add_u32 v129, 0xe000, v129
    v_add_u32 v130, 0xe000, v130
    v_add_u32 v131, 0xe000, v131
    s_waitcnt lgkmcnt(7)
    v_mfma_f32_32x32x16_bf16 v[16:31], v[88:91], v[108:111], v[16:31]
    ds_read_b128 v[104:107], v4 offset:0
    ds_read_b64_tr_b16 v[76:77], v128 offset:0
    ds_read_b64_tr_b16 v[78:79], v128 offset:768
    v_mfma_f32_32x32x16_bf16 v[32:47], v[92:95], v[108:111], v[32:47]
    ds_read_b64_tr_b16 v[80:81], v128 offset:56
    ds_read_b64_tr_b16 v[82:83], v128 offset:824
    v_mfma_f32_32x32x16_bf16 v[48:63], v[108:111], v[96:99], v[48:63]
    ds_read_b64_tr_b16 v[84:85], v128 offset:112
    ds_read_b64_tr_b16 v[86:87], v128 offset:880
    s_waitcnt lgkmcnt(7)
    v_mfma_f32_32x32x16_bf16 v[16:31], v[64:67], v[100:103], v[16:31]
    ds_read_b128 v[108:111], v5 offset:0
    ds_read_b64_tr_b16 v[88:89], v129 offset:0
    ds_read_b64_tr_b16 v[90:91], v129 offset:768
    v_mfma_f32_32x32x16_bf16 v[32:47], v[68:71], v[100:103], v[32:47]
    ds_read_b64_tr_b16 v[92:93], v129 offset:56
    ds_read_b64_tr_b16 v[94:95], v129 offset:824
    v_mfma_f32_32x32x16_bf16 v[48:63], v[100:103], v[72:75], v[48:63]
    ds_read_b64_tr_b16 v[96:97], v129 offset:112
    ds_read_b64_tr_b16 v[98:99], v129 offset:880
    s_waitcnt lgkmcnt(7)
    v_mfma_f32_32x32x16_bf16 v[16:31], v[76:79], v[104:107], v[16:31]
    ds_read_b128 v[100:103], v6 offset:0
    ds_read_b64_tr_b16 v[64:65], v130 offset:0
    ds_read_b64_tr_b16 v[66:67], v130 offset:768
    v_mfma_f32_32x32x16_bf16 v[32:47], v[80:83], v[104:107], v[32:47]
    ds_read_b64_tr_b16 v[68:69], v130 offset:56
    ds_read_b64_tr_b16 v[70:71], v130 offset:824
    v_mfma_f32_32x32x16_bf16 v[48:63], v[104:107], v[84:87], v[48:63]
    ds_read_b64_tr_b16 v[72:73], v130 offset:112
    ds_read_b64_tr_b16 v[74:75], v130 offset:880
    v_mfma_f32_16x16x32_bf16 v[112:115], v[124:127], v[76:79], v[112:115]
    v_mfma_f32_16x16x32_bf16 v[116:119], v[124:127], v[80:83], v[116:119]
    v_mfma_f32_16x16x32_bf16 v[120:123], v[124:127], v[84:87], v[120:123]
    s_waitcnt lgkmcnt(7)
    v_mfma_f32_32x32x16_bf16 v[16:31], v[88:91], v[108:111], v[16:31]
    ds_read_b128 v[104:107], v7 offset:0
    ds_read_b64_tr_b16 v[76:77], v131 offset:0
    ds_read_b64_tr_b16 v[78:79], v131 offset:768
    v_mfma_f32_32x32x16_bf16 v[32:47], v[92:95], v[108:111], v[32:47]
    ds_read_b64_tr_b16 v[80:81], v131 offset:56
    ds_read_b64_tr_b16 v[82:83], v131 offset:824
    v_mfma_f32_32x32x16_bf16 v[48:63], v[108:111], v[96:99], v[48:63]
    ds_read_b64_tr_b16 v[84:85], v131 offset:112
    ds_read_b64_tr_b16 v[86:87], v131 offset:880
    s_barrier
    v_add_u32 v4, 0xfffe4000, v4
    v_add_u32 v5, 0xfffe4000, v5
    v_add_u32 v6, 0xfffe4000, v6
    v_add_u32 v7, 0xfffe4000, v7
    v_add_u32 v128, 0xfffe4000, v128
    v_add_u32 v129, 0xfffe4000, v129
    v_add_u32 v130, 0xfffe4000, v130
    v_add_u32 v131, 0xfffe4000, v131
    s_waitcnt lgkmcnt(7)
    v_mfma_f32_32x32x16_bf16 v[16:31], v[64:67], v[100:103], v[16:31]
    ds_read_b128 v[108:111], v4 offset:0
    ds_read_b64_tr_b16 v[88:89], v128 offset:0
    ds_read_b64_tr_b16 v[90:91], v128 offset:768
    v_mfma_f32_32x32x16_bf16 v[32:47], v[68:71], v[100:103], v[32:47]
    ds_read_b64_tr_b16 v[92:93], v128 offset:56
    ds_read_b64_tr_b16 v[94:95], v128 offset:824
    v_mfma_f32_32x32x16_bf16 v[48:63], v[100:103], v[72:75], v[48:63]
    ds_read_b64_tr_b16 v[96:97], v128 offset:112
    ds_read_b64_tr_b16 v[98:99], v128 offset:880
    s_waitcnt lgkmcnt(7)
    v_mfma_f32_32x32x16_bf16 v[16:31], v[76:79], v[104:107], v[16:31]
    ds_read_b128 v[100:103], v5 offset:0
    ds_read_b64_tr_b16 v[64:65], v129 offset:0
    ds_read_b64_tr_b16 v[66:67], v129 offset:768
    v_mfma_f32_32x32x16_bf16 v[32:47], v[80:83], v[104:107], v[32:47]
    ds_read_b64_tr_b16 v[68:69], v129 offset:56
    ds_read_b64_tr_b16 v[70:71], v129 offset:824
    v_mfma_f32_32x32x16_bf16 v[48:63], v[104:107], v[84:87], v[48:63]
    ds_read_b64_tr_b16 v[72:73], v129 offset:112
    ds_read_b64_tr_b16 v[74:75], v129 offset:880
    s_waitcnt lgkmcnt(7)
    v_mfma_f32_32x32x16_bf16 v[16:31], v[88:91], v[108:111], v[16:31]
    ds_read_b128 v[104:107], v6 offset:0
    ds_read_b64_tr_b16 v[76:77], v130 offset:0
    ds_read_b64_tr_b16 v[78:79], v130 offset:768
    v_mfma_f32_32x32x16_bf16 v[32:47], v[92:95], v[108:111], v[32:47]
    ds_read_b64_tr_b16 v[80:81], v130 offset:56
    ds_read_b64_tr_b16 v[82:83], v130 offset:824
    v_mfma_f32_32x32x16_bf16 v[48:63], v[108:111], v[96:99], v[48:63]
    ds_read_b64_tr_b16 v[84:85], v130 offset:112
    ds_read_b64_tr_b16 v[86:87], v130 offset:880
    v_mfma_f32_16x16x32_bf16 v[112:115], v[124:127], v[88:91], v[112:115]
    v_mfma_f32_16x16x32_bf16 v[116:119], v[124:127], v[92:95], v[116:119]
    v_mfma_f32_16x16x32_bf16 v[120:123], v[124:127], v[96:99], v[120:123]
    s_waitcnt lgkmcnt(7)
    v_mfma_f32_32x32x16_bf16 v[16:31], v[64:67], v[100:103], v[16:31]
    ds_read_b128 v[108:111], v7 offset:0
    ds_read_b64_tr_b16 v[88:89], v131 offset:0
    ds_read_b64_tr_b16 v[90:91], v131 offset:768
    v_mfma_f32_32x32x16_bf16 v[32:47], v[68:71], v[100:103], v[32:47]
    ds_read_b64_tr_b16 v[92:93], v131 offset:56
    ds_read_b64_tr_b16 v[94:95], v131 offset:824
    v_mfma_f32_32x32x16_bf16 v[48:63], v[100:103], v[72:75], v[48:63]
    ds_read_b64_tr_b16 v[96:97], v131 offset:112
    ds_read_b64_tr_b16 v[98:99], v131 offset:880
    s_barrier
    s_waitcnt lgkmcnt(7)
    v_mfma_f32_32x32x16_bf16 v[16:31], v[76:79], v[104:107], v[16:31]
    ds_read_b128 v[100:103], v4 offset:28672
    ds_read_b64_tr_b16 v[64:65], v128 offset:28672
    ds_read_b64_tr_b16 v[66:67], v128 offset:29440
    v_mfma_f32_32x32x16_bf16 v[32:47], v[80:83], v[104:107], v[32:47]
    ds_read_b64_tr_b16 v[68:69], v128 offset:28728
    ds_read_b64_tr_b16 v[70:71], v128 offset:29496
    v_mfma_f32_32x32x16_bf16 v[48:63], v[104:107], v[84:87], v[48:63]
    ds_read_b64_tr_b16 v[72:73], v128 offset:28784
    ds_read_b64_tr_b16 v[74:75], v128 offset:29552
    s_waitcnt lgkmcnt(7)
    v_mfma_f32_32x32x16_bf16 v[16:31], v[88:91], v[108:111], v[16:31]
    ds_read_b128 v[104:107], v5 offset:28672
    ds_read_b64_tr_b16 v[76:77], v129 offset:28672
    ds_read_b64_tr_b16 v[78:79], v129 offset:29440
    v_mfma_f32_32x32x16_bf16 v[32:47], v[92:95], v[108:111], v[32:47]
    ds_read_b64_tr_b16 v[80:81], v129 offset:28728
    ds_read_b64_tr_b16 v[82:83], v129 offset:29496
    v_mfma_f32_32x32x16_bf16 v[48:63], v[108:111], v[96:99], v[48:63]
    ds_read_b64_tr_b16 v[84:85], v129 offset:28784
    ds_read_b64_tr_b16 v[86:87], v129 offset:29552
    s_waitcnt lgkmcnt(7)
    v_mfma_f32_32x32x16_bf16 v[16:31], v[64:67], v[100:103], v[16:31]
    ds_read_b128 v[108:111], v6 offset:28672
    ds_read_b64_tr_b16 v[88:89], v130 offset:28672
    ds_read_b64_tr_b16 v[90:91], v130 offset:29440
    v_mfma_f32_32x32x16_bf16 v[32:47], v[68:71], v[100:103], v[32:47]
    ds_read_b64_tr_b16 v[92:93], v130 offset:28728
    ds_read_b64_tr_b16 v[94:95], v130 offset:29496
    v_mfma_f32_32x32x16_bf16 v[48:63], v[100:103], v[72:75], v[48:63]
    ds_read_b64_tr_b16 v[96:97], v130 offset:28784
    ds_read_b64_tr_b16 v[98:99], v130 offset:29552
    v_mfma_f32_16x16x32_bf16 v[112:115], v[124:127], v[64:67], v[112:115]
    v_mfma_f32_16x16x32_bf16 v[116:119], v[124:127], v[68:71], v[116:119]
    v_mfma_f32_16x16x32_bf16 v[120:123], v[124:127], v[72:75], v[120:123]
    s_waitcnt lgkmcnt(7)
    v_mfma_f32_32x32x16_bf16 v[16:31], v[76:79], v[104:107], v[16:31]
    ds_read_b128 v[100:103], v7 offset:28672
    ds_read_b64_tr_b16 v[64:65], v131 offset:28672
    ds_read_b64_tr_b16 v[66:67], v131 offset:29440
    v_mfma_f32_32x32x16_bf16 v[32:47], v[80:83], v[104:107], v[32:47]
    ds_read_b64_tr_b16 v[68:69], v131 offset:28728
    ds_read_b64_tr_b16 v[70:71], v131 offset:29496
    v_mfma_f32_32x32x16_bf16 v[48:63], v[104:107], v[84:87], v[48:63]
    ds_read_b64_tr_b16 v[72:73], v131 offset:28784
    ds_read_b64_tr_b16 v[74:75], v131 offset:29552
    s_mov_b64 exec, 0xffff
    ds_write_b32 v132, v112 offset:0
    ds_write_b32 v132, v113 offset:64
    ds_write_b32 v132, v116 offset:128
    ds_write_b32 v132, v117 offset:192
    ds_write_b32 v132, v120 offset:256
    ds_write_b32 v132, v121 offset:320
    s_mov_b64 exec, -1
    s_waitcnt lgkmcnt(13)
    v_mfma_f32_32x32x16_bf16 v[16:31], v[88:91], v[108:111], v[16:31]
    v_mfma_f32_32x32x16_bf16 v[32:47], v[92:95], v[108:111], v[32:47]
    v_mfma_f32_32x32x16_bf16 v[48:63], v[108:111], v[96:99], v[48:63]
    s_waitcnt lgkmcnt(0)
    s_barrier
    v_mfma_f32_32x32x16_bf16 v[16:31], v[64:67], v[100:103], v[16:31]
    v_mfma_f32_32x32x16_bf16 v[32:47], v[68:71], v[100:103], v[32:47]
    v_mfma_f32_32x32x16_bf16 v[48:63], v[100:103], v[72:75], v[48:63]
L_p1_eKKV:
    s_barrier
    ds_read_b32 v10, v133
    ds_read_b32 v11, v133 offset:128
    ds_read_b128 v[140:143], v135 offset:0
    ds_read_b128 v[144:147], v135 offset:32
    ds_read_b128 v[148:151], v135 offset:64
    ds_read_b128 v[152:155], v135 offset:96
    ds_read_b128 v[156:159], v135 offset:128
    ds_read_b128 v[160:163], v135 offset:160
    ds_read_b128 v[164:167], v135 offset:192
    ds_read_b128 v[168:171], v135 offset:224
    s_waitcnt lgkmcnt(4)
    ds_read_b32 v104, v136 offset:256
    ds_read_b128 v[64:67], v134 offset:0
    ds_read_b128 v[80:83], v134 offset:128
    ds_read_b128 v[68:71], v134 offset:32
    ds_read_b128 v[84:87], v134 offset:160
    ds_read_b128 v[72:75], v134 offset:64
    ds_read_b128 v[88:91], v134 offset:192
    ds_read_b128 v[76:79], v134 offset:96
    ds_read_b128 v[92:95], v134 offset:224
    s_waitcnt lgkmcnt(13)
    v_mov_b32 v196, v11
    v_mul_f32_e64 v198, -v10, v196
    v_mov_b32 v197, v196
    v_mov_b32 v199, v198
    v_pk_mul_f32 v[16:17], v[16:17], v[196:197]
    v_pk_mul_f32 v[18:19], v[18:19], v[196:197]
    v_pk_mul_f32 v[20:21], v[20:21], v[196:197]
    v_pk_mul_f32 v[22:23], v[22:23], v[196:197]
    v_pk_mul_f32 v[24:25], v[24:25], v[196:197]
    v_pk_mul_f32 v[26:27], v[26:27], v[196:197]
    v_pk_mul_f32 v[28:29], v[28:29], v[196:197]
    v_pk_mul_f32 v[30:31], v[30:31], v[196:197]
    s_waitcnt lgkmcnt(13)
    v_pk_fma_f32 v[16:17], v[140:141], v[198:199], v[16:17]
    v_pk_fma_f32 v[18:19], v[142:143], v[198:199], v[18:19]
    v_pk_fma_f32 v[20:21], v[144:145], v[198:199], v[20:21]
    v_pk_fma_f32 v[22:23], v[146:147], v[198:199], v[22:23]
    v_pk_fma_f32 v[24:25], v[148:149], v[198:199], v[24:25]
    v_pk_fma_f32 v[26:27], v[150:151], v[198:199], v[26:27]
    v_pk_fma_f32 v[28:29], v[152:153], v[198:199], v[28:29]
    v_pk_fma_f32 v[30:31], v[154:155], v[198:199], v[30:31]
    v_cvt_pk_bf16_f32 v204, v16, v17
    v_cvt_pk_bf16_f32 v205, v18, v19
    v_cvt_pk_bf16_f32 v206, v20, v21
    v_cvt_pk_bf16_f32 v207, v22, v23
    buffer_store_dwordx4 v[204:207], v2, s[20:23], s57 offen offset:0 sc1
    v_cvt_pk_bf16_f32 v208, v24, v25
    v_cvt_pk_bf16_f32 v209, v26, v27
    v_cvt_pk_bf16_f32 v210, v28, v29
    v_cvt_pk_bf16_f32 v211, v30, v31
    v_and_b32 v211, v211, v228
    v_and_or_b32 v210, v210, v228, v229
    buffer_store_dwordx4 v[208:211], v2, s[20:23], s57 offen offset:1024 sc1
    v_pk_mul_f32 v[32:33], v[32:33], v[196:197]
    v_dot2_f32_bf16 v234, v204, v204, 0
    v_pk_mul_f32 v[34:35], v[34:35], v[196:197]
    v_dot2_f32_bf16 v235, v205, v205, 0
    v_pk_mul_f32 v[36:37], v[36:37], v[196:197]
    v_dot2_f32_bf16 v234, v206, v206, v234
    v_pk_mul_f32 v[38:39], v[38:39], v[196:197]
    v_dot2_f32_bf16 v235, v207, v207, v235
    v_pk_mul_f32 v[40:41], v[40:41], v[196:197]
    v_dot2_f32_bf16 v234, v208, v208, v234
    v_pk_mul_f32 v[42:43], v[42:43], v[196:197]
    v_dot2_f32_bf16 v235, v209, v209, v235
    v_pk_mul_f32 v[44:45], v[44:45], v[196:197]
    v_dot2_f32_bf16 v234, v210, v210, v234
    v_pk_mul_f32 v[46:47], v[46:47], v[196:197]
    v_dot2_f32_bf16 v235, v211, v211, v235
    s_waitcnt lgkmcnt(0)
    v_pk_fma_f32 v[32:33], v[156:157], v[198:199], v[32:33]
    v_pk_fma_f32 v[34:35], v[158:159], v[198:199], v[34:35]
    v_add_f32 v234, v234, v235
    v_pk_fma_f32 v[36:37], v[160:161], v[198:199], v[36:37]
    v_mov_b32 v235, v234
    v_pk_fma_f32 v[38:39], v[162:163], v[198:199], v[38:39]
    v_pk_fma_f32 v[40:41], v[164:165], v[198:199], v[40:41]
    v_permlane32_swap_b32 v234, v235
    v_pk_fma_f32 v[42:43], v[166:167], v[198:199], v[42:43]
    v_add_f32 v234, v234, v235
    v_pk_fma_f32 v[44:45], v[168:169], v[198:199], v[44:45]
    ds_max_u32 v14, v234 offset:0
    v_pk_fma_f32 v[46:47], v[170:171], v[198:199], v[46:47]
    v_cvt_pk_bf16_f32 v212, v32, v33
    v_cvt_pk_bf16_f32 v213, v34, v35
    v_cvt_pk_bf16_f32 v214, v36, v37
    v_cvt_pk_bf16_f32 v215, v38, v39
    buffer_store_dwordx4 v[212:215], v2, s[20:23], s58 offen offset:0 sc1
    v_cvt_pk_bf16_f32 v216, v40, v41
    v_cvt_pk_bf16_f32 v217, v42, v43
    v_cvt_pk_bf16_f32 v218, v44, v45
    v_cvt_pk_bf16_f32 v219, v46, v47
    v_and_b32 v219, v219, v228
    v_and_or_b32 v218, v218, v228, v229
    buffer_store_dwordx4 v[216:219], v2, s[20:23], s58 offen offset:1024 sc1
    s_waitcnt lgkmcnt(0)
    v_dot2_f32_bf16 v236, v212, v212, 0
    v_sub_f32 v104, 0, v104
    v_dot2_f32_bf16 v237, v213, v213, 0
    v_mov_b32 v105, v104
    v_dot2_f32_bf16 v236, v214, v214, v236
    v_pk_fma_f32 v[48:49], v[64:65], v[104:105], v[48:49]
    v_dot2_f32_bf16 v237, v215, v215, v237
    v_pk_fma_f32 v[50:51], v[66:67], v[104:105], v[50:51]
    v_dot2_f32_bf16 v236, v216, v216, v236
    v_pk_fma_f32 v[52:53], v[68:69], v[104:105], v[52:53]
    v_dot2_f32_bf16 v237, v217, v217, v237
    v_pk_fma_f32 v[54:55], v[70:71], v[104:105], v[54:55]
    v_dot2_f32_bf16 v236, v218, v218, v236
    v_pk_fma_f32 v[56:57], v[72:73], v[104:105], v[56:57]
    v_dot2_f32_bf16 v237, v219, v219, v237
    v_pk_fma_f32 v[58:59], v[74:75], v[104:105], v[58:59]
    v_pk_fma_f32 v[60:61], v[76:77], v[104:105], v[60:61]
    v_pk_fma_f32 v[62:63], v[78:79], v[104:105], v[62:63]
    v_add_f32 v236, v236, v237
    v_pk_mul_f32 v[48:49], v[48:49], v[80:81]
    v_mov_b32 v237, v236
    v_pk_mul_f32 v[50:51], v[50:51], v[82:83]
    v_pk_mul_f32 v[52:53], v[52:53], v[84:85]
    v_permlane32_swap_b32 v236, v237
    v_pk_mul_f32 v[54:55], v[54:55], v[86:87]
    v_add_f32 v236, v236, v237
    v_pk_mul_f32 v[56:57], v[56:57], v[88:89]
    ds_max_u32 v14, v236 offset:4
    v_pk_mul_f32 v[58:59], v[58:59], v[90:91]
    v_pk_mul_f32 v[60:61], v[60:61], v[92:93]
    v_pk_mul_f32 v[62:63], v[62:63], v[94:95]
    v_cvt_pk_bf16_f32 v220, v48, v49
    v_cvt_pk_bf16_f32 v221, v50, v51
    v_cvt_pk_bf16_f32 v222, v52, v53
    v_cvt_pk_bf16_f32 v223, v54, v55
    v_cvt_pk_bf16_f32 v224, v56, v57
    v_cvt_pk_bf16_f32 v225, v58, v59
    v_cvt_pk_bf16_f32 v226, v60, v61
    v_cvt_pk_bf16_f32 v227, v62, v63
    v_and_or_b32 v220, v220, v231, v232
    v_and_or_b32 v221, v221, v231, v232
    v_and_or_b32 v222, v222, v231, v232
    v_and_or_b32 v223, v223, v231, v232
    buffer_store_dwordx4 v[220:223], v2, s[20:23], s59 offen offset:0 sc1
    v_and_or_b32 v224, v224, v231, v232
    v_and_or_b32 v225, v225, v231, v232
    v_and_or_b32 v226, v226, v231, v232
    v_and_or_b32 v227, v227, v231, v232
    buffer_store_dwordx4 v[224:227], v2, s[20:23], s59 offen offset:1024 sc1
    s_branch L_p1_done
L_p1_v2:
    s_barrier
    ds_read_b128 v[100:103], v4 offset:0
    ds_read_b64_tr_b16 v[64:65], v128 offset:0
    ds_read_b64_tr_b16 v[66:67], v128 offset:768
    ds_read_b64_tr_b16 v[68:69], v128 offset:56
    ds_read_b64_tr_b16 v[70:71], v128 offset:824
    ds_read_b64_tr_b16 v[72:73], v128 offset:112
    ds_read_b64_tr_b16 v[74:75], v128 offset:880
    ds_read_b128 v[104:107], v5 offset:0
    ds_read_b64_tr_b16 v[76:77], v129 offset:0
    ds_read_b64_tr_b16 v[78:79], v129 offset:768
    ds_read_b64_tr_b16 v[80:81], v129 offset:56
    ds_read_b64_tr_b16 v[82:83], v129 offset:824
    ds_read_b64_tr_b16 v[84:85], v129 offset:112
    ds_read_b64_tr_b16 v[86:87], v129 offset:880
    s_waitcnt lgkmcnt(7)
    v_mfma_f32_32x32x16_bf16 v[16:31], v[100:103], v[64:67], 0
    ds_read_b128 v[108:111], v6 offset:0
    ds_read_b64_tr_b16 v[88:89], v130 offset:0
    ds_read_b64_tr_b16 v[90:91], v130 offset:768
    v_mfma_f32_32x32x16_bf16 v[32:47], v[100:103], v[68:71], 0
    ds_read_b64_tr_b16 v[92:93], v130 offset:56
    ds_read_b64_tr_b16 v[94:95], v130 offset:824
    v_mfma_f32_32x32x16_bf16 v[48:63], v[100:103], v[72:75], 0
    ds_read_b64_tr_b16 v[96:97], v130 offset:112
    ds_read_b64_tr_b16 v[98:99], v130 offset:880
    v_mfma_f32_16x16x32_bf16 v[112:115], v[124:127], v[64:67], 0
    v_mfma_f32_16x16x32_bf16 v[116:119], v[124:127], v[68:71], 0
    v_mfma_f32_16x16x32_bf16 v[120:123], v[124:127], v[72:75], 0
    s_waitcnt lgkmcnt(7)
    v_mfma_f32_32x32x16_bf16 v[16:31], v[104:107], v[76:79], v[16:31]
    ds_read_b128 v[100:103], v7 offset:0
    ds_read_b64_tr_b16 v[64:65], v131 offset:0
    ds_read_b64_tr_b16 v[66:67], v131 offset:768
    v_mfma_f32_32x32x16_bf16 v[32:47], v[104:107], v[80:83], v[32:47]
    ds_read_b64_tr_b16 v[68:69], v131 offset:56
    ds_read_b64_tr_b16 v[70:71], v131 offset:824
    v_mfma_f32_32x32x16_bf16 v[48:63], v[104:107], v[84:87], v[48:63]
    ds_read_b64_tr_b16 v[72:73], v131 offset:112
    ds_read_b64_tr_b16 v[74:75], v131 offset:880
    s_waitcnt vmcnt(0)
    s_barrier
    s_waitcnt lgkmcnt(7)
    v_mfma_f32_32x32x16_bf16 v[16:31], v[108:111], v[88:91], v[16:31]
    ds_read_b128 v[104:107], v4 offset:28672
    ds_read_b64_tr_b16 v[76:77], v128 offset:28672
    ds_read_b64_tr_b16 v[78:79], v128 offset:29440
    v_mfma_f32_32x32x16_bf16 v[32:47], v[108:111], v[92:95], v[32:47]
    ds_read_b64_tr_b16 v[80:81], v128 offset:28728
    ds_read_b64_tr_b16 v[82:83], v128 offset:29496
    v_mfma_f32_32x32x16_bf16 v[48:63], v[108:111], v[96:99], v[48:63]
    ds_read_b64_tr_b16 v[84:85], v128 offset:28784
    ds_read_b64_tr_b16 v[86:87], v128 offset:29552
    s_waitcnt lgkmcnt(7)
    v_mfma_f32_32x32x16_bf16 v[16:31], v[100:103], v[64:67], v[16:31]
    ds_read_b128 v[108:111], v5 offset:28672
    ds_read_b64_tr_b16 v[88:89], v129 offset:28672
    ds_read_b64_tr_b16 v[90:91], v129 offset:29440
    v_mfma_f32_32x32x16_bf16 v[32:47], v[100:103], v[68:71], v[32:47]
    ds_read_b64_tr_b16 v[92:93], v129 offset:28728
    ds_read_b64_tr_b16 v[94:95], v129 offset:29496
    v_mfma_f32_32x32x16_bf16 v[48:63], v[100:103], v[72:75], v[48:63]
    ds_read_b64_tr_b16 v[96:97], v129 offset:28784
    ds_read_b64_tr_b16 v[98:99], v129 offset:29552
    s_waitcnt lgkmcnt(7)
    v_mfma_f32_32x32x16_bf16 v[16:31], v[104:107], v[76:79], v[16:31]
    ds_read_b128 v[100:103], v6 offset:28672
    ds_read_b64_tr_b16 v[64:65], v130 offset:28672
    ds_read_b64_tr_b16 v[66:67], v130 offset:29440
    v_mfma_f32_32x32x16_bf16 v[32:47], v[104:107], v[80:83], v[32:47]
    ds_read_b64_tr_b16 v[68:69], v130 offset:28728
    ds_read_b64_tr_b16 v[70:71], v130 offset:29496
    v_mfma_f32_32x32x16_bf16 v[48:63], v[104:107], v[84:87], v[48:63]
    ds_read_b64_tr_b16 v[72:73], v130 offset:28784
    ds_read_b64_tr_b16 v[74:75], v130 offset:29552
    v_mfma_f32_16x16x32_bf16 v[112:115], v[124:127], v[76:79], v[112:115]
    v_mfma_f32_16x16x32_bf16 v[116:119], v[124:127], v[80:83], v[116:119]
    v_mfma_f32_16x16x32_bf16 v[120:123], v[124:127], v[84:87], v[120:123]
    s_waitcnt lgkmcnt(7)
    v_mfma_f32_32x32x16_bf16 v[16:31], v[108:111], v[88:91], v[16:31]
    ds_read_b128 v[104:107], v7 offset:28672
    ds_read_b64_tr_b16 v[76:77], v131 offset:28672
    ds_read_b64_tr_b16 v[78:79], v131 offset:29440
    v_mfma_f32_32x32x16_bf16 v[32:47], v[108:111], v[92:95], v[32:47]
    ds_read_b64_tr_b16 v[80:81], v131 offset:28728
    ds_read_b64_tr_b16 v[82:83], v131 offset:29496
    v_mfma_f32_32x32x16_bf16 v[48:63], v[108:111], v[96:99], v[48:63]
    ds_read_b64_tr_b16 v[84:85], v131 offset:28784
    ds_read_b64_tr_b16 v[86:87], v131 offset:29552
    s_barrier
    v_add_u32 v4, 0xe000, v4
    v_add_u32 v5, 0xe000, v5
    v_add_u32 v6, 0xe000, v6
    v_add_u32 v7, 0xe000, v7
    v_add_u32 v128, 0xe000, v128
    v_add_u32 v129, 0xe000, v129
    v_add_u32 v130, 0xe000, v130
    v_add_u32 v131, 0xe000, v131
    s_waitcnt lgkmcnt(7)
    v_mfma_f32_32x32x16_bf16 v[16:31], v[100:103], v[64:67], v[16:31]
    ds_read_b128 v[108:111], v4 offset:0
    ds_read_b64_tr_b16 v[88:89], v128 offset:0
    ds_read_b64_tr_b16 v[90:91], v128 offset:768
    v_mfma_f32_32x32x16_bf16 v[32:47], v[100:103], v[68:71], v[32:47]
    ds_read_b64_tr_b16 v[92:93], v128 offset:56
    ds_read_b64_tr_b16 v[94:95], v128 offset:824
    v_mfma_f32_32x32x16_bf16 v[48:63], v[100:103], v[72:75], v[48:63]
    ds_read_b64_tr_b16 v[96:97], v128 offset:112
    ds_read_b64_tr_b16 v[98:99], v128 offset:880
    s_waitcnt lgkmcnt(7)
    v_mfma_f32_32x32x16_bf16 v[16:31], v[104:107], v[76:79], v[16:31]
    ds_read_b128 v[100:103], v5 offset:0
    ds_read_b64_tr_b16 v[64:65], v129 offset:0
    ds_read_b64_tr_b16 v[66:67], v129 offset:768
    v_mfma_f32_32x32x16_bf16 v[32:47], v[104:107], v[80:83], v[32:47]
    ds_read_b64_tr_b16 v[68:69], v129 offset:56
    ds_read_b64_tr_b16 v[70:71], v129 offset:824
    v_mfma_f32_32x32x16_bf16 v[48:63], v[104:107], v[84:87], v[48:63]
    ds_read_b64_tr_b16 v[72:73], v129 offset:112
    ds_read_b64_tr_b16 v[74:75], v129 offset:880
    s_waitcnt lgkmcnt(7)
    v_mfma_f32_32x32x16_bf16 v[16:31], v[108:111], v[88:91], v[16:31]
    ds_read_b128 v[104:107], v6 offset:0
    ds_read_b64_tr_b16 v[76:77], v130 offset:0
    ds_read_b64_tr_b16 v[78:79], v130 offset:768
    v_mfma_f32_32x32x16_bf16 v[32:47], v[108:111], v[92:95], v[32:47]
    ds_read_b64_tr_b16 v[80:81], v130 offset:56
    ds_read_b64_tr_b16 v[82:83], v130 offset:824
    v_mfma_f32_32x32x16_bf16 v[48:63], v[108:111], v[96:99], v[48:63]
    ds_read_b64_tr_b16 v[84:85], v130 offset:112
    ds_read_b64_tr_b16 v[86:87], v130 offset:880
    v_mfma_f32_16x16x32_bf16 v[112:115], v[124:127], v[88:91], v[112:115]
    v_mfma_f32_16x16x32_bf16 v[116:119], v[124:127], v[92:95], v[116:119]
    v_mfma_f32_16x16x32_bf16 v[120:123], v[124:127], v[96:99], v[120:123]
    s_waitcnt lgkmcnt(7)
    v_mfma_f32_32x32x16_bf16 v[16:31], v[100:103], v[64:67], v[16:31]
    ds_read_b128 v[108:111], v7 offset:0
    ds_read_b64_tr_b16 v[88:89], v131 offset:0
    ds_read_b64_tr_b16 v[90:91], v131 offset:768
    v_mfma_f32_32x32x16_bf16 v[32:47], v[100:103], v[68:71], v[32:47]
    ds_read_b64_tr_b16 v[92:93], v131 offset:56
    ds_read_b64_tr_b16 v[94:95], v131 offset:824
    v_mfma_f32_32x32x16_bf16 v[48:63], v[100:103], v[72:75], v[48:63]
    ds_read_b64_tr_b16 v[96:97], v131 offset:112
    ds_read_b64_tr_b16 v[98:99], v131 offset:880
    s_barrier
    s_waitcnt lgkmcnt(7)
    v_mfma_f32_32x32x16_bf16 v[16:31], v[104:107], v[76:79], v[16:31]
    ds_read_b128 v[100:103], v4 offset:28672
    ds_read_b64_tr_b16 v[64:65], v128 offset:28672
    ds_read_b64_tr_b16 v[66:67], v128 offset:29440
    v_mfma_f32_32x32x16_bf16 v[32:47], v[104:107], v[80:83], v[32:47]
    ds_read_b64_tr_b16 v[68:69], v128 offset:28728
    ds_read_b64_tr_b16 v[70:71], v128 offset:29496
    v_mfma_f32_32x32x16_bf16 v[48:63], v[104:107], v[84:87], v[48:63]
    ds_read_b64_tr_b16 v[72:73], v128 offset:28784
    ds_read_b64_tr_b16 v[74:75], v128 offset:29552
    s_waitcnt lgkmcnt(7)
    v_mfma_f32_32x32x16_bf16 v[16:31], v[108:111], v[88:91], v[16:31]
    ds_read_b128 v[104:107], v5 offset:28672
    ds_read_b64_tr_b16 v[76:77], v129 offset:28672
    ds_read_b64_tr_b16 v[78:79], v129 offset:29440
    v_mfma_f32_32x32x16_bf16 v[32:47], v[108:111], v[92:95], v[32:47]
    ds_read_b64_tr_b16 v[80:81], v129 offset:28728
    ds_read_b64_tr_b16 v[82:83], v129 offset:29496
    v_mfma_f32_32x32x16_bf16 v[48:63], v[108:111], v[96:99], v[48:63]
    ds_read_b64_tr_b16 v[84:85], v129 offset:28784
    ds_read_b64_tr_b16 v[86:87], v129 offset:29552
    s_waitcnt lgkmcnt(7)
    v_mfma_f32_32x32x16_bf16 v[16:31], v[100:103], v[64:67], v[16:31]
    ds_read_b128 v[108:111], v6 offset:28672
    ds_read_b64_tr_b16 v[88:89], v130 offset:28672
    ds_read_b64_tr_b16 v[90:91], v130 offset:29440
    v_mfma_f32_32x32x16_bf16 v[32:47], v[100:103], v[68:71], v[32:47]
    ds_read_b64_tr_b16 v[92:93], v130 offset:28728
    ds_read_b64_tr_b16 v[94:95], v130 offset:29496
    v_mfma_f32_32x32x16_bf16 v[48:63], v[100:103], v[72:75], v[48:63]
    ds_read_b64_tr_b16 v[96:97], v130 offset:28784
    ds_read_b64_tr_b16 v[98:99], v130 offset:29552
    v_mfma_f32_16x16x32_bf16 v[112:115], v[124:127], v[64:67], v[112:115]
    v_mfma_f32_16x16x32_bf16 v[116:119], v[124:127], v[68:71], v[116:119]
    v_mfma_f32_16x16x32_bf16 v[120:123], v[124:127], v[72:75], v[120:123]
    s_waitcnt lgkmcnt(7)
    v_mfma_f32_32x32x16_bf16 v[16:31], v[104:107], v[76:79], v[16:31]
    ds_read_b128 v[100:103], v7 offset:28672
    ds_read_b64_tr_b16 v[64:65], v131 offset:28672
    ds_read_b64_tr_b16 v[66:67], v131 offset:29440
    v_mfma_f32_32x32x16_bf16 v[32:47], v[104:107], v[80:83], v[32:47]
    ds_read_b64_tr_b16 v[68:69], v131 offset:28728
    ds_read_b64_tr_b16 v[70:71], v131 offset:29496
    v_mfma_f32_32x32x16_bf16 v[48:63], v[104:107], v[84:87], v[48:63]
    ds_read_b64_tr_b16 v[72:73], v131 offset:28784
    ds_read_b64_tr_b16 v[74:75], v131 offset:29552
    s_barrier
    v_add_u32 v4, 0xe000, v4
    v_add_u32 v5, 0xe000, v5
    v_add_u32 v6, 0xe000, v6
    v_add_u32 v7, 0xe000, v7
    v_add_u32 v128, 0xe000, v128
    v_add_u32 v129, 0xe000, v129
    v_add_u32 v130, 0xe000, v130
    v_add_u32 v131, 0xe000, v131
    s_waitcnt lgkmcnt(7)
    v_mfma_f32_32x32x16_bf16 v[16:31], v[108:111], v[88:91], v[16:31]
    ds_read_b128 v[104:107], v4 offset:0
    ds_read_b64_tr_b16 v[76:77], v128 offset:0
    ds_read_b64_tr_b16 v[78:79], v128 offset:768
    v_mfma_f32_32x32x16_bf16 v[32:47], v[108:111], v[92:95], v[32:47]
    ds_read_b64_tr_b16 v[80:81], v128 offset:56
    ds_read_b64_tr_b16 v[82:83], v128 offset:824
    v_mfma_f32_32x32x16_bf16 v[48:63], v[108:111], v[96:99], v[48:63]
    ds_read_b64_tr_b16 v[84:85], v128 offset:112
    ds_read_b64_tr_b16 v[86:87], v128 offset:880
    s_waitcnt lgkmcnt(7)
    v_mfma_f32_32x32x16_bf16 v[16:31], v[100:103], v[64:67], v[16:31]
    ds_read_b128 v[108:111], v5 offset:0
    ds_read_b64_tr_b16 v[88:89], v129 offset:0
    ds_read_b64_tr_b16 v[90:91], v129 offset:768
    v_mfma_f32_32x32x16_bf16 v[32:47], v[100:103], v[68:71], v[32:47]
    ds_read_b64_tr_b16 v[92:93], v129 offset:56
    ds_read_b64_tr_b16 v[94:95], v129 offset:824
    v_mfma_f32_32x32x16_bf16 v[48:63], v[100:103], v[72:75], v[48:63]
    ds_read_b64_tr_b16 v[96:97], v129 offset:112
    ds_read_b64_tr_b16 v[98:99], v129 offset:880
    s_waitcnt lgkmcnt(7)
    v_mfma_f32_32x32x16_bf16 v[16:31], v[104:107], v[76:79], v[16:31]
    ds_read_b128 v[100:103], v6 offset:0
    ds_read_b64_tr_b16 v[64:65], v130 offset:0
    ds_read_b64_tr_b16 v[66:67], v130 offset:768
    v_mfma_f32_32x32x16_bf16 v[32:47], v[104:107], v[80:83], v[32:47]
    ds_read_b64_tr_b16 v[68:69], v130 offset:56
    ds_read_b64_tr_b16 v[70:71], v130 offset:824
    v_mfma_f32_32x32x16_bf16 v[48:63], v[104:107], v[84:87], v[48:63]
    ds_read_b64_tr_b16 v[72:73], v130 offset:112
    ds_read_b64_tr_b16 v[74:75], v130 offset:880
    v_mfma_f32_16x16x32_bf16 v[112:115], v[124:127], v[76:79], v[112:115]
    v_mfma_f32_16x16x32_bf16 v[116:119], v[124:127], v[80:83], v[116:119]
    v_mfma_f32_16x16x32_bf16 v[120:123], v[124:127], v[84:87], v[120:123]
    s_waitcnt lgkmcnt(7)
    v_mfma_f32_32x32x16_bf16 v[16:31], v[108:111], v[88:91], v[16:31]
    ds_read_b128 v[104:107], v7 offset:0
    ds_read_b64_tr_b16 v[76:77], v131 offset:0
    ds_read_b64_tr_b16 v[78:79], v131 offset:768
    v_mfma_f32_32x32x16_bf16 v[32:47], v[108:111], v[92:95], v[32:47]
    ds_read_b64_tr_b16 v[80:81], v131 offset:56
    ds_read_b64_tr_b16 v[82:83], v131 offset:824
    v_mfma_f32_32x32x16_bf16 v[48:63], v[108:111], v[96:99], v[48:63]
    ds_read_b64_tr_b16 v[84:85], v131 offset:112
    ds_read_b64_tr_b16 v[86:87], v131 offset:880
    s_barrier
    v_add_u32 v4, 0xfffe4000, v4
    v_add_u32 v5, 0xfffe4000, v5
    v_add_u32 v6, 0xfffe4000, v6
    v_add_u32 v7, 0xfffe4000, v7
    v_add_u32 v128, 0xfffe4000, v128
    v_add_u32 v129, 0xfffe4000, v129
    v_add_u32 v130, 0xfffe4000, v130
    v_add_u32 v131, 0xfffe4000, v131
    s_waitcnt lgkmcnt(7)
    v_mfma_f32_32x32x16_bf16 v[16:31], v[100:103], v[64:67], v[16:31]
    ds_read_b128 v[108:111], v4 offset:0
    ds_read_b64_tr_b16 v[88:89], v128 offset:0
    ds_read_b64_tr_b16 v[90:91], v128 offset:768
    v_mfma_f32_32x32x16_bf16 v[32:47], v[100:103], v[68:71], v[32:47]
    ds_read_b64_tr_b16 v[92:93], v128 offset:56
    ds_read_b64_tr_b16 v[94:95], v128 offset:824
    v_mfma_f32_32x32x16_bf16 v[48:63], v[100:103], v[72:75], v[48:63]
    ds_read_b64_tr_b16 v[96:97], v128 offset:112
    ds_read_b64_tr_b16 v[98:99], v128 offset:880
    s_waitcnt lgkmcnt(7)
    v_mfma_f32_32x32x16_bf16 v[16:31], v[104:107], v[76:79], v[16:31]
    ds_read_b128 v[100:103], v5 offset:0
    ds_read_b64_tr_b16 v[64:65], v129 offset:0
    ds_read_b64_tr_b16 v[66:67], v129 offset:768
    v_mfma_f32_32x32x16_bf16 v[32:47], v[104:107], v[80:83], v[32:47]
    ds_read_b64_tr_b16 v[68:69], v129 offset:56
    ds_read_b64_tr_b16 v[70:71], v129 offset:824
    v_mfma_f32_32x32x16_bf16 v[48:63], v[104:107], v[84:87], v[48:63]
    ds_read_b64_tr_b16 v[72:73], v129 offset:112
    ds_read_b64_tr_b16 v[74:75], v129 offset:880
    s_waitcnt lgkmcnt(7)
    v_mfma_f32_32x32x16_bf16 v[16:31], v[108:111], v[88:91], v[16:31]
    ds_read_b128 v[104:107], v6 offset:0
    ds_read_b64_tr_b16 v[76:77], v130 offset:0
    ds_read_b64_tr_b16 v[78:79], v130 offset:768
    v_mfma_f32_32x32x16_bf16 v[32:47], v[108:111], v[92:95], v[32:47]
    ds_read_b64_tr_b16 v[80:81], v130 offset:56
    ds_read_b64_tr_b16 v[82:83], v130 offset:824
    v_mfma_f32_32x32x16_bf16 v[48:63], v[108:111], v[96:99], v[48:63]
    ds_read_b64_tr_b16 v[84:85], v130 offset:112
    ds_read_b64_tr_b16 v[86:87], v130 offset:880
    v_mfma_f32_16x16x32_bf16 v[112:115], v[124:127], v[88:91], v[112:115]
    v_mfma_f32_16x16x32_bf16 v[116:119], v[124:127], v[92:95], v[116:119]
    v_mfma_f32_16x16x32_bf16 v[120:123], v[124:127], v[96:99], v[120:123]
    s_waitcnt lgkmcnt(7)
    v_mfma_f32_32x32x16_bf16 v[16:31], v[100:103], v[64:67], v[16:31]
    ds_read_b128 v[108:111], v7 offset:0
    ds_read_b64_tr_b16 v[88:89], v131 offset:0
    ds_read_b64_tr_b16 v[90:91], v131 offset:768
    v_mfma_f32_32x32x16_bf16 v[32:47], v[100:103], v[68:71], v[32:47]
    ds_read_b64_tr_b16 v[92:93], v131 offset:56
    ds_read_b64_tr_b16 v[94:95], v131 offset:824
    v_mfma_f32_32x32x16_bf16 v[48:63], v[100:103], v[72:75], v[48:63]
    ds_read_b64_tr_b16 v[96:97], v131 offset:112
    ds_read_b64_tr_b16 v[98:99], v131 offset:880
    s_barrier
    s_waitcnt lgkmcnt(7)
    v_mfma_f32_32x32x16_bf16 v[16:31], v[104:107], v[76:79], v[16:31]
    ds_read_b128 v[100:103], v4 offset:28672
    ds_read_b64_tr_b16 v[64:65], v128 offset:28672
    ds_read_b64_tr_b16 v[66:67], v128 offset:29440
    v_mfma_f32_32x32x16_bf16 v[32:47], v[104:107], v[80:83], v[32:47]
    ds_read_b64_tr_b16 v[68:69], v128 offset:28728
    ds_read_b64_tr_b16 v[70:71], v128 offset:29496
    v_mfma_f32_32x32x16_bf16 v[48:63], v[104:107], v[84:87], v[48:63]
    ds_read_b64_tr_b16 v[72:73], v128 offset:28784
    ds_read_b64_tr_b16 v[74:75], v128 offset:29552
    s_waitcnt lgkmcnt(7)
    v_mfma_f32_32x32x16_bf16 v[16:31], v[108:111], v[88:91], v[16:31]
    ds_read_b128 v[104:107], v5 offset:28672
    ds_read_b64_tr_b16 v[76:77], v129 offset:28672
    ds_read_b64_tr_b16 v[78:79], v129 offset:29440
    v_mfma_f32_32x32x16_bf16 v[32:47], v[108:111], v[92:95], v[32:47]
    ds_read_b64_tr_b16 v[80:81], v129 offset:28728
    ds_read_b64_tr_b16 v[82:83], v129 offset:29496
    v_mfma_f32_32x32x16_bf16 v[48:63], v[108:111], v[96:99], v[48:63]
    ds_read_b64_tr_b16 v[84:85], v129 offset:28784
    ds_read_b64_tr_b16 v[86:87], v129 offset:29552
    s_waitcnt lgkmcnt(7)
    v_mfma_f32_32x32x16_bf16 v[16:31], v[100:103], v[64:67], v[16:31]
    ds_read_b128 v[108:111], v6 offset:28672
    ds_read_b64_tr_b16 v[88:89], v130 offset:28672
    ds_read_b64_tr_b16 v[90:91], v130 offset:29440
    v_mfma_f32_32x32x16_bf16 v[32:47], v[100:103], v[68:71], v[32:47]
    ds_read_b64_tr_b16 v[92:93], v130 offset:28728
    ds_read_b64_tr_b16 v[94:95], v130 offset:29496
    v_mfma_f32_32x32x16_bf16 v[48:63], v[100:103], v[72:75], v[48:63]
    ds_read_b64_tr_b16 v[96:97], v130 offset:28784
    ds_read_b64_tr_b16 v[98:99], v130 offset:29552
    v_mfma_f32_16x16x32_bf16 v[112:115], v[124:127], v[64:67], v[112:115]
    v_mfma_f32_16x16x32_bf16 v[116:119], v[124:127], v[68:71], v[116:119]
    v_mfma_f32_16x16x32_bf16 v[120:123], v[124:127], v[72:75], v[120:123]
    s_waitcnt lgkmcnt(7)
    v_mfma_f32_32x32x16_bf16 v[16:31], v[104:107], v[76:79], v[16:31]
    ds_read_b128 v[100:103], v7 offset:28672
    ds_read_b64_tr_b16 v[64:65], v131 offset:28672
    ds_read_b64_tr_b16 v[66:67], v131 offset:29440
    v_mfma_f32_32x32x16_bf16 v[32:47], v[104:107], v[80:83], v[32:47]
    ds_read_b64_tr_b16 v[68:69], v131 offset:28728
    ds_read_b64_tr_b16 v[70:71], v131 offset:29496
    v_mfma_f32_32x32x16_bf16 v[48:63], v[104:107], v[84:87], v[48:63]
    ds_read_b64_tr_b16 v[72:73], v131 offset:28784
    ds_read_b64_tr_b16 v[74:75], v131 offset:29552
    s_mov_b64 exec, 0xffff
    ds_write_b32 v132, v112 offset:0
    ds_write_b32 v132, v113 offset:64
    ds_write_b32 v132, v116 offset:128
    ds_write_b32 v132, v117 offset:192
    ds_write_b32 v132, v120 offset:256
    ds_write_b32 v132, v121 offset:320
    s_mov_b64 exec, -1
    s_waitcnt lgkmcnt(13)
    v_mfma_f32_32x32x16_bf16 v[16:31], v[108:111], v[88:91], v[16:31]
    v_mfma_f32_32x32x16_bf16 v[32:47], v[108:111], v[92:95], v[32:47]
    v_mfma_f32_32x32x16_bf16 v[48:63], v[108:111], v[96:99], v[48:63]
    s_waitcnt lgkmcnt(0)
    s_barrier
    v_mfma_f32_32x32x16_bf16 v[16:31], v[100:103], v[64:67], v[16:31]
    v_mfma_f32_32x32x16_bf16 v[32:47], v[100:103], v[68:71], v[32:47]
    v_mfma_f32_32x32x16_bf16 v[48:63], v[100:103], v[72:75], v[48:63]
L_p1_eVVV:
    s_barrier
    ds_read_b32 v100, v136 offset:0
    ds_read_b32 v102, v136 offset:128
    ds_read_b32 v104, v136 offset:256
    ds_read_b128 v[64:67], v134 offset:0
    ds_read_b128 v[80:83], v134 offset:128
    ds_read_b128 v[68:71], v134 offset:32
    ds_read_b128 v[84:87], v134 offset:160
    ds_read_b128 v[72:75], v134 offset:64
    ds_read_b128 v[88:91], v134 offset:192
    ds_read_b128 v[76:79], v134 offset:96
    ds_read_b128 v[92:95], v134 offset:224
    s_waitcnt lgkmcnt(0)
    v_sub_f32 v100, 0, v100
    v_mov_b32 v101, v100
    v_pk_fma_f32 v[16:17], v[64:65], v[100:101], v[16:17]
    v_pk_fma_f32 v[18:19], v[66:67], v[100:101], v[18:19]
    v_pk_fma_f32 v[20:21], v[68:69], v[100:101], v[20:21]
    v_pk_fma_f32 v[22:23], v[70:71], v[100:101], v[22:23]
    v_pk_fma_f32 v[24:25], v[72:73], v[100:101], v[24:25]
    v_pk_fma_f32 v[26:27], v[74:75], v[100:101], v[26:27]
    v_pk_fma_f32 v[28:29], v[76:77], v[100:101], v[28:29]
    v_pk_fma_f32 v[30:31], v[78:79], v[100:101], v[30:31]
    v_pk_mul_f32 v[16:17], v[16:17], v[80:81]
    v_pk_mul_f32 v[18:19], v[18:19], v[82:83]
    v_pk_mul_f32 v[20:21], v[20:21], v[84:85]
    v_pk_mul_f32 v[22:23], v[22:23], v[86:87]
    v_pk_mul_f32 v[24:25], v[24:25], v[88:89]
    v_pk_mul_f32 v[26:27], v[26:27], v[90:91]
    v_pk_mul_f32 v[28:29], v[28:29], v[92:93]
    v_pk_mul_f32 v[30:31], v[30:31], v[94:95]
    v_cvt_pk_bf16_f32 v204, v16, v17
    v_cvt_pk_bf16_f32 v205, v18, v19
    v_cvt_pk_bf16_f32 v206, v20, v21
    v_cvt_pk_bf16_f32 v207, v22, v23
    v_cvt_pk_bf16_f32 v208, v24, v25
    v_cvt_pk_bf16_f32 v209, v26, v27
    v_cvt_pk_bf16_f32 v210, v28, v29
    v_cvt_pk_bf16_f32 v211, v30, v31
    v_and_or_b32 v204, v204, v231, v232
    v_and_or_b32 v205, v205, v231, v232
    v_and_or_b32 v206, v206, v231, v232
    v_and_or_b32 v207, v207, v231, v232
    buffer_store_dwordx4 v[204:207], v2, s[20:23], s57 offen offset:0 sc1
    v_and_or_b32 v208, v208, v231, v232
    v_and_or_b32 v209, v209, v231, v232
    v_and_or_b32 v210, v210, v231, v232
    v_and_or_b32 v211, v211, v231, v232
    buffer_store_dwordx4 v[208:211], v2, s[20:23], s57 offen offset:1024 sc1
    s_waitcnt lgkmcnt(0)
    v_sub_f32 v102, 0, v102
    v_mov_b32 v103, v102
    v_pk_fma_f32 v[32:33], v[64:65], v[102:103], v[32:33]
    v_pk_fma_f32 v[34:35], v[66:67], v[102:103], v[34:35]
    v_pk_fma_f32 v[36:37], v[68:69], v[102:103], v[36:37]
    v_pk_fma_f32 v[38:39], v[70:71], v[102:103], v[38:39]
    v_pk_fma_f32 v[40:41], v[72:73], v[102:103], v[40:41]
    v_pk_fma_f32 v[42:43], v[74:75], v[102:103], v[42:43]
    v_pk_fma_f32 v[44:45], v[76:77], v[102:103], v[44:45]
    v_pk_fma_f32 v[46:47], v[78:79], v[102:103], v[46:47]
    v_pk_mul_f32 v[32:33], v[32:33], v[80:81]
    v_pk_mul_f32 v[34:35], v[34:35], v[82:83]
    v_pk_mul_f32 v[36:37], v[36:37], v[84:85]
    v_pk_mul_f32 v[38:39], v[38:39], v[86:87]
    v_pk_mul_f32 v[40:41], v[40:41], v[88:89]
    v_pk_mul_f32 v[42:43], v[42:43], v[90:91]
    v_pk_mul_f32 v[44:45], v[44:45], v[92:93]
    v_pk_mul_f32 v[46:47], v[46:47], v[94:95]
    v_cvt_pk_bf16_f32 v212, v32, v33
    v_cvt_pk_bf16_f32 v213, v34, v35
    v_cvt_pk_bf16_f32 v214, v36, v37
    v_cvt_pk_bf16_f32 v215, v38, v39
    v_cvt_pk_bf16_f32 v216, v40, v41
    v_cvt_pk_bf16_f32 v217, v42, v43
    v_cvt_pk_bf16_f32 v218, v44, v45
    v_cvt_pk_bf16_f32 v219, v46, v47
    v_and_or_b32 v212, v212, v231, v232
    v_and_or_b32 v213, v213, v231, v232
    v_and_or_b32 v214, v214, v231, v232
    v_and_or_b32 v215, v215, v231, v232
    buffer_store_dwordx4 v[212:215], v2, s[20:23], s58 offen offset:0 sc1
    v_and_or_b32 v216, v216, v231, v232
    v_and_or_b32 v217, v217, v231, v232
    v_and_or_b32 v218, v218, v231, v232
    v_and_or_b32 v219, v219, v231, v232
    buffer_store_dwordx4 v[216:219], v2, s[20:23], s58 offen offset:1024 sc1
    s_waitcnt lgkmcnt(0)
    v_sub_f32 v104, 0, v104
    v_mov_b32 v105, v104
    v_pk_fma_f32 v[48:49], v[64:65], v[104:105], v[48:49]
    v_pk_fma_f32 v[50:51], v[66:67], v[104:105], v[50:51]
    v_pk_fma_f32 v[52:53], v[68:69], v[104:105], v[52:53]
    v_pk_fma_f32 v[54:55], v[70:71], v[104:105], v[54:55]
    v_pk_fma_f32 v[56:57], v[72:73], v[104:105], v[56:57]
    v_pk_fma_f32 v[58:59], v[74:75], v[104:105], v[58:59]
    v_pk_fma_f32 v[60:61], v[76:77], v[104:105], v[60:61]
    v_pk_fma_f32 v[62:63], v[78:79], v[104:105], v[62:63]
    v_pk_mul_f32 v[48:49], v[48:49], v[80:81]
    v_pk_mul_f32 v[50:51], v[50:51], v[82:83]
    v_pk_mul_f32 v[52:53], v[52:53], v[84:85]
    v_pk_mul_f32 v[54:55], v[54:55], v[86:87]
    v_pk_mul_f32 v[56:57], v[56:57], v[88:89]
    v_pk_mul_f32 v[58:59], v[58:59], v[90:91]
    v_pk_mul_f32 v[60:61], v[60:61], v[92:93]
    v_pk_mul_f32 v[62:63], v[62:63], v[94:95]
    v_cvt_pk_bf16_f32 v220, v48, v49
    v_cvt_pk_bf16_f32 v221, v50, v51
    v_cvt_pk_bf16_f32 v222, v52, v53
    v_cvt_pk_bf16_f32 v223, v54, v55
    v_cvt_pk_bf16_f32 v224, v56, v57
    v_cvt_pk_bf16_f32 v225, v58, v59
    v_cvt_pk_bf16_f32 v226, v60, v61
    v_cvt_pk_bf16_f32 v227, v62, v63
    v_and_or_b32 v220, v220, v231, v232
    v_and_or_b32 v221, v221, v231, v232
    v_and_or_b32 v222, v222, v231, v232
    v_and_or_b32 v223, v223, v231, v232
    buffer_store_dwordx4 v[220:223], v2, s[20:23], s59 offen offset:0 sc1
    v_and_or_b32 v224, v224, v231, v232
    v_and_or_b32 v225, v225, v231, v232
    v_and_or_b32 v226, v226, v231, v232
    v_and_or_b32 v227, v227, v231, v232
    buffer_store_dwordx4 v[224:227], v2, s[20:23], s59 offen offset:1024 sc1
L_p1_done:
    s_and_b32 s52, s2, 15
    s_lshr_b32 s53, s2, 4
    s_lshl_b32 s54, s52, 6
    s_lshl_b32 s55, s4, 4
    s_add_u32 s55, s55, s54
    s_lshl_b32 s55, s55, 12
    s_add_u32 s55, s55, 2097152
    s_add_u32 s48, s20, s55
    s_addc_u32 s49, s21, 0
    s_mov_b32 s50, 65536
    s_mov_b32 s51, 0x00020000
    s_lshl_b32 s55, s53, 2
    s_add_u32 s55, s55, s54
    v_lshlrev_b32 v3, 2, v1
    v_mov_b32 v9, 97280
    s_mov_b32 s62, 0
    s_add_u32 s60, s4, 1
    s_and_b32 s60, s60, 3
    s_add_u32 s56, s60, s55
    s_lshl_b32 s56, s56, 11
    s_mul_i32 s60, s60, 12288
    s_add_u32 s60, s60, 98304
    v_add_u32 v216, s60, v2
    s_add_u32 s60, s4, 2
    s_and_b32 s60, s60, 3
    s_add_u32 s57, s60, s55
    s_lshl_b32 s57, s57, 11
    s_mul_i32 s60, s60, 12288
    s_add_u32 s60, s60, 102400
    v_add_u32 v217, s60, v2
    s_add_u32 s60, s4, 3
    s_and_b32 s60, s60, 3
    s_add_u32 s58, s60, s55
    s_lshl_b32 s58, s58, 11
    s_mul_i32 s60, s60, 12288
    s_add_u32 s60, s60, 106496
    v_add_u32 v218, s60, v2
    s_add_u32 s60, s4, 4
    s_and_b32 s60, s60, 3
    s_add_u32 s59, s60, s55
    s_lshl_b32 s59, s59, 11
    s_mul_i32 s60, s60, 12288
    s_add_u32 s60, s60, 98304
    v_add_u32 v219, s60, v2
    s_waitcnt vmcnt(0) lgkmcnt(0)
    s_barrier
    s_mov_b32 s63, s58
    s_lshr_b32 s58, s4, 1
    v_bfe_u32 v9, v1, 2, 2
    v_lshl_add_u32 v10, v13, 2, v9
    v_lshlrev_b32 v10, 7, v10
    v_lshrrev_b32 v9, 1, v9
    v_xor_b32 v9, s58, v9
    v_lshl_add_u32 v10, v9, 6, v10
    v_bfe_u32 v9, v1, 4, 1
    v_lshl_add_u32 v10, v9, 5, v10
    v_and_b32 v9, 1, v1
    v_lshl_add_u32 v10, v9, 4, v10
    v_bfe_u32 v9, v1, 1, 1
    v_lshl_add_u32 v220, v9, 3, v10
    s_lshr_b32 s60, s6, 2
    s_and_b32 s60, s60, 0
    s_mul_i32 s60, s60, 7168
    s_add_u32 s60, s60, 35072
    v_add_u32 v220, s60, v220
    s_mov_b32 s58, s63
    v_mov_b32 v9, 97280
    s_barrier
    ds_read_b32 v5, v9 offset:4
    s_and_b32 s61, s53, 3
    s_mul_i32 s61, s61, 16384
    buffer_load_dwordx4 v[20:23], v2, s[20:23], s56 offen offset:1024 sc1
    buffer_load_dwordx4 v[16:19], v2, s[20:23], s56 offen sc1
    buffer_load_dwordx4 v[152:155], v2, s[48:51], s61 offen offset:0 sc1
    buffer_load_dwordx4 v[156:159], v2, s[48:51], s61 offen offset:1024 sc1
    buffer_load_dwordx4 v[28:31], v2, s[20:23], s57 offen offset:1024 sc1
    buffer_load_dwordx4 v[24:27], v2, s[20:23], s57 offen sc1
    buffer_load_dwordx4 v[160:163], v2, s[48:51], s61 offen offset:2048 sc1
    buffer_load_dwordx4 v[164:167], v2, s[48:51], s61 offen offset:3072 sc1
    buffer_load_dwordx4 v[36:39], v2, s[20:23], s58 offen offset:1024 sc1
    buffer_load_dwordx4 v[32:35], v2, s[20:23], s58 offen sc1
    buffer_load_dwordx4 v[44:47], v2, s[20:23], s59 offen offset:1024 sc1
    buffer_load_dwordx4 v[40:43], v2, s[20:23], s59 offen sc1
    s_add_u32 s61, s61, 4096
    s_and_b32 s61, s61, 0xffff
    buffer_load_dwordx4 v[168:171], v2, s[48:51], s61 offen offset:0 sc1
    buffer_load_dwordx4 v[172:175], v2, s[48:51], s61 offen offset:1024 sc1
    s_waitcnt vmcnt(12) lgkmcnt(0)
    s_mov_b32 exec_lo, 0
    v_lshlrev_b32 v6, 16, v22
    v_mul_f32 v6, v5, v6
    v_add_u32 v6, 0x8000ffff, v6
    v_lshrrev_b32 v22, 16, v6
    s_mov_b32 exec_lo, -1
    s_waitcnt vmcnt(10)
    v_mfma_f32_32x32x16_bf16 v[112:127], v[152:155], v[16:19], 0
    v_mfma_f32_32x32x16_bf16 v[112:127], v[156:159], v[20:23], v[112:127]
    s_waitcnt vmcnt(2)
    s_mov_b32 exec_lo, 0
    v_lshlrev_b32 v6, 16, v30
    v_mul_f32 v6, v5, v6
    v_add_u32 v6, 0x8000ffff, v6
    v_lshrrev_b32 v30, 16, v6
    s_mov_b32 exec_lo, -1
    s_mov_b32 exec_lo, 0
    v_lshlrev_b32 v6, 16, v38
    v_mul_f32 v6, v5, v6
    v_add_u32 v6, 0x8000ffff, v6
    v_lshrrev_b32 v38, 16, v6
    s_mov_b32 exec_lo, -1
    s_mov_b32 exec_lo, 0
    v_lshlrev_b32 v6, 16, v46
    v_mul_f32 v6, v5, v6
    v_add_u32 v6, 0x8000ffff, v6
    v_lshrrev_b32 v46, 16, v6
    s_mov_b32 exec_lo, -1
L_p2_first:
    v_mfma_f32_32x32x16_bf16 v[128:143], v[152:155], v[24:27], 0
    buffer_load_dwordx4 v[176:179], v2, s[48:51], s61 offen offset:2048 sc1
    v_exp_f32 v112, v112
    v_exp_f32 v113, v113
    v_exp_f32 v114, v114
    v_exp_f32 v115, v115
    v_cvt_pk_bf16_f32 v144, v112, v113
    v_cvt_pk_bf16_f32 v145, v114, v115
    buffer_load_dwordx4 v[180:183], v2, s[48:51], s61 offen offset:3072 sc1
    v_exp_f32 v116, v116
    v_exp_f32 v117, v117
    v_exp_f32 v118, v118
    v_exp_f32 v119, v119
    v_cvt_pk_bf16_f32 v146, v116, v117
    v_cvt_pk_bf16_f32 v147, v118, v119
    v_mfma_f32_32x32x16_bf16 v[128:143], v[156:159], v[28:31], v[128:143]
    s_add_u32 s61, s61, 4096
    s_and_b32 s61, s61, 0xffff
    buffer_load_dwordx4 v[184:187], v2, s[48:51], s61 offen offset:0 sc1
    v_exp_f32 v120, v120
    v_exp_f32 v121, v121
    v_exp_f32 v122, v122
    v_exp_f32 v123, v123
    v_cvt_pk_bf16_f32 v148, v120, v121
    v_cvt_pk_bf16_f32 v149, v122, v123
    v_mfma_f32_32x32x16_bf16 v[48:63], v[160:163], v[144:147], 0
    buffer_load_dwordx4 v[188:191], v2, s[48:51], s61 offen offset:1024 sc1
    v_exp_f32 v124, v124
    v_exp_f32 v125, v125
    v_exp_f32 v126, v126
    v_exp_f32 v127, v127
    v_cvt_pk_bf16_f32 v150, v124, v125
    v_cvt_pk_bf16_f32 v151, v126, v127
    v_mfma_f32_32x32x16_bf16 v[112:127], v[152:155], v[32:35], 0
    buffer_load_dwordx4 v[192:195], v2, s[48:51], s61 offen offset:2048 sc1
    v_exp_f32 v128, v128
    v_exp_f32 v129, v129
    v_exp_f32 v130, v130
    v_exp_f32 v131, v131
    v_cvt_pk_bf16_f32 v144, v128, v129
    v_cvt_pk_bf16_f32 v145, v130, v131
    v_mfma_f32_32x32x16_bf16 v[48:63], v[164:167], v[148:151], v[48:63]
    buffer_load_dwordx4 v[196:199], v2, s[48:51], s61 offen offset:3072 sc1
    v_exp_f32 v132, v132
    v_exp_f32 v133, v133
    v_exp_f32 v134, v134
    v_exp_f32 v135, v135
    v_cvt_pk_bf16_f32 v146, v132, v133
    v_cvt_pk_bf16_f32 v147, v134, v135
    v_mfma_f32_32x32x16_bf16 v[112:127], v[156:159], v[36:39], v[112:127]
    s_add_u32 s61, s61, 4096
    s_and_b32 s61, s61, 0xffff
    buffer_load_dwordx4 v[200:203], v2, s[48:51], s61 offen offset:0 sc1
    v_exp_f32 v136, v136
    v_exp_f32 v137, v137
    v_exp_f32 v138, v138
    v_exp_f32 v139, v139
    v_cvt_pk_bf16_f32 v148, v136, v137
    v_cvt_pk_bf16_f32 v149, v138, v139
    v_mfma_f32_32x32x16_bf16 v[64:79], v[160:163], v[144:147], 0
    buffer_load_dwordx4 v[204:207], v2, s[48:51], s61 offen offset:1024 sc1
    v_exp_f32 v140, v140
    v_exp_f32 v141, v141
    v_exp_f32 v142, v142
    v_exp_f32 v143, v143
    v_cvt_pk_bf16_f32 v150, v140, v141
    v_cvt_pk_bf16_f32 v151, v142, v143
    v_mfma_f32_32x32x16_bf16 v[128:143], v[152:155], v[40:43], 0
    buffer_load_dwordx4 v[208:211], v2, s[48:51], s61 offen offset:2048 sc1
    v_exp_f32 v112, v112
    v_exp_f32 v113, v113
    v_exp_f32 v114, v114
    v_exp_f32 v115, v115
    v_cvt_pk_bf16_f32 v144, v112, v113
    v_cvt_pk_bf16_f32 v145, v114, v115
    v_mfma_f32_32x32x16_bf16 v[64:79], v[164:167], v[148:151], v[64:79]
    v_exp_f32 v116, v116
    v_exp_f32 v117, v117
    v_exp_f32 v118, v118
    v_exp_f32 v119, v119
    v_cvt_pk_bf16_f32 v146, v116, v117
    v_cvt_pk_bf16_f32 v147, v118, v119
    v_mfma_f32_32x32x16_bf16 v[128:143], v[156:159], v[44:47], v[128:143]
    buffer_load_dwordx4 v[212:215], v2, s[48:51], s61 offen offset:3072 sc1
    v_exp_f32 v120, v120
    v_exp_f32 v121, v121
    v_exp_f32 v122, v122
    v_exp_f32 v123, v123
    v_cvt_pk_bf16_f32 v148, v120, v121
    v_cvt_pk_bf16_f32 v149, v122, v123
    v_mfma_f32_32x32x16_bf16 v[80:95], v[160:163], v[144:147], 0
    v_exp_f32 v124, v124
    v_exp_f32 v125, v125
    v_exp_f32 v126, v126
    v_exp_f32 v127, v127
    v_cvt_pk_bf16_f32 v150, v124, v125
    v_cvt_pk_bf16_f32 v151, v126, v127
    s_barrier
    s_waitcnt vmcnt(10)
    v_mfma_f32_32x32x16_bf16 v[112:127], v[168:171], v[16:19], 0
    v_exp_f32 v128, v128
    v_exp_f32 v129, v129
    v_exp_f32 v130, v130
    v_exp_f32 v131, v131
    v_cvt_pk_bf16_f32 v144, v128, v129
    v_cvt_pk_bf16_f32 v145, v130, v131
    v_mfma_f32_32x32x16_bf16 v[80:95], v[164:167], v[148:151], v[80:95]
    v_exp_f32 v132, v132
    v_exp_f32 v133, v133
    v_exp_f32 v134, v134
    v_exp_f32 v135, v135
    v_cvt_pk_bf16_f32 v146, v132, v133
    v_cvt_pk_bf16_f32 v147, v134, v135
    v_mfma_f32_32x32x16_bf16 v[112:127], v[172:175], v[20:23], v[112:127]
    s_add_u32 s61, s61, 4096
    s_and_b32 s61, s61, 0xffff
    buffer_load_dwordx4 v[152:155], v2, s[48:51], s61 offen offset:0 sc1
    v_exp_f32 v136, v136
    v_exp_f32 v137, v137
    v_exp_f32 v138, v138
    v_exp_f32 v139, v139
    v_cvt_pk_bf16_f32 v148, v136, v137
    v_cvt_pk_bf16_f32 v149, v138, v139
    v_mfma_f32_32x32x16_bf16 v[96:111], v[160:163], v[144:147], 0
    v_exp_f32 v140, v140
    v_exp_f32 v141, v141
    v_exp_f32 v142, v142
    v_exp_f32 v143, v143
    v_cvt_pk_bf16_f32 v150, v140, v141
    v_cvt_pk_bf16_f32 v151, v142, v143
    v_mfma_f32_32x32x16_bf16 v[128:143], v[168:171], v[24:27], 0
    v_exp_f32 v112, v112
    v_exp_f32 v113, v113
    v_exp_f32 v114, v114
    v_exp_f32 v115, v115
    v_cvt_pk_bf16_f32 v144, v112, v113
    v_cvt_pk_bf16_f32 v145, v114, v115
    v_mfma_f32_32x32x16_bf16 v[96:111], v[164:167], v[148:151], v[96:111]
    v_exp_f32 v116, v116
    v_exp_f32 v117, v117
    v_exp_f32 v118, v118
    v_exp_f32 v119, v119
    v_cvt_pk_bf16_f32 v146, v116, v117
    v_cvt_pk_bf16_f32 v147, v118, v119
    v_mfma_f32_32x32x16_bf16 v[128:143], v[172:175], v[28:31], v[128:143]
    buffer_load_dwordx4 v[156:159], v2, s[48:51], s61 offen offset:1024 sc1
    v_exp_f32 v120, v120
    v_exp_f32 v121, v121
    v_exp_f32 v122, v122
    v_exp_f32 v123, v123
    v_cvt_pk_bf16_f32 v148, v120, v121
    v_cvt_pk_bf16_f32 v149, v122, v123
    s_waitcnt vmcnt(11)
    v_mfma_f32_32x32x16_bf16 v[48:63], v[176:179], v[144:147], v[48:63]
    v_exp_f32 v124, v124
    v_exp_f32 v125, v125
    v_exp_f32 v126, v126
    v_exp_f32 v127, v127
    v_cvt_pk_bf16_f32 v150, v124, v125
    v_cvt_pk_bf16_f32 v151, v126, v127
    v_mfma_f32_32x32x16_bf16 v[112:127], v[168:171], v[32:35], 0
    v_exp_f32 v128, v128
    v_exp_f32 v129, v129
    v_exp_f32 v130, v130
    v_exp_f32 v131, v131
    v_cvt_pk_bf16_f32 v144, v128, v129
    v_cvt_pk_bf16_f32 v145, v130, v131
    s_waitcnt vmcnt(10)
    v_mfma_f32_32x32x16_bf16 v[48:63], v[180:183], v[148:151], v[48:63]
    v_exp_f32 v132, v132
    v_exp_f32 v133, v133
    v_exp_f32 v134, v134
    v_exp_f32 v135, v135
    v_cvt_pk_bf16_f32 v146, v132, v133
    v_cvt_pk_bf16_f32 v147, v134, v135
    v_mfma_f32_32x32x16_bf16 v[112:127], v[172:175], v[36:39], v[112:127]
    buffer_load_dwordx4 v[160:163], v2, s[48:51], s61 offen offset:2048 sc1
    v_exp_f32 v136, v136
    v_exp_f32 v137, v137
    v_exp_f32 v138, v138
    v_exp_f32 v139, v139
    v_cvt_pk_bf16_f32 v148, v136, v137
    v_cvt_pk_bf16_f32 v149, v138, v139
    v_mfma_f32_32x32x16_bf16 v[64:79], v[176:179], v[144:147], v[64:79]
    v_exp_f32 v140, v140
    v_exp_f32 v141, v141
    v_exp_f32 v142, v142
    v_exp_f32 v143, v143
    v_cvt_pk_bf16_f32 v150, v140, v141
    v_cvt_pk_bf16_f32 v151, v142, v143
    v_mfma_f32_32x32x16_bf16 v[128:143], v[168:171], v[40:43], 0
    v_exp_f32 v112, v112
    v_exp_f32 v113, v113
    v_exp_f32 v114, v114
    v_exp_f32 v115, v115
    v_cvt_pk_bf16_f32 v144, v112, v113
    v_cvt_pk_bf16_f32 v145, v114, v115
    v_mfma_f32_32x32x16_bf16 v[64:79], v[180:183], v[148:151], v[64:79]
    v_exp_f32 v116, v116
    v_exp_f32 v117, v117
    v_exp_f32 v118, v118
    v_exp_f32 v119, v119
    v_cvt_pk_bf16_f32 v146, v116, v117
    v_cvt_pk_bf16_f32 v147, v118, v119
    v_mfma_f32_32x32x16_bf16 v[128:143], v[172:175], v[44:47], v[128:143]
    buffer_load_dwordx4 v[164:167], v2, s[48:51], s61 offen offset:3072 sc1
    v_exp_f32 v120, v120
    v_exp_f32 v121, v121
    v_exp_f32 v122, v122
    v_exp_f32 v123, v123
    v_cvt_pk_bf16_f32 v148, v120, v121
    v_cvt_pk_bf16_f32 v149, v122, v123
    v_mfma_f32_32x32x16_bf16 v[80:95], v[176:179], v[144:147], v[80:95]
    v_exp_f32 v124, v124
    v_exp_f32 v125, v125
    v_exp_f32 v126, v126
    v_exp_f32 v127, v127
    v_cvt_pk_bf16_f32 v150, v124, v125
    v_cvt_pk_bf16_f32 v151, v126, v127
    s_waitcnt vmcnt(10)
    v_mfma_f32_32x32x16_bf16 v[112:127], v[184:187], v[16:19], 0
    v_exp_f32 v128, v128
    v_exp_f32 v129, v129
    v_exp_f32 v130, v130
    v_exp_f32 v131, v131
    v_cvt_pk_bf16_f32 v144, v128, v129
    v_cvt_pk_bf16_f32 v145, v130, v131
    v_mfma_f32_32x32x16_bf16 v[80:95], v[180:183], v[148:151], v[80:95]
    v_exp_f32 v132, v132
    v_exp_f32 v133, v133
    v_exp_f32 v134, v134
    v_exp_f32 v135, v135
    v_cvt_pk_bf16_f32 v146, v132, v133
    v_cvt_pk_bf16_f32 v147, v134, v135
    v_mfma_f32_32x32x16_bf16 v[112:127], v[188:191], v[20:23], v[112:127]
    s_add_u32 s61, s61, 4096
    s_and_b32 s61, s61, 0xffff
    buffer_load_dwordx4 v[168:171], v2, s[48:51], s61 offen offset:0 sc1
    v_exp_f32 v136, v136
    v_exp_f32 v137, v137
    v_exp_f32 v138, v138
    v_exp_f32 v139, v139
    v_cvt_pk_bf16_f32 v148, v136, v137
    v_cvt_pk_bf16_f32 v149, v138, v139
    v_mfma_f32_32x32x16_bf16 v[96:111], v[176:179], v[144:147], v[96:111]
    v_exp_f32 v140, v140
    v_exp_f32 v141, v141
    v_exp_f32 v142, v142
    v_exp_f32 v143, v143
    v_cvt_pk_bf16_f32 v150, v140, v141
    v_cvt_pk_bf16_f32 v151, v142, v143
    v_mfma_f32_32x32x16_bf16 v[128:143], v[184:187], v[24:27], 0
    v_exp_f32 v112, v112
    v_exp_f32 v113, v113
    v_exp_f32 v114, v114
    v_exp_f32 v115, v115
    v_cvt_pk_bf16_f32 v144, v112, v113
    v_cvt_pk_bf16_f32 v145, v114, v115
    v_mfma_f32_32x32x16_bf16 v[96:111], v[180:183], v[148:151], v[96:111]
    v_exp_f32 v116, v116
    v_exp_f32 v117, v117
    v_exp_f32 v118, v118
    v_exp_f32 v119, v119
    v_cvt_pk_bf16_f32 v146, v116, v117
    v_cvt_pk_bf16_f32 v147, v118, v119
    v_mfma_f32_32x32x16_bf16 v[128:143], v[188:191], v[28:31], v[128:143]
    buffer_load_dwordx4 v[172:175], v2, s[48:51], s61 offen offset:1024 sc1
    v_exp_f32 v120, v120
    v_exp_f32 v121, v121
    v_exp_f32 v122, v122
    v_exp_f32 v123, v123
    v_cvt_pk_bf16_f32 v148, v120, v121
    v_cvt_pk_bf16_f32 v149, v122, v123
    s_waitcnt vmcnt(11)
    v_mfma_f32_32x32x16_bf16 v[48:63], v[192:195], v[144:147], v[48:63]
    v_exp_f32 v124, v124
    v_exp_f32 v125, v125
    v_exp_f32 v126, v126
    v_exp_f32 v127, v127
    v_cvt_pk_bf16_f32 v150, v124, v125
    v_cvt_pk_bf16_f32 v151, v126, v127
    v_mfma_f32_32x32x16_bf16 v[112:127], v[184:187], v[32:35], 0
    v_exp_f32 v128, v128
    v_exp_f32 v129, v129
    v_exp_f32 v130, v130
    v_exp_f32 v131, v131
    v_cvt_pk_bf16_f32 v144, v128, v129
    v_cvt_pk_bf16_f32 v145, v130, v131
    s_waitcnt vmcnt(10)
    v_mfma_f32_32x32x16_bf16 v[48:63], v[196:199], v[148:151], v[48:63]
    v_exp_f32 v132, v132
    v_exp_f32 v133, v133
    v_exp_f32 v134, v134
    v_exp_f32 v135, v135
    v_cvt_pk_bf16_f32 v146, v132, v133
    v_cvt_pk_bf16_f32 v147, v134, v135
    v_mfma_f32_32x32x16_bf16 v[112:127], v[188:191], v[36:39], v[112:127]
    buffer_load_dwordx4 v[176:179], v2, s[48:51], s61 offen offset:2048 sc1
    v_exp_f32 v136, v136
    v_exp_f32 v137, v137
    v_exp_f32 v138, v138
    v_exp_f32 v139, v139
    v_cvt_pk_bf16_f32 v148, v136, v137
    v_cvt_pk_bf16_f32 v149, v138, v139
    v_mfma_f32_32x32x16_bf16 v[64:79], v[192:195], v[144:147], v[64:79]
    v_exp_f32 v140, v140
    v_exp_f32 v141, v141
    v_exp_f32 v142, v142
    v_exp_f32 v143, v143
    v_cvt_pk_bf16_f32 v150, v140, v141
    v_cvt_pk_bf16_f32 v151, v142, v143
    v_mfma_f32_32x32x16_bf16 v[128:143], v[184:187], v[40:43], 0
    v_exp_f32 v112, v112
    v_exp_f32 v113, v113
    v_exp_f32 v114, v114
    v_exp_f32 v115, v115
    v_cvt_pk_bf16_f32 v144, v112, v113
    v_cvt_pk_bf16_f32 v145, v114, v115
    v_mfma_f32_32x32x16_bf16 v[64:79], v[196:199], v[148:151], v[64:79]
    v_exp_f32 v116, v116
    v_exp_f32 v117, v117
    v_exp_f32 v118, v118
    v_exp_f32 v119, v119
    v_cvt_pk_bf16_f32 v146, v116, v117
    v_cvt_pk_bf16_f32 v147, v118, v119
    v_mfma_f32_32x32x16_bf16 v[128:143], v[188:191], v[44:47], v[128:143]
    buffer_load_dwordx4 v[180:183], v2, s[48:51], s61 offen offset:3072 sc1
    v_exp_f32 v120, v120
    v_exp_f32 v121, v121
    v_exp_f32 v122, v122
    v_exp_f32 v123, v123
    v_cvt_pk_bf16_f32 v148, v120, v121
    v_cvt_pk_bf16_f32 v149, v122, v123
    v_mfma_f32_32x32x16_bf16 v[80:95], v[192:195], v[144:147], v[80:95]
    v_exp_f32 v124, v124
    v_exp_f32 v125, v125
    v_exp_f32 v126, v126
    v_exp_f32 v127, v127
    v_cvt_pk_bf16_f32 v150, v124, v125
    v_cvt_pk_bf16_f32 v151, v126, v127
    s_waitcnt vmcnt(10)
    v_mfma_f32_32x32x16_bf16 v[112:127], v[200:203], v[16:19], 0
    v_exp_f32 v128, v128
    v_exp_f32 v129, v129
    v_exp_f32 v130, v130
    v_exp_f32 v131, v131
    v_cvt_pk_bf16_f32 v144, v128, v129
    v_cvt_pk_bf16_f32 v145, v130, v131
    v_mfma_f32_32x32x16_bf16 v[80:95], v[196:199], v[148:151], v[80:95]
    v_exp_f32 v132, v132
    v_exp_f32 v133, v133
    v_exp_f32 v134, v134
    v_exp_f32 v135, v135
    v_cvt_pk_bf16_f32 v146, v132, v133
    v_cvt_pk_bf16_f32 v147, v134, v135
    v_mfma_f32_32x32x16_bf16 v[112:127], v[204:207], v[20:23], v[112:127]
    s_add_u32 s61, s61, 4096
    s_and_b32 s61, s61, 0xffff
    buffer_load_dwordx4 v[184:187], v2, s[48:51], s61 offen offset:0 sc1
    v_exp_f32 v136, v136
    v_exp_f32 v137, v137
    v_exp_f32 v138, v138
    v_exp_f32 v139, v139
    v_cvt_pk_bf16_f32 v148, v136, v137
    v_cvt_pk_bf16_f32 v149, v138, v139
    v_mfma_f32_32x32x16_bf16 v[96:111], v[192:195], v[144:147], v[96:111]
    v_exp_f32 v140, v140
    v_exp_f32 v141, v141
    v_exp_f32 v142, v142
    v_exp_f32 v143, v143
    v_cvt_pk_bf16_f32 v150, v140, v141
    v_cvt_pk_bf16_f32 v151, v142, v143
    v_mfma_f32_32x32x16_bf16 v[128:143], v[200:203], v[24:27], 0
    v_exp_f32 v112, v112
    v_exp_f32 v113, v113
    v_exp_f32 v114, v114
    v_exp_f32 v115, v115
    v_cvt_pk_bf16_f32 v144, v112, v113
    v_cvt_pk_bf16_f32 v145, v114, v115
    v_mfma_f32_32x32x16_bf16 v[96:111], v[196:199], v[148:151], v[96:111]
    v_exp_f32 v116, v116
    v_exp_f32 v117, v117
    v_exp_f32 v118, v118
    v_exp_f32 v119, v119
    v_cvt_pk_bf16_f32 v146, v116, v117
    v_cvt_pk_bf16_f32 v147, v118, v119
    v_mfma_f32_32x32x16_bf16 v[128:143], v[204:207], v[28:31], v[128:143]
    buffer_load_dwordx4 v[188:191], v2, s[48:51], s61 offen offset:1024 sc1
    v_exp_f32 v120, v120
    v_exp_f32 v121, v121
    v_exp_f32 v122, v122
    v_exp_f32 v123, v123
    v_cvt_pk_bf16_f32 v148, v120, v121
    v_cvt_pk_bf16_f32 v149, v122, v123
    s_waitcnt vmcnt(11)
    v_mfma_f32_32x32x16_bf16 v[48:63], v[208:211], v[144:147], v[48:63]
    v_exp_f32 v124, v124
    v_exp_f32 v125, v125
    v_exp_f32 v126, v126
    v_exp_f32 v127, v127
    v_cvt_pk_bf16_f32 v150, v124, v125
    v_cvt_pk_bf16_f32 v151, v126, v127
    v_mfma_f32_32x32x16_bf16 v[112:127], v[200:203], v[32:35], 0
    v_exp_f32 v128, v128
    v_exp_f32 v129, v129
    v_exp_f32 v130, v130
    v_exp_f32 v131, v131
    v_cvt_pk_bf16_f32 v144, v128, v129
    v_cvt_pk_bf16_f32 v145, v130, v131
    s_waitcnt vmcnt(10)
    v_mfma_f32_32x32x16_bf16 v[48:63], v[212:215], v[148:151], v[48:63]
    v_exp_f32 v132, v132
    v_exp_f32 v133, v133
    v_exp_f32 v134, v134
    v_exp_f32 v135, v135
    v_cvt_pk_bf16_f32 v146, v132, v133
    v_cvt_pk_bf16_f32 v147, v134, v135
    v_mfma_f32_32x32x16_bf16 v[112:127], v[204:207], v[36:39], v[112:127]
    buffer_load_dwordx4 v[192:195], v2, s[48:51], s61 offen offset:2048 sc1
    v_exp_f32 v136, v136
    v_exp_f32 v137, v137
    v_exp_f32 v138, v138
    v_exp_f32 v139, v139
    v_cvt_pk_bf16_f32 v148, v136, v137
    v_cvt_pk_bf16_f32 v149, v138, v139
    v_mfma_f32_32x32x16_bf16 v[64:79], v[208:211], v[144:147], v[64:79]
    v_exp_f32 v140, v140
    v_exp_f32 v141, v141
    v_exp_f32 v142, v142
    v_exp_f32 v143, v143
    v_cvt_pk_bf16_f32 v150, v140, v141
    v_cvt_pk_bf16_f32 v151, v142, v143
    v_mfma_f32_32x32x16_bf16 v[128:143], v[200:203], v[40:43], 0
    v_exp_f32 v112, v112
    v_exp_f32 v113, v113
    v_exp_f32 v114, v114
    v_exp_f32 v115, v115
    v_cvt_pk_bf16_f32 v144, v112, v113
    v_cvt_pk_bf16_f32 v145, v114, v115
    v_mfma_f32_32x32x16_bf16 v[64:79], v[212:215], v[148:151], v[64:79]
    v_exp_f32 v116, v116
    v_exp_f32 v117, v117
    v_exp_f32 v118, v118
    v_exp_f32 v119, v119
    v_cvt_pk_bf16_f32 v146, v116, v117
    v_cvt_pk_bf16_f32 v147, v118, v119
    v_mfma_f32_32x32x16_bf16 v[128:143], v[204:207], v[44:47], v[128:143]
    buffer_load_dwordx4 v[196:199], v2, s[48:51], s61 offen offset:3072 sc1
    v_exp_f32 v120, v120
    v_exp_f32 v121, v121
    v_exp_f32 v122, v122
    v_exp_f32 v123, v123
    v_cvt_pk_bf16_f32 v148, v120, v121
    v_cvt_pk_bf16_f32 v149, v122, v123
    v_mfma_f32_32x32x16_bf16 v[80:95], v[208:211], v[144:147], v[80:95]
    v_exp_f32 v124, v124
    v_exp_f32 v125, v125
    v_exp_f32 v126, v126
    v_exp_f32 v127, v127
    v_cvt_pk_bf16_f32 v150, v124, v125
    v_cvt_pk_bf16_f32 v151, v126, v127
    s_waitcnt vmcnt(10)
    v_mfma_f32_32x32x16_bf16 v[112:127], v[152:155], v[16:19], 0
    v_exp_f32 v128, v128
    v_exp_f32 v129, v129
    v_exp_f32 v130, v130
    v_exp_f32 v131, v131
    v_cvt_pk_bf16_f32 v144, v128, v129
    v_cvt_pk_bf16_f32 v145, v130, v131
    v_mfma_f32_32x32x16_bf16 v[80:95], v[212:215], v[148:151], v[80:95]
    v_exp_f32 v132, v132
    v_exp_f32 v133, v133
    v_exp_f32 v134, v134
    v_exp_f32 v135, v135
    v_cvt_pk_bf16_f32 v146, v132, v133
    v_cvt_pk_bf16_f32 v147, v134, v135
    v_mfma_f32_32x32x16_bf16 v[112:127], v[156:159], v[20:23], v[112:127]
    s_add_u32 s61, s61, 4096
    s_and_b32 s61, s61, 0xffff
    buffer_load_dwordx4 v[200:203], v2, s[48:51], s61 offen offset:0 sc1
    v_exp_f32 v136, v136
    v_exp_f32 v137, v137
    v_exp_f32 v138, v138
    v_exp_f32 v139, v139
    v_cvt_pk_bf16_f32 v148, v136, v137
    v_cvt_pk_bf16_f32 v149, v138, v139
    v_mfma_f32_32x32x16_bf16 v[96:111], v[208:211], v[144:147], v[96:111]
    v_exp_f32 v140, v140
    v_exp_f32 v141, v141
    v_exp_f32 v142, v142
    v_exp_f32 v143, v143
    v_cvt_pk_bf16_f32 v150, v140, v141
    v_cvt_pk_bf16_f32 v151, v142, v143
    s_mov_b32 s63, 0
L_p2_loop:
    v_mfma_f32_32x32x16_bf16 v[128:143], v[152:155], v[24:27], 0
    v_exp_f32 v112, v112
    v_exp_f32 v113, v113
    v_exp_f32 v114, v114
    v_exp_f32 v115, v115
    v_cvt_pk_bf16_f32 v144, v112, v113
    v_cvt_pk_bf16_f32 v145, v114, v115
    v_mfma_f32_32x32x16_bf16 v[96:111], v[212:215], v[148:151], v[96:111]
    v_exp_f32 v116, v116
    v_exp_f32 v117, v117
    v_exp_f32 v118, v118
    v_exp_f32 v119, v119
    v_cvt_pk_bf16_f32 v146, v116, v117
    v_cvt_pk_bf16_f32 v147, v118, v119
    v_mfma_f32_32x32x16_bf16 v[128:143], v[156:159], v[28:31], v[128:143]
    buffer_load_dwordx4 v[204:207], v2, s[48:51], s61 offen offset:1024 sc1
    v_exp_f32 v120, v120
    v_exp_f32 v121, v121
    v_exp_f32 v122, v122
    v_exp_f32 v123, v123
    v_cvt_pk_bf16_f32 v148, v120, v121
    v_cvt_pk_bf16_f32 v149, v122, v123
    s_waitcnt vmcnt(11)
    v_mfma_f32_32x32x16_bf16 v[48:63], v[160:163], v[144:147], v[48:63]
    v_exp_f32 v124, v124
    v_exp_f32 v125, v125
    v_exp_f32 v126, v126
    v_exp_f32 v127, v127
    v_cvt_pk_bf16_f32 v150, v124, v125
    v_cvt_pk_bf16_f32 v151, v126, v127
    v_mfma_f32_32x32x16_bf16 v[112:127], v[152:155], v[32:35], 0
    v_exp_f32 v128, v128
    v_exp_f32 v129, v129
    v_exp_f32 v130, v130
    v_exp_f32 v131, v131
    v_cvt_pk_bf16_f32 v144, v128, v129
    v_cvt_pk_bf16_f32 v145, v130, v131
    s_waitcnt vmcnt(10)
    v_mfma_f32_32x32x16_bf16 v[48:63], v[164:167], v[148:151], v[48:63]
    v_exp_f32 v132, v132
    v_exp_f32 v133, v133
    v_exp_f32 v134, v134
    v_exp_f32 v135, v135
    v_cvt_pk_bf16_f32 v146, v132, v133
    v_cvt_pk_bf16_f32 v147, v134, v135
    v_mfma_f32_32x32x16_bf16 v[112:127], v[156:159], v[36:39], v[112:127]
    buffer_load_dwordx4 v[208:211], v2, s[48:51], s61 offen offset:2048 sc1
    v_exp_f32 v136, v136
    v_exp_f32 v137, v137
    v_exp_f32 v138, v138
    v_exp_f32 v139, v139
    v_cvt_pk_bf16_f32 v148, v136, v137
    v_cvt_pk_bf16_f32 v149, v138, v139
    v_mfma_f32_32x32x16_bf16 v[64:79], v[160:163], v[144:147], v[64:79]
    v_exp_f32 v140, v140
    v_exp_f32 v141, v141
    v_exp_f32 v142, v142
    v_exp_f32 v143, v143
    v_cvt_pk_bf16_f32 v150, v140, v141
    v_cvt_pk_bf16_f32 v151, v142, v143
    v_mfma_f32_32x32x16_bf16 v[128:143], v[152:155], v[40:43], 0
    v_exp_f32 v112, v112
    v_exp_f32 v113, v113
    v_exp_f32 v114, v114
    v_exp_f32 v115, v115
    v_cvt_pk_bf16_f32 v144, v112, v113
    v_cvt_pk_bf16_f32 v145, v114, v115
    v_mfma_f32_32x32x16_bf16 v[64:79], v[164:167], v[148:151], v[64:79]
    v_exp_f32 v116, v116
    v_exp_f32 v117, v117
    v_exp_f32 v118, v118
    v_exp_f32 v119, v119
    v_cvt_pk_bf16_f32 v146, v116, v117
    v_cvt_pk_bf16_f32 v147, v118, v119
    v_mfma_f32_32x32x16_bf16 v[128:143], v[156:159], v[44:47], v[128:143]
    buffer_load_dwordx4 v[212:215], v2, s[48:51], s61 offen offset:3072 sc1
    v_exp_f32 v120, v120
    v_exp_f32 v121, v121
    v_exp_f32 v122, v122
    v_exp_f32 v123, v123
    v_cvt_pk_bf16_f32 v148, v120, v121
    v_cvt_pk_bf16_f32 v149, v122, v123
    v_mfma_f32_32x32x16_bf16 v[80:95], v[160:163], v[144:147], v[80:95]
    v_exp_f32 v124, v124
    v_exp_f32 v125, v125
    v_exp_f32 v126, v126
    v_exp_f32 v127, v127
    v_cvt_pk_bf16_f32 v150, v124, v125
    v_cvt_pk_bf16_f32 v151, v126, v127
    s_waitcnt vmcnt(10)
    v_mfma_f32_32x32x16_bf16 v[112:127], v[168:171], v[16:19], 0
    v_exp_f32 v128, v128
    v_exp_f32 v129, v129
    v_exp_f32 v130, v130
    v_exp_f32 v131, v131
    v_cvt_pk_bf16_f32 v144, v128, v129
    v_cvt_pk_bf16_f32 v145, v130, v131
    v_mfma_f32_32x32x16_bf16 v[80:95], v[164:167], v[148:151], v[80:95]
    v_exp_f32 v132, v132
    v_exp_f32 v133, v133
    v_exp_f32 v134, v134
    v_exp_f32 v135, v135
    v_cvt_pk_bf16_f32 v146, v132, v133
    v_cvt_pk_bf16_f32 v147, v134, v135
    v_mfma_f32_32x32x16_bf16 v[112:127], v[172:175], v[20:23], v[112:127]
    s_add_u32 s61, s61, 4096
    s_and_b32 s61, s61, 0xffff
    buffer_load_dwordx4 v[152:155], v2, s[48:51], s61 offen offset:0 sc1
    v_exp_f32 v136, v136
    v_exp_f32 v137, v137
    v_exp_f32 v138, v138
    v_exp_f32 v139, v139
    v_cvt_pk_bf16_f32 v148, v136, v137
    v_cvt_pk_bf16_f32 v149, v138, v139
    v_mfma_f32_32x32x16_bf16 v[96:111], v[160:163], v[144:147], v[96:111]
    v_exp_f32 v140, v140
    v_exp_f32 v141, v141
    v_exp_f32 v142, v142
    v_exp_f32 v143, v143
    v_cvt_pk_bf16_f32 v150, v140, v141
    v_cvt_pk_bf16_f32 v151, v142, v143
    v_mfma_f32_32x32x16_bf16 v[128:143], v[168:171], v[24:27], 0
    v_exp_f32 v112, v112
    v_exp_f32 v113, v113
    v_exp_f32 v114, v114
    v_exp_f32 v115, v115
    v_cvt_pk_bf16_f32 v144, v112, v113
    v_cvt_pk_bf16_f32 v145, v114, v115
    v_mfma_f32_32x32x16_bf16 v[96:111], v[164:167], v[148:151], v[96:111]
    v_exp_f32 v116, v116
    v_exp_f32 v117, v117
    v_exp_f32 v118, v118
    v_exp_f32 v119, v119
    v_cvt_pk_bf16_f32 v146, v116, v117
    v_cvt_pk_bf16_f32 v147, v118, v119
    v_mfma_f32_32x32x16_bf16 v[128:143], v[172:175], v[28:31], v[128:143]
    buffer_load_dwordx4 v[156:159], v2, s[48:51], s61 offen offset:1024 sc1
    v_exp_f32 v120, v120
    v_exp_f32 v121, v121
    v_exp_f32 v122, v122
    v_exp_f32 v123, v123
    v_cvt_pk_bf16_f32 v148, v120, v121
    v_cvt_pk_bf16_f32 v149, v122, v123
    s_waitcnt vmcnt(11)
    v_mfma_f32_32x32x16_bf16 v[48:63], v[176:179], v[144:147], v[48:63]
    v_exp_f32 v124, v124
    v_exp_f32 v125, v125
    v_exp_f32 v126, v126
    v_exp_f32 v127, v127
    v_cvt_pk_bf16_f32 v150, v124, v125
    v_cvt_pk_bf16_f32 v151, v126, v127
    v_mfma_f32_32x32x16_bf16 v[112:127], v[168:171], v[32:35], 0
    v_exp_f32 v128, v128
    v_exp_f32 v129, v129
    v_exp_f32 v130, v130
    v_exp_f32 v131, v131
    v_cvt_pk_bf16_f32 v144, v128, v129
    v_cvt_pk_bf16_f32 v145, v130, v131
    s_waitcnt vmcnt(10)
    v_mfma_f32_32x32x16_bf16 v[48:63], v[180:183], v[148:151], v[48:63]
    v_exp_f32 v132, v132
    v_exp_f32 v133, v133
    v_exp_f32 v134, v134
    v_exp_f32 v135, v135
    v_cvt_pk_bf16_f32 v146, v132, v133
    v_cvt_pk_bf16_f32 v147, v134, v135
    v_mfma_f32_32x32x16_bf16 v[112:127], v[172:175], v[36:39], v[112:127]
    buffer_load_dwordx4 v[160:163], v2, s[48:51], s61 offen offset:2048 sc1
    v_exp_f32 v136, v136
    v_exp_f32 v137, v137
    v_exp_f32 v138, v138
    v_exp_f32 v139, v139
    v_cvt_pk_bf16_f32 v148, v136, v137
    v_cvt_pk_bf16_f32 v149, v138, v139
    v_mfma_f32_32x32x16_bf16 v[64:79], v[176:179], v[144:147], v[64:79]
    v_exp_f32 v140, v140
    v_exp_f32 v141, v141
    v_exp_f32 v142, v142
    v_exp_f32 v143, v143
    v_cvt_pk_bf16_f32 v150, v140, v141
    v_cvt_pk_bf16_f32 v151, v142, v143
    v_mfma_f32_32x32x16_bf16 v[128:143], v[168:171], v[40:43], 0
    v_exp_f32 v112, v112
    v_exp_f32 v113, v113
    v_exp_f32 v114, v114
    v_exp_f32 v115, v115
    v_cvt_pk_bf16_f32 v144, v112, v113
    v_cvt_pk_bf16_f32 v145, v114, v115
    v_mfma_f32_32x32x16_bf16 v[64:79], v[180:183], v[148:151], v[64:79]
    v_exp_f32 v116, v116
    v_exp_f32 v117, v117
    v_exp_f32 v118, v118
    v_exp_f32 v119, v119
    v_cvt_pk_bf16_f32 v146, v116, v117
    v_cvt_pk_bf16_f32 v147, v118, v119
    v_mfma_f32_32x32x16_bf16 v[128:143], v[172:175], v[44:47], v[128:143]
    buffer_load_dwordx4 v[164:167], v2, s[48:51], s61 offen offset:3072 sc1
    v_exp_f32 v120, v120
    v_exp_f32 v121, v121
    v_exp_f32 v122, v122
    v_exp_f32 v123, v123
    v_cvt_pk_bf16_f32 v148, v120, v121
    v_cvt_pk_bf16_f32 v149, v122, v123
    v_mfma_f32_32x32x16_bf16 v[80:95], v[176:179], v[144:147], v[80:95]
    v_exp_f32 v124, v124
    v_exp_f32 v125, v125
    v_exp_f32 v126, v126
    v_exp_f32 v127, v127
    v_cvt_pk_bf16_f32 v150, v124, v125
    v_cvt_pk_bf16_f32 v151, v126, v127
    s_waitcnt vmcnt(10)
    v_mfma_f32_32x32x16_bf16 v[112:127], v[184:187], v[16:19], 0
    v_exp_f32 v128, v128
    v_exp_f32 v129, v129
    v_exp_f32 v130, v130
    v_exp_f32 v131, v131
    v_cvt_pk_bf16_f32 v144, v128, v129
    v_cvt_pk_bf16_f32 v145, v130, v131
    v_mfma_f32_32x32x16_bf16 v[80:95], v[180:183], v[148:151], v[80:95]
    v_exp_f32 v132, v132
    v_exp_f32 v133, v133
    v_exp_f32 v134, v134
    v_exp_f32 v135, v135
    v_cvt_pk_bf16_f32 v146, v132, v133
    v_cvt_pk_bf16_f32 v147, v134, v135
    v_mfma_f32_32x32x16_bf16 v[112:127], v[188:191], v[20:23], v[112:127]
    s_add_u32 s61, s61, 4096
    s_and_b32 s61, s61, 0xffff
    buffer_load_dwordx4 v[168:171], v2, s[48:51], s61 offen offset:0 sc1
    v_exp_f32 v136, v136
    v_exp_f32 v137, v137
    v_exp_f32 v138, v138
    v_exp_f32 v139, v139
    v_cvt_pk_bf16_f32 v148, v136, v137
    v_cvt_pk_bf16_f32 v149, v138, v139
    v_mfma_f32_32x32x16_bf16 v[96:111], v[176:179], v[144:147], v[96:111]
    v_exp_f32 v140, v140
    v_exp_f32 v141, v141
    v_exp_f32 v142, v142
    v_exp_f32 v143, v143
    v_cvt_pk_bf16_f32 v150, v140, v141
    v_cvt_pk_bf16_f32 v151, v142, v143
    v_mfma_f32_32x32x16_bf16 v[128:143], v[184:187], v[24:27], 0
    v_exp_f32 v112, v112
    v_exp_f32 v113, v113
    v_exp_f32 v114, v114
    v_exp_f32 v115, v115
    v_cvt_pk_bf16_f32 v144, v112, v113
    v_cvt_pk_bf16_f32 v145, v114, v115
    v_mfma_f32_32x32x16_bf16 v[96:111], v[180:183], v[148:151], v[96:111]
    v_exp_f32 v116, v116
    v_exp_f32 v117, v117
    v_exp_f32 v118, v118
    v_exp_f32 v119, v119
    v_cvt_pk_bf16_f32 v146, v116, v117
    v_cvt_pk_bf16_f32 v147, v118, v119
    v_mfma_f32_32x32x16_bf16 v[128:143], v[188:191], v[28:31], v[128:143]
    buffer_load_dwordx4 v[172:175], v2, s[48:51], s61 offen offset:1024 sc1
    v_exp_f32 v120, v120
    v_exp_f32 v121, v121
    v_exp_f32 v122, v122
    v_exp_f32 v123, v123
    v_cvt_pk_bf16_f32 v148, v120, v121
    v_cvt_pk_bf16_f32 v149, v122, v123
    s_waitcnt vmcnt(11)
    v_mfma_f32_32x32x16_bf16 v[48:63], v[192:195], v[144:147], v[48:63]
    v_exp_f32 v124, v124
    v_exp_f32 v125, v125
    v_exp_f32 v126, v126
    v_exp_f32 v127, v127
    v_cvt_pk_bf16_f32 v150, v124, v125
    v_cvt_pk_bf16_f32 v151, v126, v127
    v_mfma_f32_32x32x16_bf16 v[112:127], v[184:187], v[32:35], 0
    v_exp_f32 v128, v128
    v_exp_f32 v129, v129
    v_exp_f32 v130, v130
    v_exp_f32 v131, v131
    v_cvt_pk_bf16_f32 v144, v128, v129
    v_cvt_pk_bf16_f32 v145, v130, v131
    s_waitcnt vmcnt(10)
    v_mfma_f32_32x32x16_bf16 v[48:63], v[196:199], v[148:151], v[48:63]
    v_exp_f32 v132, v132
    v_exp_f32 v133, v133
    v_exp_f32 v134, v134
    v_exp_f32 v135, v135
    v_cvt_pk_bf16_f32 v146, v132, v133
    v_cvt_pk_bf16_f32 v147, v134, v135
    v_mfma_f32_32x32x16_bf16 v[112:127], v[188:191], v[36:39], v[112:127]
    buffer_load_dwordx4 v[176:179], v2, s[48:51], s61 offen offset:2048 sc1
    v_exp_f32 v136, v136
    v_exp_f32 v137, v137
    v_exp_f32 v138, v138
    v_exp_f32 v139, v139
    v_cvt_pk_bf16_f32 v148, v136, v137
    v_cvt_pk_bf16_f32 v149, v138, v139
    v_mfma_f32_32x32x16_bf16 v[64:79], v[192:195], v[144:147], v[64:79]
    v_exp_f32 v140, v140
    v_exp_f32 v141, v141
    v_exp_f32 v142, v142
    v_exp_f32 v143, v143
    v_cvt_pk_bf16_f32 v150, v140, v141
    v_cvt_pk_bf16_f32 v151, v142, v143
    v_mfma_f32_32x32x16_bf16 v[128:143], v[184:187], v[40:43], 0
    v_exp_f32 v112, v112
    v_exp_f32 v113, v113
    v_exp_f32 v114, v114
    v_exp_f32 v115, v115
    v_cvt_pk_bf16_f32 v144, v112, v113
    v_cvt_pk_bf16_f32 v145, v114, v115
    v_mfma_f32_32x32x16_bf16 v[64:79], v[196:199], v[148:151], v[64:79]
    v_exp_f32 v116, v116
    v_exp_f32 v117, v117
    v_exp_f32 v118, v118
    v_exp_f32 v119, v119
    v_cvt_pk_bf16_f32 v146, v116, v117
    v_cvt_pk_bf16_f32 v147, v118, v119
    v_mfma_f32_32x32x16_bf16 v[128:143], v[188:191], v[44:47], v[128:143]
    buffer_load_dwordx4 v[180:183], v2, s[48:51], s61 offen offset:3072 sc1
    v_exp_f32 v120, v120
    v_exp_f32 v121, v121
    v_exp_f32 v122, v122
    v_exp_f32 v123, v123
    v_cvt_pk_bf16_f32 v148, v120, v121
    v_cvt_pk_bf16_f32 v149, v122, v123
    v_mfma_f32_32x32x16_bf16 v[80:95], v[192:195], v[144:147], v[80:95]
    v_exp_f32 v124, v124
    v_exp_f32 v125, v125
    v_exp_f32 v126, v126
    v_exp_f32 v127, v127
    v_cvt_pk_bf16_f32 v150, v124, v125
    v_cvt_pk_bf16_f32 v151, v126, v127
    s_waitcnt vmcnt(10)
    v_mfma_f32_32x32x16_bf16 v[112:127], v[200:203], v[16:19], 0
    v_exp_f32 v128, v128
    v_exp_f32 v129, v129
    v_exp_f32 v130, v130
    v_exp_f32 v131, v131
    v_cvt_pk_bf16_f32 v144, v128, v129
    v_cvt_pk_bf16_f32 v145, v130, v131
    v_mfma_f32_32x32x16_bf16 v[80:95], v[196:199], v[148:151], v[80:95]
    v_exp_f32 v132, v132
    v_exp_f32 v133, v133
    v_exp_f32 v134, v134
    v_exp_f32 v135, v135
    v_cvt_pk_bf16_f32 v146, v132, v133
    v_cvt_pk_bf16_f32 v147, v134, v135
    v_mfma_f32_32x32x16_bf16 v[112:127], v[204:207], v[20:23], v[112:127]
    s_add_u32 s61, s61, 4096
    s_and_b32 s61, s61, 0xffff
    buffer_load_dwordx4 v[184:187], v2, s[48:51], s61 offen offset:0 sc1
    v_exp_f32 v136, v136
    v_exp_f32 v137, v137
    v_exp_f32 v138, v138
    v_exp_f32 v139, v139
    v_cvt_pk_bf16_f32 v148, v136, v137
    v_cvt_pk_bf16_f32 v149, v138, v139
    v_mfma_f32_32x32x16_bf16 v[96:111], v[192:195], v[144:147], v[96:111]
    v_exp_f32 v140, v140
    v_exp_f32 v141, v141
    v_exp_f32 v142, v142
    v_exp_f32 v143, v143
    v_cvt_pk_bf16_f32 v150, v140, v141
    v_cvt_pk_bf16_f32 v151, v142, v143
    v_mfma_f32_32x32x16_bf16 v[128:143], v[200:203], v[24:27], 0
    v_exp_f32 v112, v112
    v_exp_f32 v113, v113
    v_exp_f32 v114, v114
    v_exp_f32 v115, v115
    v_cvt_pk_bf16_f32 v144, v112, v113
    v_cvt_pk_bf16_f32 v145, v114, v115
    v_mfma_f32_32x32x16_bf16 v[96:111], v[196:199], v[148:151], v[96:111]
    v_exp_f32 v116, v116
    v_exp_f32 v117, v117
    v_exp_f32 v118, v118
    v_exp_f32 v119, v119
    v_cvt_pk_bf16_f32 v146, v116, v117
    v_cvt_pk_bf16_f32 v147, v118, v119
    v_mfma_f32_32x32x16_bf16 v[128:143], v[204:207], v[28:31], v[128:143]
    buffer_load_dwordx4 v[188:191], v2, s[48:51], s61 offen offset:1024 sc1
    v_exp_f32 v120, v120
    v_exp_f32 v121, v121
    v_exp_f32 v122, v122
    v_exp_f32 v123, v123
    v_cvt_pk_bf16_f32 v148, v120, v121
    v_cvt_pk_bf16_f32 v149, v122, v123
    s_waitcnt vmcnt(11)
    v_mfma_f32_32x32x16_bf16 v[48:63], v[208:211], v[144:147], v[48:63]
    v_exp_f32 v124, v124
    v_exp_f32 v125, v125
    v_exp_f32 v126, v126
    v_exp_f32 v127, v127
    v_cvt_pk_bf16_f32 v150, v124, v125
    v_cvt_pk_bf16_f32 v151, v126, v127
    v_mfma_f32_32x32x16_bf16 v[112:127], v[200:203], v[32:35], 0
    v_exp_f32 v128, v128
    v_exp_f32 v129, v129
    v_exp_f32 v130, v130
    v_exp_f32 v131, v131
    v_cvt_pk_bf16_f32 v144, v128, v129
    v_cvt_pk_bf16_f32 v145, v130, v131
    s_waitcnt vmcnt(10)
    v_mfma_f32_32x32x16_bf16 v[48:63], v[212:215], v[148:151], v[48:63]
    v_exp_f32 v132, v132
    v_exp_f32 v133, v133
    v_exp_f32 v134, v134
    v_exp_f32 v135, v135
    v_cvt_pk_bf16_f32 v146, v132, v133
    v_cvt_pk_bf16_f32 v147, v134, v135
    v_mfma_f32_32x32x16_bf16 v[112:127], v[204:207], v[36:39], v[112:127]
    buffer_load_dwordx4 v[192:195], v2, s[48:51], s61 offen offset:2048 sc1
    v_exp_f32 v136, v136
    v_exp_f32 v137, v137
    v_exp_f32 v138, v138
    v_exp_f32 v139, v139
    v_cvt_pk_bf16_f32 v148, v136, v137
    v_cvt_pk_bf16_f32 v149, v138, v139
    v_mfma_f32_32x32x16_bf16 v[64:79], v[208:211], v[144:147], v[64:79]
    v_exp_f32 v140, v140
    v_exp_f32 v141, v141
    v_exp_f32 v142, v142
    v_exp_f32 v143, v143
    v_cvt_pk_bf16_f32 v150, v140, v141
    v_cvt_pk_bf16_f32 v151, v142, v143
    v_mfma_f32_32x32x16_bf16 v[128:143], v[200:203], v[40:43], 0
    v_exp_f32 v112, v112
    v_exp_f32 v113, v113
    v_exp_f32 v114, v114
    v_exp_f32 v115, v115
    v_cvt_pk_bf16_f32 v144, v112, v113
    v_cvt_pk_bf16_f32 v145, v114, v115
    v_mfma_f32_32x32x16_bf16 v[64:79], v[212:215], v[148:151], v[64:79]
    v_exp_f32 v116, v116
    v_exp_f32 v117, v117
    v_exp_f32 v118, v118
    v_exp_f32 v119, v119
    v_cvt_pk_bf16_f32 v146, v116, v117
    v_cvt_pk_bf16_f32 v147, v118, v119
    v_mfma_f32_32x32x16_bf16 v[128:143], v[204:207], v[44:47], v[128:143]
    buffer_load_dwordx4 v[196:199], v2, s[48:51], s61 offen offset:3072 sc1
    v_exp_f32 v120, v120
    v_exp_f32 v121, v121
    v_exp_f32 v122, v122
    v_exp_f32 v123, v123
    v_cvt_pk_bf16_f32 v148, v120, v121
    v_cvt_pk_bf16_f32 v149, v122, v123
    v_mfma_f32_32x32x16_bf16 v[80:95], v[208:211], v[144:147], v[80:95]
    v_exp_f32 v124, v124
    v_exp_f32 v125, v125
    v_exp_f32 v126, v126
    v_exp_f32 v127, v127
    v_cvt_pk_bf16_f32 v150, v124, v125
    v_cvt_pk_bf16_f32 v151, v126, v127
    s_waitcnt vmcnt(10)
    v_mfma_f32_32x32x16_bf16 v[112:127], v[152:155], v[16:19], 0
    v_exp_f32 v128, v128
    v_exp_f32 v129, v129
    v_exp_f32 v130, v130
    v_exp_f32 v131, v131
    v_cvt_pk_bf16_f32 v144, v128, v129
    v_cvt_pk_bf16_f32 v145, v130, v131
    v_mfma_f32_32x32x16_bf16 v[80:95], v[212:215], v[148:151], v[80:95]
    v_exp_f32 v132, v132
    v_exp_f32 v133, v133
    v_exp_f32 v134, v134
    v_exp_f32 v135, v135
    v_cvt_pk_bf16_f32 v146, v132, v133
    v_cvt_pk_bf16_f32 v147, v134, v135
    v_mfma_f32_32x32x16_bf16 v[112:127], v[156:159], v[20:23], v[112:127]
    s_add_u32 s61, s61, 4096
    s_and_b32 s61, s61, 0xffff
    buffer_load_dwordx4 v[200:203], v2, s[48:51], s61 offen offset:0 sc1
    v_exp_f32 v136, v136
    v_exp_f32 v137, v137
    v_exp_f32 v138, v138
    v_exp_f32 v139, v139
    v_cvt_pk_bf16_f32 v148, v136, v137
    v_cvt_pk_bf16_f32 v149, v138, v139
    v_mfma_f32_32x32x16_bf16 v[96:111], v[208:211], v[144:147], v[96:111]
    v_exp_f32 v140, v140
    v_exp_f32 v141, v141
    v_exp_f32 v142, v142
    v_exp_f32 v143, v143
    v_cvt_pk_bf16_f32 v150, v140, v141
    v_cvt_pk_bf16_f32 v151, v142, v143
    s_add_u32 s63, s63, 1
    s_cmp_lt_u32 s63, 2
    s_cbranch_scc1 L_p2_loop
L_p2_lastb:
    v_mfma_f32_32x32x16_bf16 v[128:143], v[152:155], v[24:27], 0
    v_exp_f32 v112, v112
    v_exp_f32 v113, v113
    v_exp_f32 v114, v114
    v_exp_f32 v115, v115
    v_cvt_pk_bf16_f32 v144, v112, v113
    v_cvt_pk_bf16_f32 v145, v114, v115
    v_mfma_f32_32x32x16_bf16 v[96:111], v[212:215], v[148:151], v[96:111]
    v_exp_f32 v116, v116
    v_exp_f32 v117, v117
    v_exp_f32 v118, v118
    v_exp_f32 v119, v119
    v_cvt_pk_bf16_f32 v146, v116, v117
    v_cvt_pk_bf16_f32 v147, v118, v119
    v_mfma_f32_32x32x16_bf16 v[128:143], v[156:159], v[28:31], v[128:143]
    buffer_load_dwordx4 v[204:207], v2, s[48:51], s61 offen offset:1024 sc1
    v_exp_f32 v120, v120
    v_exp_f32 v121, v121
    v_exp_f32 v122, v122
    v_exp_f32 v123, v123
    v_cvt_pk_bf16_f32 v148, v120, v121
    v_cvt_pk_bf16_f32 v149, v122, v123
    s_waitcnt vmcnt(11)
    v_mfma_f32_32x32x16_bf16 v[48:63], v[160:163], v[144:147], v[48:63]
    v_exp_f32 v124, v124
    v_exp_f32 v125, v125
    v_exp_f32 v126, v126
    v_exp_f32 v127, v127
    v_cvt_pk_bf16_f32 v150, v124, v125
    v_cvt_pk_bf16_f32 v151, v126, v127
    v_mfma_f32_32x32x16_bf16 v[112:127], v[152:155], v[32:35], 0
    v_exp_f32 v128, v128
    v_exp_f32 v129, v129
    v_exp_f32 v130, v130
    v_exp_f32 v131, v131
    v_cvt_pk_bf16_f32 v144, v128, v129
    v_cvt_pk_bf16_f32 v145, v130, v131
    s_waitcnt vmcnt(10)
    v_mfma_f32_32x32x16_bf16 v[48:63], v[164:167], v[148:151], v[48:63]
    v_exp_f32 v132, v132
    v_exp_f32 v133, v133
    v_exp_f32 v134, v134
    v_exp_f32 v135, v135
    v_cvt_pk_bf16_f32 v146, v132, v133
    v_cvt_pk_bf16_f32 v147, v134, v135
    v_mfma_f32_32x32x16_bf16 v[112:127], v[156:159], v[36:39], v[112:127]
    buffer_load_dwordx4 v[208:211], v2, s[48:51], s61 offen offset:2048 sc1
    v_exp_f32 v136, v136
    v_exp_f32 v137, v137
    v_exp_f32 v138, v138
    v_exp_f32 v139, v139
    v_cvt_pk_bf16_f32 v148, v136, v137
    v_cvt_pk_bf16_f32 v149, v138, v139
    v_mfma_f32_32x32x16_bf16 v[64:79], v[160:163], v[144:147], v[64:79]
    v_exp_f32 v140, v140
    v_exp_f32 v141, v141
    v_exp_f32 v142, v142
    v_exp_f32 v143, v143
    v_cvt_pk_bf16_f32 v150, v140, v141
    v_cvt_pk_bf16_f32 v151, v142, v143
    v_mfma_f32_32x32x16_bf16 v[128:143], v[152:155], v[40:43], 0
    v_exp_f32 v112, v112
    v_exp_f32 v113, v113
    v_exp_f32 v114, v114
    v_exp_f32 v115, v115
    v_cvt_pk_bf16_f32 v144, v112, v113
    v_cvt_pk_bf16_f32 v145, v114, v115
    v_mfma_f32_32x32x16_bf16 v[64:79], v[164:167], v[148:151], v[64:79]
    v_exp_f32 v116, v116
    v_exp_f32 v117, v117
    v_exp_f32 v118, v118
    v_exp_f32 v119, v119
    v_cvt_pk_bf16_f32 v146, v116, v117
    v_cvt_pk_bf16_f32 v147, v118, v119
    v_mfma_f32_32x32x16_bf16 v[128:143], v[156:159], v[44:47], v[128:143]
    buffer_load_dwordx4 v[212:215], v2, s[48:51], s61 offen offset:3072 sc1
    v_exp_f32 v120, v120
    v_exp_f32 v121, v121
    v_exp_f32 v122, v122
    v_exp_f32 v123, v123
    v_cvt_pk_bf16_f32 v148, v120, v121
    v_cvt_pk_bf16_f32 v149, v122, v123
    v_mfma_f32_32x32x16_bf16 v[80:95], v[160:163], v[144:147], v[80:95]
    v_exp_f32 v124, v124
    v_exp_f32 v125, v125
    v_exp_f32 v126, v126
    v_exp_f32 v127, v127
    v_cvt_pk_bf16_f32 v150, v124, v125
    v_cvt_pk_bf16_f32 v151, v126, v127
    s_waitcnt vmcnt(10)
    v_mfma_f32_32x32x16_bf16 v[112:127], v[168:171], v[16:19], 0
    v_exp_f32 v128, v128
    v_exp_f32 v129, v129
    v_exp_f32 v130, v130
    v_exp_f32 v131, v131
    v_cvt_pk_bf16_f32 v144, v128, v129
    v_cvt_pk_bf16_f32 v145, v130, v131
    v_mfma_f32_32x32x16_bf16 v[80:95], v[164:167], v[148:151], v[80:95]
    v_exp_f32 v132, v132
    v_exp_f32 v133, v133
    v_exp_f32 v134, v134
    v_exp_f32 v135, v135
    v_cvt_pk_bf16_f32 v146, v132, v133
    v_cvt_pk_bf16_f32 v147, v134, v135
    v_mfma_f32_32x32x16_bf16 v[112:127], v[172:175], v[20:23], v[112:127]
    v_exp_f32 v136, v136
    v_exp_f32 v137, v137
    v_exp_f32 v138, v138
    v_exp_f32 v139, v139
    v_cvt_pk_bf16_f32 v148, v136, v137
    v_cvt_pk_bf16_f32 v149, v138, v139
    v_mfma_f32_32x32x16_bf16 v[96:111], v[160:163], v[144:147], v[96:111]
    v_exp_f32 v140, v140
    v_exp_f32 v141, v141
    v_exp_f32 v142, v142
    v_exp_f32 v143, v143
    v_cvt_pk_bf16_f32 v150, v140, v141
    v_cvt_pk_bf16_f32 v151, v142, v143
    v_mfma_f32_32x32x16_bf16 v[128:143], v[168:171], v[24:27], 0
    v_exp_f32 v112, v112
    v_exp_f32 v113, v113
    v_exp_f32 v114, v114
    v_exp_f32 v115, v115
    v_cvt_pk_bf16_f32 v144, v112, v113
    v_cvt_pk_bf16_f32 v145, v114, v115
    v_mfma_f32_32x32x16_bf16 v[96:111], v[164:167], v[148:151], v[96:111]
    v_exp_f32 v116, v116
    v_exp_f32 v117, v117
    v_exp_f32 v118, v118
    v_exp_f32 v119, v119
    v_cvt_pk_bf16_f32 v146, v116, v117
    v_cvt_pk_bf16_f32 v147, v118, v119
    v_mfma_f32_32x32x16_bf16 v[128:143], v[172:175], v[28:31], v[128:143]
    v_exp_f32 v120, v120
    v_exp_f32 v121, v121
    v_exp_f32 v122, v122
    v_exp_f32 v123, v123
    v_cvt_pk_bf16_f32 v148, v120, v121
    v_cvt_pk_bf16_f32 v149, v122, v123
    s_waitcnt vmcnt(9)
    v_mfma_f32_32x32x16_bf16 v[48:63], v[176:179], v[144:147], v[48:63]
    v_exp_f32 v124, v124
    v_exp_f32 v125, v125
    v_exp_f32 v126, v126
    v_exp_f32 v127, v127
    v_cvt_pk_bf16_f32 v150, v124, v125
    v_cvt_pk_bf16_f32 v151, v126, v127
    v_mfma_f32_32x32x16_bf16 v[112:127], v[168:171], v[32:35], 0
    v_exp_f32 v128, v128
    v_exp_f32 v129, v129
    v_exp_f32 v130, v130
    v_exp_f32 v131, v131
    v_cvt_pk_bf16_f32 v144, v128, v129
    v_cvt_pk_bf16_f32 v145, v130, v131
    s_waitcnt vmcnt(8)
    v_mfma_f32_32x32x16_bf16 v[48:63], v[180:183], v[148:151], v[48:63]
    v_exp_f32 v132, v132
    v_exp_f32 v133, v133
    v_exp_f32 v134, v134
    v_exp_f32 v135, v135
    v_cvt_pk_bf16_f32 v146, v132, v133
    v_cvt_pk_bf16_f32 v147, v134, v135
    v_mfma_f32_32x32x16_bf16 v[112:127], v[172:175], v[36:39], v[112:127]
    v_exp_f32 v136, v136
    v_exp_f32 v137, v137
    v_exp_f32 v138, v138
    v_exp_f32 v139, v139
    v_cvt_pk_bf16_f32 v148, v136, v137
    v_cvt_pk_bf16_f32 v149, v138, v139
    v_mfma_f32_32x32x16_bf16 v[64:79], v[176:179], v[144:147], v[64:79]
    v_exp_f32 v140, v140
    v_exp_f32 v141, v141
    v_exp_f32 v142, v142
    v_exp_f32 v143, v143
    v_cvt_pk_bf16_f32 v150, v140, v141
    v_cvt_pk_bf16_f32 v151, v142, v143
    v_mfma_f32_32x32x16_bf16 v[128:143], v[168:171], v[40:43], 0
    v_exp_f32 v112, v112
    v_exp_f32 v113, v113
    v_exp_f32 v114, v114
    v_exp_f32 v115, v115
    v_cvt_pk_bf16_f32 v144, v112, v113
    v_cvt_pk_bf16_f32 v145, v114, v115
    v_mfma_f32_32x32x16_bf16 v[64:79], v[180:183], v[148:151], v[64:79]
    v_exp_f32 v116, v116
    v_exp_f32 v117, v117
    v_exp_f32 v118, v118
    v_exp_f32 v119, v119
    v_cvt_pk_bf16_f32 v146, v116, v117
    v_cvt_pk_bf16_f32 v147, v118, v119
    v_mfma_f32_32x32x16_bf16 v[128:143], v[172:175], v[44:47], v[128:143]
    v_exp_f32 v120, v120
    v_exp_f32 v121, v121
    v_exp_f32 v122, v122
    v_exp_f32 v123, v123
    v_cvt_pk_bf16_f32 v148, v120, v121
    v_cvt_pk_bf16_f32 v149, v122, v123
    v_mfma_f32_32x32x16_bf16 v[80:95], v[176:179], v[144:147], v[80:95]
    v_exp_f32 v124, v124
    v_exp_f32 v125, v125
    v_exp_f32 v126, v126
    v_exp_f32 v127, v127
    v_cvt_pk_bf16_f32 v150, v124, v125
    v_cvt_pk_bf16_f32 v151, v126, v127
    s_waitcnt vmcnt(6)
    v_mfma_f32_32x32x16_bf16 v[112:127], v[184:187], v[16:19], 0
    v_exp_f32 v128, v128
    v_exp_f32 v129, v129
    v_exp_f32 v130, v130
    v_exp_f32 v131, v131
    v_cvt_pk_bf16_f32 v144, v128, v129
    v_cvt_pk_bf16_f32 v145, v130, v131
    v_mfma_f32_32x32x16_bf16 v[80:95], v[180:183], v[148:151], v[80:95]
    v_exp_f32 v132, v132
    v_exp_f32 v133, v133
    v_exp_f32 v134, v134
    v_exp_f32 v135, v135
    v_cvt_pk_bf16_f32 v146, v132, v133
    v_cvt_pk_bf16_f32 v147, v134, v135
    v_mfma_f32_32x32x16_bf16 v[112:127], v[188:191], v[20:23], v[112:127]
    v_exp_f32 v136, v136
    v_exp_f32 v137, v137
    v_exp_f32 v138, v138
    v_exp_f32 v139, v139
    v_cvt_pk_bf16_f32 v148, v136, v137
    v_cvt_pk_bf16_f32 v149, v138, v139
    v_mfma_f32_32x32x16_bf16 v[96:111], v[176:179], v[144:147], v[96:111]
    v_exp_f32 v140, v140
    v_exp_f32 v141, v141
    v_exp_f32 v142, v142
    v_exp_f32 v143, v143
    v_cvt_pk_bf16_f32 v150, v140, v141
    v_cvt_pk_bf16_f32 v151, v142, v143
    s_barrier
    v_mfma_f32_32x32x16_bf16 v[128:143], v[184:187], v[24:27], 0
    v_exp_f32 v112, v112
    v_exp_f32 v113, v113
    v_exp_f32 v114, v114
    v_exp_f32 v115, v115
    v_cvt_pk_bf16_f32 v144, v112, v113
    v_cvt_pk_bf16_f32 v145, v114, v115
    v_mfma_f32_32x32x16_bf16 v[96:111], v[180:183], v[148:151], v[96:111]
    v_exp_f32 v116, v116
    v_exp_f32 v117, v117
    v_exp_f32 v118, v118
    v_exp_f32 v119, v119
    v_cvt_pk_bf16_f32 v146, v116, v117
    v_cvt_pk_bf16_f32 v147, v118, v119
    v_mfma_f32_32x32x16_bf16 v[128:143], v[188:191], v[28:31], v[128:143]
    v_exp_f32 v120, v120
    v_exp_f32 v121, v121
    v_exp_f32 v122, v122
    v_exp_f32 v123, v123
    v_cvt_pk_bf16_f32 v148, v120, v121
    v_cvt_pk_bf16_f32 v149, v122, v123
    s_waitcnt vmcnt(5)
    v_mfma_f32_32x32x16_bf16 v[48:63], v[192:195], v[144:147], v[48:63]
    v_exp_f32 v124, v124
    v_exp_f32 v125, v125
    v_exp_f32 v126, v126
    v_exp_f32 v127, v127
    v_cvt_pk_bf16_f32 v150, v124, v125
    v_cvt_pk_bf16_f32 v151, v126, v127
    v_mfma_f32_32x32x16_bf16 v[112:127], v[184:187], v[32:35], 0
    v_exp_f32 v128, v128
    v_exp_f32 v129, v129
    v_exp_f32 v130, v130
    v_exp_f32 v131, v131
    v_cvt_pk_bf16_f32 v144, v128, v129
    v_cvt_pk_bf16_f32 v145, v130, v131
    s_waitcnt vmcnt(4)
    v_mfma_f32_32x32x16_bf16 v[48:63], v[196:199], v[148:151], v[48:63]
    v_exp_f32 v132, v132
    v_exp_f32 v133, v133
    v_exp_f32 v134, v134
    v_exp_f32 v135, v135
    v_cvt_pk_bf16_f32 v146, v132, v133
    v_cvt_pk_bf16_f32 v147, v134, v135
    v_mfma_f32_32x32x16_bf16 v[112:127], v[188:191], v[36:39], v[112:127]
    v_exp_f32 v136, v136
    v_exp_f32 v137, v137
    v_exp_f32 v138, v138
    v_exp_f32 v139, v139
    v_cvt_pk_bf16_f32 v148, v136, v137
    v_cvt_pk_bf16_f32 v149, v138, v139
    v_mfma_f32_32x32x16_bf16 v[64:79], v[192:195], v[144:147], v[64:79]
    v_exp_f32 v140, v140
    v_exp_f32 v141, v141
    v_exp_f32 v142, v142
    v_exp_f32 v143, v143
    v_cvt_pk_bf16_f32 v150, v140, v141
    v_cvt_pk_bf16_f32 v151, v142, v143
    v_mfma_f32_32x32x16_bf16 v[128:143], v[184:187], v[40:43], 0
    v_exp_f32 v112, v112
    v_exp_f32 v113, v113
    v_exp_f32 v114, v114
    v_exp_f32 v115, v115
    v_cvt_pk_bf16_f32 v144, v112, v113
    v_cvt_pk_bf16_f32 v145, v114, v115
    v_mfma_f32_32x32x16_bf16 v[64:79], v[196:199], v[148:151], v[64:79]
    v_exp_f32 v116, v116
    v_exp_f32 v117, v117
    v_exp_f32 v118, v118
    v_exp_f32 v119, v119
    v_cvt_pk_bf16_f32 v146, v116, v117
    v_cvt_pk_bf16_f32 v147, v118, v119
    v_mfma_f32_32x32x16_bf16 v[128:143], v[188:191], v[44:47], v[128:143]
    v_exp_f32 v120, v120
    v_exp_f32 v121, v121
    v_exp_f32 v122, v122
    v_exp_f32 v123, v123
    v_cvt_pk_bf16_f32 v148, v120, v121
    v_cvt_pk_bf16_f32 v149, v122, v123
    v_mfma_f32_32x32x16_bf16 v[80:95], v[192:195], v[144:147], v[80:95]
    v_exp_f32 v124, v124
    v_exp_f32 v125, v125
    v_exp_f32 v126, v126
    v_exp_f32 v127, v127
    v_cvt_pk_bf16_f32 v150, v124, v125
    v_cvt_pk_bf16_f32 v151, v126, v127
    s_waitcnt vmcnt(2)
    v_mfma_f32_32x32x16_bf16 v[112:127], v[200:203], v[16:19], 0
    v_exp_f32 v128, v128
    v_exp_f32 v129, v129
    v_exp_f32 v130, v130
    v_exp_f32 v131, v131
    v_cvt_pk_bf16_f32 v144, v128, v129
    v_cvt_pk_bf16_f32 v145, v130, v131
    v_mfma_f32_32x32x16_bf16 v[80:95], v[196:199], v[148:151], v[80:95]
    v_exp_f32 v132, v132
    v_exp_f32 v133, v133
    v_exp_f32 v134, v134
    v_exp_f32 v135, v135
    v_cvt_pk_bf16_f32 v146, v132, v133
    v_cvt_pk_bf16_f32 v147, v134, v135
    v_mfma_f32_32x32x16_bf16 v[112:127], v[204:207], v[20:23], v[112:127]
    v_exp_f32 v136, v136
    v_exp_f32 v137, v137
    v_exp_f32 v138, v138
    v_exp_f32 v139, v139
    v_cvt_pk_bf16_f32 v148, v136, v137
    v_cvt_pk_bf16_f32 v149, v138, v139
    v_mfma_f32_32x32x16_bf16 v[96:111], v[192:195], v[144:147], v[96:111]
    v_exp_f32 v140, v140
    v_exp_f32 v141, v141
    v_exp_f32 v142, v142
    v_exp_f32 v143, v143
    v_cvt_pk_bf16_f32 v150, v140, v141
    v_cvt_pk_bf16_f32 v151, v142, v143
    v_mfma_f32_32x32x16_bf16 v[128:143], v[200:203], v[24:27], 0
    v_exp_f32 v112, v112
    v_exp_f32 v113, v113
    v_exp_f32 v114, v114
    v_exp_f32 v115, v115
    v_cvt_pk_bf16_f32 v144, v112, v113
    v_cvt_pk_bf16_f32 v145, v114, v115
    v_mfma_f32_32x32x16_bf16 v[96:111], v[196:199], v[148:151], v[96:111]
    v_exp_f32 v116, v116
    v_exp_f32 v117, v117
    v_exp_f32 v118, v118
    v_exp_f32 v119, v119
    v_cvt_pk_bf16_f32 v146, v116, v117
    v_cvt_pk_bf16_f32 v147, v118, v119
    v_mfma_f32_32x32x16_bf16 v[128:143], v[204:207], v[28:31], v[128:143]
    v_exp_f32 v120, v120
    v_exp_f32 v121, v121
    v_exp_f32 v122, v122
    v_exp_f32 v123, v123
    v_cvt_pk_bf16_f32 v148, v120, v121
    v_cvt_pk_bf16_f32 v149, v122, v123
    s_waitcnt vmcnt(1)
    v_mfma_f32_32x32x16_bf16 v[48:63], v[208:211], v[144:147], v[48:63]
    v_exp_f32 v124, v124
    v_exp_f32 v125, v125
    v_exp_f32 v126, v126
    v_exp_f32 v127, v127
    v_cvt_pk_bf16_f32 v150, v124, v125
    v_cvt_pk_bf16_f32 v151, v126, v127
    v_mfma_f32_32x32x16_bf16 v[112:127], v[200:203], v[32:35], 0
    v_exp_f32 v128, v128
    v_exp_f32 v129, v129
    v_exp_f32 v130, v130
    v_exp_f32 v131, v131
    v_cvt_pk_bf16_f32 v144, v128, v129
    v_cvt_pk_bf16_f32 v145, v130, v131
    s_waitcnt vmcnt(0)
    v_mfma_f32_32x32x16_bf16 v[48:63], v[212:215], v[148:151], v[48:63]
    v_exp_f32 v132, v132
    v_exp_f32 v133, v133
    v_exp_f32 v134, v134
    v_exp_f32 v135, v135
    v_cvt_pk_bf16_f32 v146, v132, v133
    v_cvt_pk_bf16_f32 v147, v134, v135
    v_mfma_f32_32x32x16_bf16 v[112:127], v[204:207], v[36:39], v[112:127]
    v_exp_f32 v136, v136
    v_exp_f32 v137, v137
    v_exp_f32 v138, v138
    v_exp_f32 v139, v139
    v_cvt_pk_bf16_f32 v148, v136, v137
    v_cvt_pk_bf16_f32 v149, v138, v139
    v_mfma_f32_32x32x16_bf16 v[64:79], v[208:211], v[144:147], v[64:79]
    v_exp_f32 v140, v140
    v_exp_f32 v141, v141
    v_exp_f32 v142, v142
    v_exp_f32 v143, v143
    v_cvt_pk_bf16_f32 v150, v140, v141
    v_cvt_pk_bf16_f32 v151, v142, v143
    v_mfma_f32_32x32x16_bf16 v[128:143], v[200:203], v[40:43], 0
    ds_write_b128 v216, v[48:51] offset:0
    v_exp_f32 v112, v112
    v_exp_f32 v113, v113
    v_exp_f32 v114, v114
    v_exp_f32 v115, v115
    v_cvt_pk_bf16_f32 v144, v112, v113
    v_cvt_pk_bf16_f32 v145, v114, v115
    v_mfma_f32_32x32x16_bf16 v[64:79], v[212:215], v[148:151], v[64:79]
    ds_write_b128 v216, v[52:55] offset:1024
    v_exp_f32 v116, v116
    v_exp_f32 v117, v117
    v_exp_f32 v118, v118
    v_exp_f32 v119, v119
    v_cvt_pk_bf16_f32 v146, v116, v117
    v_cvt_pk_bf16_f32 v147, v118, v119
    v_mfma_f32_32x32x16_bf16 v[128:143], v[204:207], v[44:47], v[128:143]
    ds_write_b128 v216, v[56:59] offset:2048
    v_exp_f32 v120, v120
    v_exp_f32 v121, v121
    v_exp_f32 v122, v122
    v_exp_f32 v123, v123
    v_cvt_pk_bf16_f32 v148, v120, v121
    v_cvt_pk_bf16_f32 v149, v122, v123
    v_mfma_f32_32x32x16_bf16 v[80:95], v[208:211], v[144:147], v[80:95]
    ds_write_b128 v216, v[60:63] offset:3072
    v_exp_f32 v124, v124
    v_exp_f32 v125, v125
    v_exp_f32 v126, v126
    v_exp_f32 v127, v127
    v_cvt_pk_bf16_f32 v150, v124, v125
    v_cvt_pk_bf16_f32 v151, v126, v127
    ds_write_b128 v217, v[64:67] offset:0
    v_exp_f32 v128, v128
    v_exp_f32 v129, v129
    v_exp_f32 v130, v130
    v_exp_f32 v131, v131
    v_cvt_pk_bf16_f32 v144, v128, v129
    v_cvt_pk_bf16_f32 v145, v130, v131
    v_mfma_f32_32x32x16_bf16 v[80:95], v[212:215], v[148:151], v[80:95]
    ds_write_b128 v217, v[68:71] offset:1024
    v_exp_f32 v132, v132
    v_exp_f32 v133, v133
    v_exp_f32 v134, v134
    v_exp_f32 v135, v135
    v_cvt_pk_bf16_f32 v146, v132, v133
    v_cvt_pk_bf16_f32 v147, v134, v135
    ds_write_b128 v217, v[72:75] offset:2048
    v_exp_f32 v136, v136
    v_exp_f32 v137, v137
    v_exp_f32 v138, v138
    v_exp_f32 v139, v139
    v_cvt_pk_bf16_f32 v148, v136, v137
    v_cvt_pk_bf16_f32 v149, v138, v139
    v_mfma_f32_32x32x16_bf16 v[96:111], v[208:211], v[144:147], v[96:111]
    ds_write_b128 v217, v[76:79] offset:3072
    v_exp_f32 v140, v140
    v_exp_f32 v141, v141
    v_exp_f32 v142, v142
    v_exp_f32 v143, v143
    v_cvt_pk_bf16_f32 v150, v140, v141
    v_cvt_pk_bf16_f32 v151, v142, v143
    s_nop 1
    v_mfma_f32_32x32x16_bf16 v[96:111], v[212:215], v[148:151], v[96:111]
    ds_write_b128 v218, v[80:83] offset:0
    ds_write_b128 v218, v[84:87] offset:1024
    ds_write_b128 v218, v[88:91] offset:2048
    ds_write_b128 v218, v[92:95] offset:3072
    s_lshl_b32 s60, s53, 2
    s_add_u32 s60, s60, s4
    s_lshl_b32 s60, s60, 15
    s_lshl_b32 s61, s52, 11
    s_add_u32 s60, s60, s61
    s_add_u32 s60, s60, 7340032
    v_mov_b32 v6, 0x1f800000
    v_mov_b32 v7, 0x5f800000
    s_waitcnt lgkmcnt(0)
    s_barrier
    ds_read_b128 v[48:51], v219 offset:0
    ds_read_b128 v[52:55], v219 offset:1024
    ds_read_b128 v[56:59], v219 offset:2048
    ds_read_b128 v[60:63], v219 offset:3072
    ds_read_b128 v[64:67], v219 offset:4096
    ds_read_b128 v[68:71], v219 offset:5120
    ds_read_b128 v[72:75], v219 offset:6144
    ds_read_b128 v[76:79], v219 offset:7168
    ds_read_b128 v[80:83], v219 offset:8192
    ds_read_b128 v[84:87], v219 offset:9216
    ds_read_b128 v[88:91], v219 offset:10240
    ds_read_b128 v[92:95], v219 offset:11264
    s_waitcnt lgkmcnt(8)
    v_pk_add_f32 v[96:97], v[96:97], v[48:49]
    v_pk_add_f32 v[98:99], v[98:99], v[50:51]
    v_pk_add_f32 v[100:101], v[100:101], v[52:53]
    v_pk_add_f32 v[102:103], v[102:103], v[54:55]
    v_pk_add_f32 v[104:105], v[104:105], v[56:57]
    v_pk_add_f32 v[106:107], v[106:107], v[58:59]
    v_pk_add_f32 v[108:109], v[108:109], v[60:61]
    v_pk_add_f32 v[110:111], v[110:111], v[62:63]
    s_waitcnt lgkmcnt(4)
    v_pk_add_f32 v[96:97], v[96:97], v[64:65]
    v_pk_add_f32 v[98:99], v[98:99], v[66:67]
    v_pk_add_f32 v[100:101], v[100:101], v[68:69]
    v_pk_add_f32 v[102:103], v[102:103], v[70:71]
    v_pk_add_f32 v[104:105], v[104:105], v[72:73]
    v_pk_add_f32 v[106:107], v[106:107], v[74:75]
    v_pk_add_f32 v[108:109], v[108:109], v[76:77]
    v_pk_add_f32 v[110:111], v[110:111], v[78:79]
    s_waitcnt lgkmcnt(0)
    v_pk_add_f32 v[96:97], v[96:97], v[80:81]
    v_pk_add_f32 v[98:99], v[98:99], v[82:83]
    v_pk_add_f32 v[100:101], v[100:101], v[84:85]
    v_pk_add_f32 v[102:103], v[102:103], v[86:87]
    v_pk_add_f32 v[104:105], v[104:105], v[88:89]
    v_pk_add_f32 v[106:107], v[106:107], v[90:91]
    v_pk_add_f32 v[108:109], v[108:109], v[92:93]
    v_pk_add_f32 v[110:111], v[110:111], v[94:95]
    v_mov_b32 v10, v108
    v_mov_b32 v11, v108
    s_nop 1
    v_permlane32_swap_b32 v10, v11
    v_rcp_f32 v10, v11
    v_cmp_nge_f32 vcc, v11, v6
    v_cmp_gt_f32 s[58:59], v11, v7
    v_mov_b32 v11, v10
    v_pk_mul_f32 v[96:97], v[96:97], v[10:11]
    v_pk_mul_f32 v[98:99], v[98:99], v[10:11]
    v_pk_mul_f32 v[100:101], v[100:101], v[10:11]
    v_pk_mul_f32 v[102:103], v[102:103], v[10:11]
    v_pk_mul_f32 v[104:105], v[104:105], v[10:11]
    v_pk_mul_f32 v[106:107], v[106:107], v[10:11]
    v_pk_mul_f32 v[108:109], v[108:109], v[10:11]
    v_pk_mul_f32 v[110:111], v[110:111], v[10:11]
    v_cvt_pk_bf16_f32 v144, v96, v97
    v_cvt_pk_bf16_f32 v145, v98, v99
    v_cvt_pk_bf16_f32 v146, v100, v101
    v_cvt_pk_bf16_f32 v147, v102, v103
    v_cvt_pk_bf16_f32 v148, v104, v105
    v_cvt_pk_bf16_f32 v149, v106, v107
    v_cvt_pk_bf16_f32 v150, v108, v109
    v_cvt_pk_bf16_f32 v151, v110, v111
    buffer_store_dwordx4 v[144:147], v2, s[20:23], s60 offen sc1
    s_mov_b32 exec_lo, 0
    v_mov_b32 v150, 0
    v_mov_b32 v151, 0
    s_mov_b32 exec_lo, -1
    buffer_store_dwordx4 v[148:151], v2, s[20:23], s60 offen offset:1024 sc1
    s_or_b64 vcc, vcc, s[58:59]
    s_cbranch_scc0 L_p2_ok
    v_mov_b32 v10, 1
    ds_write_b32 v9, v10
L_p2_ok:
    s_waitcnt lgkmcnt(0)
    s_barrier
    ds_read_b32 v14, v9
    s_cmp_ge_u32 s6, 28
    s_cbranch_scc1 L_p3_skipA
    s_lshr_b32 s58, s6, 2
    s_and_b32 s58, s58, 0
    ds_read_b64_tr_b16 v[64:65], v220 offset:0
    ds_read_b64_tr_b16 v[66:67], v220 offset:1024
    ds_read_b64_tr_b16 v[68:69], v220 offset:2048
    ds_read_b64_tr_b16 v[70:71], v220 offset:3072
    ds_read_b64_tr_b16 v[72:73], v220 offset:3584
    ds_read_b64_tr_b16 v[74:75], v220 offset:4608
    ds_read_b64_tr_b16 v[76:77], v220 offset:5632
    ds_read_b64_tr_b16 v[78:79], v220 offset:6656
    s_waitcnt lgkmcnt(6)
    ds_read_b64_tr_b16 v[80:81], v220 offset:7168
    ds_read_b64_tr_b16 v[82:83], v220 offset:8192
    ds_read_b64_tr_b16 v[84:85], v220 offset:9216
    ds_read_b64_tr_b16 v[86:87], v220 offset:10240
    ds_read_b64_tr_b16 v[88:89], v220 offset:10752
    ds_read_b64_tr_b16 v[90:91], v220 offset:11776
    ds_read_b64_tr_b16 v[92:93], v220 offset:12800
    ds_read_b64_tr_b16 v[94:95], v220 offset:13824
    s_waitcnt lgkmcnt(6)
    s_cmp_ge_u32 s58, 6
    s_cselect_b32 s59, 0xffff2000, 0
    v_add_u32 v221, s59, v220
    ds_read_b64_tr_b16 v[96:97], v221 offset:14336
    ds_read_b64_tr_b16 v[98:99], v221 offset:15360
    ds_read_b64_tr_b16 v[100:101], v221 offset:16384
    ds_read_b64_tr_b16 v[102:103], v221 offset:17408
    ds_read_b64_tr_b16 v[104:105], v221 offset:17920
    ds_read_b64_tr_b16 v[106:107], v221 offset:18944
    ds_read_b64_tr_b16 v[108:109], v221 offset:19968
    ds_read_b64_tr_b16 v[110:111], v221 offset:20992
    s_waitcnt lgkmcnt(6)
    s_cmp_ge_u32 s58, 5
    s_cselect_b32 s59, 0xffff2000, 0
    v_add_u32 v222, s59, v220
    ds_read_b64_tr_b16 v[112:113], v222 offset:21504
    ds_read_b64_tr_b16 v[114:115], v222 offset:22528
    ds_read_b64_tr_b16 v[116:117], v222 offset:23552
    ds_read_b64_tr_b16 v[118:119], v222 offset:24576
    ds_read_b64_tr_b16 v[120:121], v222 offset:25088
    ds_read_b64_tr_b16 v[122:123], v222 offset:26112
    ds_read_b64_tr_b16 v[124:125], v222 offset:27136
    ds_read_b64_tr_b16 v[126:127], v222 offset:28160
    s_waitcnt lgkmcnt(6)
    s_cmp_ge_u32 s58, 4
    s_cselect_b32 s59, 0xffff2000, 0
    v_add_u32 v221, s59, v220
    ds_read_b64_tr_b16 v[128:129], v221 offset:28672
    ds_read_b64_tr_b16 v[130:131], v221 offset:29696
    ds_read_b64_tr_b16 v[132:133], v221 offset:30720
    ds_read_b64_tr_b16 v[134:135], v221 offset:31744
    ds_read_b64_tr_b16 v[136:137], v221 offset:32256
    ds_read_b64_tr_b16 v[138:139], v221 offset:33280
    ds_read_b64_tr_b16 v[140:141], v221 offset:34304
    ds_read_b64_tr_b16 v[142:143], v221 offset:35328
    s_waitcnt lgkmcnt(6)
    s_cmp_ge_u32 s58, 3
    s_cselect_b32 s59, 0xffff2000, 0
    v_add_u32 v222, s59, v220
    ds_read_b64_tr_b16 v[144:145], v222 offset:35840
    ds_read_b64_tr_b16 v[146:147], v222 offset:36864
    ds_read_b64_tr_b16 v[148:149], v222 offset:37888
    ds_read_b64_tr_b16 v[150:151], v222 offset:38912
    ds_read_b64_tr_b16 v[152:153], v222 offset:39424
    ds_read_b64_tr_b16 v[154:155], v222 offset:40448
    ds_read_b64_tr_b16 v[156:157], v222 offset:41472
    ds_read_b64_tr_b16 v[158:159], v222 offset:42496
    s_waitcnt lgkmcnt(6)
    s_cmp_ge_u32 s58, 2
    s_cselect_b32 s59, 0xffff2000, 0
    v_add_u32 v221, s59, v220
    ds_read_b64_tr_b16 v[160:161], v221 offset:43008
    ds_read_b64_tr_b16 v[162:163], v221 offset:44032
    ds_read_b64_tr_b16 v[164:165], v221 offset:45056
    ds_read_b64_tr_b16 v[166:167], v221 offset:46080
    ds_read_b64_tr_b16 v[168:169], v221 offset:46592
    ds_read_b64_tr_b16 v[170:171], v221 offset:47616
    ds_read_b64_tr_b16 v[172:173], v221 offset:48640
    ds_read_b64_tr_b16 v[174:175], v221 offset:49664
    s_waitcnt lgkmcnt(6)
    s_cmp_ge_u32 s58, 1
    s_cselect_b32 s59, 0xffff2000, 0
    v_add_u32 v222, s59, v220
    ds_read_b64_tr_b16 v[176:177], v222 offset:50176
    ds_read_b64_tr_b16 v[178:179], v222 offset:51200
    ds_read_b64_tr_b16 v[180:181], v222 offset:52224
    ds_read_b64_tr_b16 v[182:183], v222 offset:53248
    ds_read_b64_tr_b16 v[184:185], v222 offset:53760
    ds_read_b64_tr_b16 v[186:187], v222 offset:54784
    ds_read_b64_tr_b16 v[188:189], v222 offset:55808
    ds_read_b64_tr_b16 v[190:191], v222 offset:56832
    s_waitcnt lgkmcnt(6)
L_p3_skipA:
    s_waitcnt lgkmcnt(0)
    v_readfirstlane_b32 s60, v14
    s_nop 0
    s_andn2_b32 s60, s60, s62
    s_cmp_eq_u32 s60, 0
    s_waitcnt vmcnt(0)
    s_barrier
    s_cbranch_scc1 L_p2_done
    s_mov_b32 s62, 1
    s_mov_b32 exec_lo, 0
    v_mov_b32 v22, 0
    v_mov_b32 v30, 0
    v_mov_b32 v38, 0
    v_mov_b32 v46, 0
    s_mov_b32 exec_lo, -1
    v_mov_b32 v48, 0xff800000
    v_mov_b32 v49, 0xff800000
    v_mov_b32 v50, 0xff800000
    v_mov_b32 v51, 0xff800000
    s_mov_b32 s61, 0
L_p2_mx:
    buffer_load_dwordx4 v[152:155], v2, s[48:51], s61 offen sc1
    buffer_load_dwordx4 v[156:159], v2, s[48:51], s61 offen offset:1024 sc1
    s_waitcnt vmcnt(0)
    v_mfma_f32_32x32x16_bf16 v[112:127], v[152:155], v[16:19], 0
    v_mfma_f32_32x32x16_bf16 v[112:127], v[156:159], v[20:23], v[112:127]
    s_nop 11
    v_max3_f32 v48, v112, v113, v48
    v_max3_f32 v48, v114, v115, v48
    v_max3_f32 v48, v116, v117, v48
    v_max3_f32 v48, v118, v119, v48
    v_max3_f32 v48, v120, v121, v48
    v_max3_f32 v48, v122, v123, v48
    v_max3_f32 v48, v124, v125, v48
    v_max3_f32 v48, v126, v127, v48
    v_mfma_f32_32x32x16_bf16 v[112:127], v[152:155], v[24:27], 0
    v_mfma_f32_32x32x16_bf16 v[112:127], v[156:159], v[28:31], v[112:127]
    s_nop 11
    v_max3_f32 v49, v112, v113, v49
    v_max3_f32 v49, v114, v115, v49
    v_max3_f32 v49, v116, v117, v49
    v_max3_f32 v49, v118, v119, v49
    v_max3_f32 v49, v120, v121, v49
    v_max3_f32 v49, v122, v123, v49
    v_max3_f32 v49, v124, v125, v49
    v_max3_f32 v49, v126, v127, v49
    v_mfma_f32_32x32x16_bf16 v[112:127], v[152:155], v[32:35], 0
    v_mfma_f32_32x32x16_bf16 v[112:127], v[156:159], v[36:39], v[112:127]
    s_nop 11
    v_max3_f32 v50, v112, v113, v50
    v_max3_f32 v50, v114, v115, v50
    v_max3_f32 v50, v116, v117, v50
    v_max3_f32 v50, v118, v119, v50
    v_max3_f32 v50, v120, v121, v50
    v_max3_f32 v50, v122, v123, v50
    v_max3_f32 v50, v124, v125, v50
    v_max3_f32 v50, v126, v127, v50
    v_mfma_f32_32x32x16_bf16 v[112:127], v[152:155], v[40:43], 0
    v_mfma_f32_32x32x16_bf16 v[112:127], v[156:159], v[44:47], v[112:127]
    s_nop 11
    v_max3_f32 v51, v112, v113, v51
    v_max3_f32 v51, v114, v115, v51
    v_max3_f32 v51, v116, v117, v51
    v_max3_f32 v51, v118, v119, v51
    v_max3_f32 v51, v120, v121, v51
    v_max3_f32 v51, v122, v123, v51
    v_max3_f32 v51, v124, v125, v51
    v_max3_f32 v51, v126, v127, v51
    s_add_u32 s61, s61, 4096
    s_cmp_lt_u32 s61, 65536
    s_cbranch_scc1 L_p2_mx
    v_mov_b32 v10, v48
    s_nop 1
    v_permlane32_swap_b32 v48, v10
    v_max_f32 v48, v48, v10
    s_add_u32 s60, s4, 1
    s_and_b32 s60, s60, 3
    s_lshl_b32 s60, s60, 10
    s_add_u32 s60, s60, 98304
    v_add_u32 v56, s60, v3
    s_lshl_b32 s61, s4, 8
    v_add_u32 v10, s61, v56
    ds_write_b32 v10, v48
    v_mov_b32 v10, v49
    s_nop 1
    v_permlane32_swap_b32 v49, v10
    v_max_f32 v49, v49, v10
    s_add_u32 s60, s4, 2
    s_and_b32 s60, s60, 3
    s_lshl_b32 s60, s60, 10
    s_add_u32 s60, s60, 98304
    v_add_u32 v57, s60, v3
    s_lshl_b32 s61, s4, 8
    v_add_u32 v10, s61, v57
    ds_write_b32 v10, v49
    v_mov_b32 v10, v50
    s_nop 1
    v_permlane32_swap_b32 v50, v10
    v_max_f32 v50, v50, v10
    s_add_u32 s60, s4, 3
    s_and_b32 s60, s60, 3
    s_lshl_b32 s60, s60, 10
    s_add_u32 s60, s60, 98304
    v_add_u32 v58, s60, v3
    s_lshl_b32 s61, s4, 8
    v_add_u32 v10, s61, v58
    ds_write_b32 v10, v50
    v_mov_b32 v10, v51
    s_nop 1
    v_permlane32_swap_b32 v51, v10
    v_max_f32 v51, v51, v10
    s_add_u32 s60, s4, 4
    s_and_b32 s60, s60, 3
    s_lshl_b32 s60, s60, 10
    s_add_u32 s60, s60, 98304
    v_add_u32 v59, s60, v3
    s_lshl_b32 s61, s4, 8
    v_add_u32 v10, s61, v59
    ds_write_b32 v10, v51
    s_waitcnt lgkmcnt(0)
    s_barrier
    ds_read_b32 v64, v56 offset:0
    ds_read_b32 v65, v56 offset:256
    ds_read_b32 v66, v56 offset:512
    ds_read_b32 v67, v56 offset:768
    s_waitcnt lgkmcnt(0)
    ds_read_b32 v68, v57 offset:0
    ds_read_b32 v69, v57 offset:256
    ds_read_b32 v70, v57 offset:512
    ds_read_b32 v71, v57 offset:768
    s_waitcnt lgkmcnt(0)
    ds_read_b32 v72, v58 offset:0
    ds_read_b32 v73, v58 offset:256
    ds_read_b32 v74, v58 offset:512
    ds_read_b32 v75, v58 offset:768
    s_waitcnt lgkmcnt(0)
    ds_read_b32 v76, v59 offset:0
    ds_read_b32 v77, v59 offset:256
    ds_read_b32 v78, v59 offset:512
    ds_read_b32 v79, v59 offset:768
    s_waitcnt lgkmcnt(0)
    v_max3_f32 v10, v64, v65, v66
    v_max_f32 v10, v10, v67
    v_sub_f32 v10, 0, v10
    v_and_b32 v11, 0xffff0000, v10
    v_sub_f32 v14, v10, v11
    v_cvt_pk_bf16_f32 v10, v11, v14
    s_mov_b32 exec_lo, 0
    v_mov_b32 v22, v10
    s_mov_b32 exec_lo, -1
    v_max3_f32 v10, v68, v69, v70
    v_max_f32 v10, v10, v71
    v_sub_f32 v10, 0, v10
    v_and_b32 v11, 0xffff0000, v10
    v_sub_f32 v14, v10, v11
    v_cvt_pk_bf16_f32 v10, v11, v14
    s_mov_b32 exec_lo, 0
    v_mov_b32 v30, v10
    s_mov_b32 exec_lo, -1
    v_max3_f32 v10, v72, v73, v74
    v_max_f32 v10, v10, v75
    v_sub_f32 v10, 0, v10
    v_and_b32 v11, 0xffff0000, v10
    v_sub_f32 v14, v10, v11
    v_cvt_pk_bf16_f32 v10, v11, v14
    s_mov_b32 exec_lo, 0
    v_mov_b32 v38, v10
    s_mov_b32 exec_lo, -1
    v_max3_f32 v10, v76, v77, v78
    v_max_f32 v10, v10, v79
    v_sub_f32 v10, 0, v10
    v_and_b32 v11, 0xffff0000, v10
    v_sub_f32 v14, v10, v11
    v_cvt_pk_bf16_f32 v10, v11, v14
    s_mov_b32 exec_lo, 0
    v_mov_b32 v46, v10
    s_mov_b32 exec_lo, -1
    s_and_b32 s61, s53, 3
    s_mul_i32 s61, s61, 16384
    buffer_load_dwordx4 v[152:155], v2, s[48:51], s61 offen offset:0 sc1
    buffer_load_dwordx4 v[156:159], v2, s[48:51], s61 offen offset:1024 sc1
    buffer_load_dwordx4 v[160:163], v2, s[48:51], s61 offen offset:2048 sc1
    buffer_load_dwordx4 v[164:167], v2, s[48:51], s61 offen offset:3072 sc1
    s_add_u32 s61, s61, 4096
    s_and_b32 s61, s61, 0xffff
    buffer_load_dwordx4 v[168:171], v2, s[48:51], s61 offen offset:0 sc1
    buffer_load_dwordx4 v[172:175], v2, s[48:51], s61 offen offset:1024 sc1
    s_waitcnt vmcnt(0)
    v_mfma_f32_32x32x16_bf16 v[112:127], v[152:155], v[16:19], 0
    v_mfma_f32_32x32x16_bf16 v[112:127], v[156:159], v[20:23], v[112:127]
    s_nop 15
    s_branch L_p2_first
L_p2_done:
    s_lshl_b32 s47, s5, 2
    s_and_b32 s46, s6, 3
    s_add_u32 s47, s47, s46
    s_lshr_b32 s46, s6, 2
    s_and_b32 s56, s5, 1
    s_lshl_b32 s56, s56, 3
    s_and_b32 s57, s6, 7
    s_add_u32 s56, s56, s57
    s_lshr_b32 s57, s5, 1
    s_lshl_b32 s57, s57, 2
    s_lshr_b32 s60, s6, 3
    s_add_u32 s57, s57, s60
    s_cmp_ge_u32 s6, 28
    s_cbranch_scc1 L_p3_skipB
    s_and_b32 s52, s4, 1
    s_lshr_b32 s53, s4, 1
    s_lshl_b32 s54, s47, 1
    s_add_u32 s54, s54, s52
    s_lshl_b32 s55, s46, 1
    s_add_u32 s55, s55, s53
    v_mul_u32_u24 v3, 896, v12
    v_lshl_add_u32 v3, v13, 4, v3
    s_mul_i32 s60, s54, 28672
    s_lshl_b32 s61, s55, 6
    s_add_u32 s60, s60, s61
    buffer_load_dwordx4 v[192:195], v3, s[8:11], s60 offen
    buffer_load_dwordx4 v[196:199], v3, s[8:11], s60 offen offset:32
    s_lshl_b32 s60, s52, 15
    s_add_u32 s60, s60, 98304
    v_add_u32 v5, s60, v2
    s_mul_i32 s58, s54, 28672
    s_lshl_b32 s61, s55, 11
    s_add_u32 s58, s58, s61
    s_add_u32 s58, s58, 9437184
    s_mul_i32 s59, s54, 14
    s_add_u32 s59, s59, s55
    s_lshl_b32 s59, s59, 8
    s_add_u32 s59, s59, 11534336
    v_lshlrev_b32 v14, 3, v1
    s_waitcnt vmcnt(0)
    v_lshlrev_b32 v16, 16, v192
    v_and_b32 v17, 0xffff0000, v192
    v_lshlrev_b32 v18, 16, v193
    v_and_b32 v19, 0xffff0000, v193
    v_lshlrev_b32 v20, 16, v194
    v_and_b32 v21, 0xffff0000, v194
    v_lshlrev_b32 v22, 16, v195
    v_and_b32 v23, 0xffff0000, v195
    v_lshlrev_b32 v24, 16, v196
    v_and_b32 v25, 0xffff0000, v196
    v_lshlrev_b32 v26, 16, v197
    v_and_b32 v27, 0xffff0000, v197
    v_lshlrev_b32 v28, 16, v198
    v_and_b32 v29, 0xffff0000, v198
    v_lshlrev_b32 v30, 16, v199
    v_and_b32 v31, 0xffff0000, v199
    v_mov_b32 v6, 0
    v_mov_b32 v7, 0
    s_barrier
    s_barrier
    ds_read_b128 v[32:35], v5 offset:0
    ds_read_b128 v[36:39], v5 offset:1024
    ds_read_b128 v[40:43], v5 offset:2048
    ds_read_b128 v[44:47], v5 offset:3072
    ds_read_b128 v[48:51], v5 offset:4096
    ds_read_b128 v[52:55], v5 offset:5120
    ds_read_b128 v[56:59], v5 offset:6144
    ds_read_b128 v[60:63], v5 offset:7168
    s_waitcnt lgkmcnt(7)
    v_mfma_f32_32x32x16_bf16 v[16:31], v[64:67], v[32:35], v[16:31]
    s_waitcnt lgkmcnt(6)
    v_mfma_f32_32x32x16_bf16 v[16:31], v[68:71], v[36:39], v[16:31]
    s_waitcnt lgkmcnt(5)
    v_mfma_f32_32x32x16_bf16 v[16:31], v[72:75], v[40:43], v[16:31]
    s_waitcnt lgkmcnt(4)
    v_mfma_f32_32x32x16_bf16 v[16:31], v[76:79], v[44:47], v[16:31]
    s_waitcnt lgkmcnt(3)
    v_mfma_f32_32x32x16_bf16 v[16:31], v[80:83], v[48:51], v[16:31]
    s_waitcnt lgkmcnt(2)
    v_mfma_f32_32x32x16_bf16 v[16:31], v[84:87], v[52:55], v[16:31]
    s_waitcnt lgkmcnt(1)
    v_mfma_f32_32x32x16_bf16 v[16:31], v[88:91], v[56:59], v[16:31]
    s_waitcnt lgkmcnt(0)
    v_mfma_f32_32x32x16_bf16 v[16:31], v[92:95], v[60:63], v[16:31]
    s_barrier
    ds_read_b128 v[32:35], v5 offset:8192
    ds_read_b128 v[36:39], v5 offset:9216
    ds_read_b128 v[40:43], v5 offset:10240
    ds_read_b128 v[44:47], v5 offset:11264
    ds_read_b128 v[48:51], v5 offset:12288
    ds_read_b128 v[52:55], v5 offset:13312
    ds_read_b128 v[56:59], v5 offset:14336
    ds_read_b128 v[60:63], v5 offset:15360
    s_waitcnt lgkmcnt(7)
    v_mfma_f32_32x32x16_bf16 v[16:31], v[96:99], v[32:35], v[16:31]
    s_waitcnt lgkmcnt(6)
    v_mfma_f32_32x32x16_bf16 v[16:31], v[100:103], v[36:39], v[16:31]
    s_waitcnt lgkmcnt(5)
    v_mfma_f32_32x32x16_bf16 v[16:31], v[104:107], v[40:43], v[16:31]
    s_waitcnt lgkmcnt(4)
    v_mfma_f32_32x32x16_bf16 v[16:31], v[108:111], v[44:47], v[16:31]
    s_waitcnt lgkmcnt(3)
    v_mfma_f32_32x32x16_bf16 v[16:31], v[112:115], v[48:51], v[16:31]
    s_waitcnt lgkmcnt(2)
    v_mfma_f32_32x32x16_bf16 v[16:31], v[116:119], v[52:55], v[16:31]
    s_waitcnt lgkmcnt(1)
    v_mfma_f32_32x32x16_bf16 v[16:31], v[120:123], v[56:59], v[16:31]
    s_waitcnt lgkmcnt(0)
    v_mfma_f32_32x32x16_bf16 v[16:31], v[124:127], v[60:63], v[16:31]
    s_barrier
    ds_read_b128 v[32:35], v5 offset:16384
    ds_read_b128 v[36:39], v5 offset:17408
    ds_read_b128 v[40:43], v5 offset:18432
    ds_read_b128 v[44:47], v5 offset:19456
    ds_read_b128 v[48:51], v5 offset:20480
    ds_read_b128 v[52:55], v5 offset:21504
    ds_read_b128 v[56:59], v5 offset:22528
    ds_read_b128 v[60:63], v5 offset:23552
    s_waitcnt lgkmcnt(7)
    v_mfma_f32_32x32x16_bf16 v[16:31], v[128:131], v[32:35], v[16:31]
    s_waitcnt lgkmcnt(6)
    v_mfma_f32_32x32x16_bf16 v[16:31], v[132:135], v[36:39], v[16:31]
    s_waitcnt lgkmcnt(5)
    v_mfma_f32_32x32x16_bf16 v[16:31], v[136:139], v[40:43], v[16:31]
    s_waitcnt lgkmcnt(4)
    v_mfma_f32_32x32x16_bf16 v[16:31], v[140:143], v[44:47], v[16:31]
    s_waitcnt lgkmcnt(3)
    v_mfma_f32_32x32x16_bf16 v[16:31], v[144:147], v[48:51], v[16:31]
    s_waitcnt lgkmcnt(2)
    v_mfma_f32_32x32x16_bf16 v[16:31], v[148:151], v[52:55], v[16:31]
    s_waitcnt lgkmcnt(1)
    v_mfma_f32_32x32x16_bf16 v[16:31], v[152:155], v[56:59], v[16:31]
    s_waitcnt lgkmcnt(0)
    v_mfma_f32_32x32x16_bf16 v[16:31], v[156:159], v[60:63], v[16:31]
    s_barrier
    ds_read_b128 v[32:35], v5 offset:24576
    ds_read_b128 v[36:39], v5 offset:25600
    ds_read_b128 v[40:43], v5 offset:26624
    ds_read_b128 v[44:47], v5 offset:27648
    ds_read_b128 v[48:51], v5 offset:28672
    ds_read_b128 v[52:55], v5 offset:29696
    ds_read_b128 v[56:59], v5 offset:30720
    ds_read_b128 v[60:63], v5 offset:31744
    s_waitcnt lgkmcnt(7)
    v_mfma_f32_32x32x16_bf16 v[16:31], v[160:163], v[32:35], v[16:31]
    s_waitcnt lgkmcnt(6)
    v_mfma_f32_32x32x16_bf16 v[16:31], v[164:167], v[36:39], v[16:31]
    s_waitcnt lgkmcnt(5)
    v_mfma_f32_32x32x16_bf16 v[16:31], v[168:171], v[40:43], v[16:31]
    s_waitcnt lgkmcnt(4)
    v_mfma_f32_32x32x16_bf16 v[16:31], v[172:175], v[44:47], v[16:31]
    s_waitcnt lgkmcnt(3)
    v_mfma_f32_32x32x16_bf16 v[16:31], v[176:179], v[48:51], v[16:31]
    s_waitcnt lgkmcnt(2)
    v_mfma_f32_32x32x16_bf16 v[16:31], v[180:183], v[52:55], v[16:31]
    s_waitcnt lgkmcnt(1)
    v_mfma_f32_32x32x16_bf16 v[16:31], v[184:187], v[56:59], v[16:31]
    s_waitcnt lgkmcnt(0)
    v_mfma_f32_32x32x16_bf16 v[16:31], v[188:191], v[60:63], v[16:31]
    s_nop 11
    v_cvt_pk_bf16_f32 v200, v16, v17
    v_cvt_pk_bf16_f32 v201, v18, v19
    v_cvt_pk_bf16_f32 v202, v20, v21
    v_cvt_pk_bf16_f32 v203, v22, v23
    v_cvt_pk_bf16_f32 v204, v24, v25
    v_cvt_pk_bf16_f32 v205, v26, v27
    v_cvt_pk_bf16_f32 v206, v28, v29
    v_cvt_pk_bf16_f32 v207, v30, v31
    buffer_store_dwordx4 v[200:203], v2, s[20:23], s58 offen sc1
    buffer_store_dwordx4 v[204:207], v2, s[20:23], s58 offen offset:1024 sc1
    v_dot2c_f32_bf16 v6, v200, v15
    v_dot2c_f32_bf16 v7, v200, v200
    v_dot2c_f32_bf16 v6, v201, v15
    v_dot2c_f32_bf16 v7, v201, v201
    v_dot2c_f32_bf16 v6, v202, v15
    v_dot2c_f32_bf16 v7, v202, v202
    v_dot2c_f32_bf16 v6, v203, v15
    v_dot2c_f32_bf16 v7, v203, v203
    v_dot2c_f32_bf16 v6, v204, v15
    v_dot2c_f32_bf16 v7, v204, v204
    v_dot2c_f32_bf16 v6, v205, v15
    v_dot2c_f32_bf16 v7, v205, v205
    v_dot2c_f32_bf16 v6, v206, v15
    v_dot2c_f32_bf16 v7, v206, v206
    v_dot2c_f32_bf16 v6, v207, v15
    v_dot2c_f32_bf16 v7, v207, v207
    s_nop 1
    v_mov_b32 v8, v6
    v_mov_b32 v9, v7
    s_nop 0
    v_permlane32_swap_b32 v6, v8
    v_permlane32_swap_b32 v7, v9
    v_add_f32 v6, v6, v8
    v_add_f32 v7, v7, v9
    s_mov_b32 exec_hi, 0
    buffer_store_dwordx2 v[6:7], v14, s[20:23], s59 offen sc1
    s_mov_b32 exec_hi, -1
L_p3_skipB:
    s_lshl_b32 s54, s56, 2
    s_add_u32 s54, s54, s4
    s_mul_i32 s55, s54, 28672
    s_add_u32 s55, s55, 9437184
    s_add_u32 s53, s55, 28672
    s_lshr_b32 s60, s6, 3
    s_mul_i32 s60, s60, 0
    s_and_b32 s58, s6, 7
    s_add_u32 s58, s58, s60
    s_cmp_ge_u32 s58, 7
    s_cselect_b32 s60, 7, 0
    s_sub_u32 s58, s58, s60
    s_lshl_b32 s58, s58, 12
    s_add_u32 s58, s58, s55
    v_bfe_u32 v9, v1, 2, 2
    v_mul_u32_u24 v10, 1088, v9
    v_lshl_add_u32 v10, v13, 9, v10
    v_and_b32 v9, 1, v1
    v_lshl_add_u32 v10, v9, 4, v10
    v_bfe_u32 v9, v1, 4, 1
    v_lshl_add_u32 v10, v9, 3, v10
    v_bfe_u32 v9, v1, 1, 1
    v_mul_u32_u24 v9, 4384, v9
    s_mul_i32 s60, s57, 224
    s_and_b32 s60, s60, 63
    v_add3_u32 v4, v10, v9, s60
    v_mov_b32 v8, 0xffff0000
    v_mul_u32_u24 v5, 1792, v13
    v_lshl_add_u32 v5, v12, 3, v5
    s_mul_i32 s59, s54, 3584
    s_add_u32 s59, s59, 11534336
    s_mul_i32 s62, s54, 114688
    s_mul_i32 s61, s57, 7168
    s_add_u32 s62, s62, s61
    s_add_u32 s62, s62, 12582912
    s_add_u32 s63, s62, 4096
    s_waitcnt vmcnt(0)
    s_barrier
    ds_read_b64_tr_b16 v[128:129], v4 offset:0
    ds_read_b64_tr_b16 v[130:131], v4 offset:256
    ds_read_b64_tr_b16 v[132:133], v4 offset:32
    ds_read_b64_tr_b16 v[134:135], v4 offset:288
    ds_read_b64_tr_b16 v[136:137], v4 offset:64
    ds_read_b64_tr_b16 v[138:139], v4 offset:320
    ds_read_b64_tr_b16 v[140:141], v4 offset:96
    ds_read_b64_tr_b16 v[142:143], v4 offset:352
    ds_read_b64_tr_b16 v[144:145], v4 offset:128
    ds_read_b64_tr_b16 v[146:147], v4 offset:384
    ds_read_b64_tr_b16 v[148:149], v4 offset:160
    ds_read_b64_tr_b16 v[150:151], v4 offset:416
    ds_read_b64_tr_b16 v[152:153], v4 offset:192
    ds_read_b64_tr_b16 v[154:155], v4 offset:448
    s_barrier
    buffer_load_dwordx2 v[172:173], v5, s[20:23], s59 offen offset:0 sc1
    buffer_load_dwordx2 v[174:175], v5, s[20:23], s59 offen offset:256 sc1
    buffer_load_dwordx2 v[176:177], v5, s[20:23], s59 offen offset:512 sc1
    buffer_load_dwordx2 v[178:179], v5, s[20:23], s59 offen offset:768 sc1
    buffer_load_dwordx2 v[180:181], v5, s[20:23], s59 offen offset:1024 sc1
    buffer_load_dwordx2 v[182:183], v5, s[20:23], s59 offen offset:1280 sc1
    buffer_load_dwordx2 v[184:185], v5, s[20:23], s59 offen offset:1536 sc1
    buffer_load_dwordx4 v[188:191], v2, s[20:23], s58 offen offset:0 sc1
    buffer_load_dwordx4 v[192:195], v2, s[20:23], s58 offen offset:1024 sc1
    buffer_load_dwordx4 v[196:199], v2, s[20:23], s58 offen offset:2048 sc1
    buffer_load_dwordx4 v[200:203], v2, s[20:23], s58 offen offset:3072 sc1
    s_add_u32 s58, s58, 4096
    s_cmp_eq_u32 s58, s53
    s_cselect_b32 s58, s55, s58
    buffer_load_dwordx4 v[204:207], v2, s[20:23], s58 offen offset:0 sc1
    buffer_load_dwordx4 v[208:211], v2, s[20:23], s58 offen offset:1024 sc1
    buffer_load_dwordx4 v[212:215], v2, s[20:23], s58 offen offset:2048 sc1
    buffer_load_dwordx4 v[216:219], v2, s[20:23], s58 offen offset:3072 sc1
    s_add_u32 s58, s58, 4096
    s_cmp_eq_u32 s58, s53
    s_cselect_b32 s58, s55, s58
    s_waitcnt vmcnt(8)
    v_pk_add_f32 v[174:175], v[174:175], v[180:181]
    v_pk_add_f32 v[176:177], v[176:177], v[182:183]
    v_pk_add_f32 v[178:179], v[178:179], v[184:185]
    v_pk_add_f32 v[172:173], v[172:173], v[174:175]
    v_pk_add_f32 v[176:177], v[176:177], v[178:179]
    v_pk_add_f32 v[172:173], v[172:173], v[176:177]
    v_mov_b32 v174, v172
    v_mov_b32 v175, v173
    s_nop 0
    v_permlane32_swap_b32 v172, v174
    v_permlane32_swap_b32 v173, v175
    v_pk_add_f32 v[172:173], v[172:173], v[174:175]
    v_mul_f32 v172, 0x3b124925, v172
    v_mul_f32 v173, 0x3b124925, v173
    v_fma_f32 v173, -v172, v172, v173
    v_max_f32 v173, 0, v173
    v_add_f32 v173, 0x3727c5ac, v173
    v_rsq_f32 v6, v173
    s_nop 0
    v_mul_f32 v7, v172, v6
    v_sub_f32 v7, 0, v7
    s_waitcnt vmcnt(7)
    v_lshlrev_b32 v156, 16, v188
    v_and_b32 v157, v8, v188
    v_lshlrev_b32 v158, 16, v189
    v_and_b32 v159, v8, v189
    v_lshlrev_b32 v160, 16, v190
    v_and_b32 v161, v8, v190
    v_lshlrev_b32 v162, 16, v191
    v_and_b32 v163, v8, v191
    v_fma_f32 v156, v156, v6, v7
    v_fma_f32 v157, v157, v6, v7
    v_fma_f32 v158, v158, v6, v7
    v_fma_f32 v159, v159, v6, v7
    v_fma_f32 v160, v160, v6, v7
    v_fma_f32 v161, v161, v6, v7
    v_fma_f32 v162, v162, v6, v7
    v_fma_f32 v163, v163, v6, v7
    v_cvt_pk_bf16_f32 v188, v156, v157
    v_cvt_pk_bf16_f32 v189, v158, v159
    v_cvt_pk_bf16_f32 v190, v160, v161
    v_cvt_pk_bf16_f32 v191, v162, v163
    s_waitcnt lgkmcnt(6)
    s_nop 0
    v_mfma_f32_32x32x16_bf16 v[16:31], v[128:131], v[188:191], 0
    ds_read_b64_tr_b16 v[128:129], v4 offset:8736
    ds_read_b64_tr_b16 v[130:131], v4 offset:8992
    s_waitcnt vmcnt(6)
    v_lshlrev_b32 v156, 16, v192
    v_and_b32 v157, v8, v192
    v_lshlrev_b32 v158, 16, v193
    v_mfma_f32_32x32x16_bf16 v[32:47], v[132:135], v[188:191], 0
    ds_read_b64_tr_b16 v[132:133], v4 offset:8768
    ds_read_b64_tr_b16 v[134:135], v4 offset:9024
    v_and_b32 v159, v8, v193
    v_lshlrev_b32 v160, 16, v194
    v_and_b32 v161, v8, v194
    v_lshlrev_b32 v162, 16, v195
    v_mfma_f32_32x32x16_bf16 v[48:63], v[136:139], v[188:191], 0
    ds_read_b64_tr_b16 v[136:137], v4 offset:8800
    ds_read_b64_tr_b16 v[138:139], v4 offset:9056
    v_and_b32 v163, v8, v195
    v_fma_f32 v156, v156, v6, v7
    v_fma_f32 v157, v157, v6, v7
    v_mfma_f32_32x32x16_bf16 v[64:79], v[140:143], v[188:191], 0
    ds_read_b64_tr_b16 v[140:141], v4 offset:8832
    ds_read_b64_tr_b16 v[142:143], v4 offset:9088
    v_fma_f32 v158, v158, v6, v7
    v_fma_f32 v159, v159, v6, v7
    v_fma_f32 v160, v160, v6, v7
    buffer_load_dwordx4 v[220:223], v2, s[20:23], s58 offen offset:0 sc1
    s_waitcnt lgkmcnt(8)
    v_mfma_f32_32x32x16_bf16 v[80:95], v[144:147], v[188:191], 0
    ds_read_b64_tr_b16 v[144:145], v4 offset:8864
    ds_read_b64_tr_b16 v[146:147], v4 offset:9120
    v_fma_f32 v161, v161, v6, v7
    v_fma_f32 v162, v162, v6, v7
    v_fma_f32 v163, v163, v6, v7
    v_cvt_pk_bf16_f32 v192, v156, v157
    v_mfma_f32_32x32x16_bf16 v[96:111], v[148:151], v[188:191], 0
    ds_read_b64_tr_b16 v[148:149], v4 offset:8896
    ds_read_b64_tr_b16 v[150:151], v4 offset:9152
    v_cvt_pk_bf16_f32 v193, v158, v159
    v_cvt_pk_bf16_f32 v194, v160, v161
    v_cvt_pk_bf16_f32 v195, v162, v163
    v_mfma_f32_32x32x16_bf16 v[112:127], v[152:155], v[188:191], 0
    ds_read_b64_tr_b16 v[152:153], v4 offset:8928
    ds_read_b64_tr_b16 v[154:155], v4 offset:9184
    buffer_load_dwordx4 v[224:227], v2, s[20:23], s58 offen offset:1024 sc1
    s_waitcnt lgkmcnt(6)
    v_mfma_f32_32x32x16_bf16 v[16:31], v[128:131], v[192:195], v[16:31]
    ds_read_b64_tr_b16 v[128:129], v4 offset:17472
    ds_read_b64_tr_b16 v[130:131], v4 offset:17728
    s_waitcnt vmcnt(7)
    v_lshlrev_b32 v156, 16, v196
    v_and_b32 v157, v8, v196
    v_lshlrev_b32 v158, 16, v197
    v_mfma_f32_32x32x16_bf16 v[32:47], v[132:135], v[192:195], v[32:47]
    ds_read_b64_tr_b16 v[132:133], v4 offset:17504
    ds_read_b64_tr_b16 v[134:135], v4 offset:17760
    v_and_b32 v159, v8, v197
    v_lshlrev_b32 v160, 16, v198
    v_and_b32 v161, v8, v198
    v_lshlrev_b32 v162, 16, v199
    v_mfma_f32_32x32x16_bf16 v[48:63], v[136:139], v[192:195], v[48:63]
    ds_read_b64_tr_b16 v[136:137], v4 offset:17536
    ds_read_b64_tr_b16 v[138:139], v4 offset:17792
    v_and_b32 v163, v8, v199
    v_fma_f32 v156, v156, v6, v7
    v_fma_f32 v157, v157, v6, v7
    v_mfma_f32_32x32x16_bf16 v[64:79], v[140:143], v[192:195], v[64:79]
    ds_read_b64_tr_b16 v[140:141], v4 offset:17568
    ds_read_b64_tr_b16 v[142:143], v4 offset:17824
    v_fma_f32 v158, v158, v6, v7
    v_fma_f32 v159, v159, v6, v7
    v_fma_f32 v160, v160, v6, v7
    buffer_load_dwordx4 v[228:231], v2, s[20:23], s58 offen offset:2048 sc1
    s_waitcnt lgkmcnt(8)
    v_mfma_f32_32x32x16_bf16 v[80:95], v[144:147], v[192:195], v[80:95]
    ds_read_b64_tr_b16 v[144:145], v4 offset:17600
    ds_read_b64_tr_b16 v[146:147], v4 offset:17856
    v_fma_f32 v161, v161, v6, v7
    v_fma_f32 v162, v162, v6, v7
    v_fma_f32 v163, v163, v6, v7
    v_cvt_pk_bf16_f32 v196, v156, v157
    v_mfma_f32_32x32x16_bf16 v[96:111], v[148:151], v[192:195], v[96:111]
    ds_read_b64_tr_b16 v[148:149], v4 offset:17632
    ds_read_b64_tr_b16 v[150:151], v4 offset:17888
    v_cvt_pk_bf16_f32 v197, v158, v159
    v_cvt_pk_bf16_f32 v198, v160, v161
    v_cvt_pk_bf16_f32 v199, v162, v163
    v_mfma_f32_32x32x16_bf16 v[112:127], v[152:155], v[192:195], v[112:127]
    ds_read_b64_tr_b16 v[152:153], v4 offset:17664
    ds_read_b64_tr_b16 v[154:155], v4 offset:17920
    buffer_load_dwordx4 v[232:235], v2, s[20:23], s58 offen offset:3072 sc1
    s_add_u32 s58, s58, 4096
    s_cmp_eq_u32 s58, s53
    s_cselect_b32 s58, s55, s58
    s_waitcnt lgkmcnt(6)
    v_mfma_f32_32x32x16_bf16 v[16:31], v[128:131], v[196:199], v[16:31]
    ds_read_b64_tr_b16 v[128:129], v4 offset:26208
    ds_read_b64_tr_b16 v[130:131], v4 offset:26464
    s_waitcnt vmcnt(8)
    v_lshlrev_b32 v156, 16, v200
    v_and_b32 v157, v8, v200
    v_lshlrev_b32 v158, 16, v201
    v_mfma_f32_32x32x16_bf16 v[32:47], v[132:135], v[196:199], v[32:47]
    ds_read_b64_tr_b16 v[132:133], v4 offset:26240
    ds_read_b64_tr_b16 v[134:135], v4 offset:26496
    v_and_b32 v159, v8, v201
    v_lshlrev_b32 v160, 16, v202
    v_and_b32 v161, v8, v202
    v_lshlrev_b32 v162, 16, v203
    v_mfma_f32_32x32x16_bf16 v[48:63], v[136:139], v[196:199], v[48:63]
    ds_read_b64_tr_b16 v[136:137], v4 offset:26272
    ds_read_b64_tr_b16 v[138:139], v4 offset:26528
    v_and_b32 v163, v8, v203
    v_fma_f32 v156, v156, v6, v7
    v_fma_f32 v157, v157, v6, v7
    v_mfma_f32_32x32x16_bf16 v[64:79], v[140:143], v[196:199], v[64:79]
    ds_read_b64_tr_b16 v[140:141], v4 offset:26304
    ds_read_b64_tr_b16 v[142:143], v4 offset:26560
    v_fma_f32 v158, v158, v6, v7
    v_fma_f32 v159, v159, v6, v7
    v_fma_f32 v160, v160, v6, v7
    buffer_load_dwordx4 v[188:191], v2, s[20:23], s58 offen offset:0 sc1
    s_waitcnt lgkmcnt(8)
    v_mfma_f32_32x32x16_bf16 v[80:95], v[144:147], v[196:199], v[80:95]
    ds_read_b64_tr_b16 v[144:145], v4 offset:26336
    ds_read_b64_tr_b16 v[146:147], v4 offset:26592
    v_fma_f32 v161, v161, v6, v7
    v_fma_f32 v162, v162, v6, v7
    v_fma_f32 v163, v163, v6, v7
    v_cvt_pk_bf16_f32 v200, v156, v157
    v_mfma_f32_32x32x16_bf16 v[96:111], v[148:151], v[196:199], v[96:111]
    ds_read_b64_tr_b16 v[148:149], v4 offset:26368
    ds_read_b64_tr_b16 v[150:151], v4 offset:26624
    v_cvt_pk_bf16_f32 v201, v158, v159
    v_cvt_pk_bf16_f32 v202, v160, v161
    v_cvt_pk_bf16_f32 v203, v162, v163
    v_mfma_f32_32x32x16_bf16 v[112:127], v[152:155], v[196:199], v[112:127]
    ds_read_b64_tr_b16 v[152:153], v4 offset:26400
    ds_read_b64_tr_b16 v[154:155], v4 offset:26656
    buffer_load_dwordx4 v[192:195], v2, s[20:23], s58 offen offset:1024 sc1
    s_waitcnt lgkmcnt(6)
    v_mfma_f32_32x32x16_bf16 v[16:31], v[128:131], v[200:203], v[16:31]
    ds_read_b64_tr_b16 v[128:129], v4 offset:34944
    ds_read_b64_tr_b16 v[130:131], v4 offset:35200
    s_waitcnt vmcnt(9)
    v_lshlrev_b32 v156, 16, v204
    v_and_b32 v157, v8, v204
    v_lshlrev_b32 v158, 16, v205
    v_mfma_f32_32x32x16_bf16 v[32:47], v[132:135], v[200:203], v[32:47]
    ds_read_b64_tr_b16 v[132:133], v4 offset:34976
    ds_read_b64_tr_b16 v[134:135], v4 offset:35232
    v_and_b32 v159, v8, v205
    v_lshlrev_b32 v160, 16, v206
    v_and_b32 v161, v8, v206
    v_lshlrev_b32 v162, 16, v207
    v_mfma_f32_32x32x16_bf16 v[48:63], v[136:139], v[200:203], v[48:63]
    ds_read_b64_tr_b16 v[136:137], v4 offset:35008
    ds_read_b64_tr_b16 v[138:139], v4 offset:35264
    v_and_b32 v163, v8, v207
    v_fma_f32 v156, v156, v6, v7
    v_fma_f32 v157, v157, v6, v7
    v_mfma_f32_32x32x16_bf16 v[64:79], v[140:143], v[200:203], v[64:79]
    ds_read_b64_tr_b16 v[140:141], v4 offset:35040
    ds_read_b64_tr_b16 v[142:143], v4 offset:35296
    v_fma_f32 v158, v158, v6, v7
    v_fma_f32 v159, v159, v6, v7
    v_fma_f32 v160, v160, v6, v7
    buffer_load_dwordx4 v[196:199], v2, s[20:23], s58 offen offset:2048 sc1
    s_waitcnt lgkmcnt(8)
    v_mfma_f32_32x32x16_bf16 v[80:95], v[144:147], v[200:203], v[80:95]
    ds_read_b64_tr_b16 v[144:145], v4 offset:35072
    ds_read_b64_tr_b16 v[146:147], v4 offset:35328
    v_fma_f32 v161, v161, v6, v7
    v_fma_f32 v162, v162, v6, v7
    v_fma_f32 v163, v163, v6, v7
    v_cvt_pk_bf16_f32 v204, v156, v157
    v_mfma_f32_32x32x16_bf16 v[96:111], v[148:151], v[200:203], v[96:111]
    ds_read_b64_tr_b16 v[148:149], v4 offset:35104
    ds_read_b64_tr_b16 v[150:151], v4 offset:35360
    v_cvt_pk_bf16_f32 v205, v158, v159
    v_cvt_pk_bf16_f32 v206, v160, v161
    v_cvt_pk_bf16_f32 v207, v162, v163
    v_mfma_f32_32x32x16_bf16 v[112:127], v[152:155], v[200:203], v[112:127]
    ds_read_b64_tr_b16 v[152:153], v4 offset:35136
    ds_read_b64_tr_b16 v[154:155], v4 offset:35392
    buffer_load_dwordx4 v[200:203], v2, s[20:23], s58 offen offset:3072 sc1
    s_add_u32 s58, s58, 4096
    s_cmp_eq_u32 s58, s53
    s_cselect_b32 s58, s55, s58
    s_waitcnt lgkmcnt(6)
    v_mfma_f32_32x32x16_bf16 v[16:31], v[128:131], v[204:207], v[16:31]
    ds_read_b64_tr_b16 v[128:129], v4 offset:43680
    ds_read_b64_tr_b16 v[130:131], v4 offset:43936
    s_waitcnt vmcnt(10)
    v_lshlrev_b32 v156, 16, v208
    v_and_b32 v157, v8, v208
    v_lshlrev_b32 v158, 16, v209
    v_mfma_f32_32x32x16_bf16 v[32:47], v[132:135], v[204:207], v[32:47]
    ds_read_b64_tr_b16 v[132:133], v4 offset:43712
    ds_read_b64_tr_b16 v[134:135], v4 offset:43968
    v_and_b32 v159, v8, v209
    v_lshlrev_b32 v160, 16, v210
    v_and_b32 v161, v8, v210
    v_lshlrev_b32 v162, 16, v211
    v_mfma_f32_32x32x16_bf16 v[48:63], v[136:139], v[204:207], v[48:63]
    ds_read_b64_tr_b16 v[136:137], v4 offset:43744
    ds_read_b64_tr_b16 v[138:139], v4 offset:44000
    v_and_b32 v163, v8, v211
    v_fma_f32 v156, v156, v6, v7
    v_fma_f32 v157, v157, v6, v7
    v_mfma_f32_32x32x16_bf16 v[64:79], v[140:143], v[204:207], v[64:79]
    ds_read_b64_tr_b16 v[140:141], v4 offset:43776
    ds_read_b64_tr_b16 v[142:143], v4 offset:44032
    v_fma_f32 v158, v158, v6, v7
    v_fma_f32 v159, v159, v6, v7
    v_fma_f32 v160, v160, v6, v7
    s_waitcnt lgkmcnt(8)
    v_mfma_f32_32x32x16_bf16 v[80:95], v[144:147], v[204:207], v[80:95]
    ds_read_b64_tr_b16 v[144:145], v4 offset:43808
    ds_read_b64_tr_b16 v[146:147], v4 offset:44064
    v_fma_f32 v161, v161, v6, v7
    v_fma_f32 v162, v162, v6, v7
    v_fma_f32 v163, v163, v6, v7
    v_cvt_pk_bf16_f32 v208, v156, v157
    v_mfma_f32_32x32x16_bf16 v[96:111], v[148:151], v[204:207], v[96:111]
    ds_read_b64_tr_b16 v[148:149], v4 offset:43840
    ds_read_b64_tr_b16 v[150:151], v4 offset:44096
    v_cvt_pk_bf16_f32 v209, v158, v159
    v_cvt_pk_bf16_f32 v210, v160, v161
    v_cvt_pk_bf16_f32 v211, v162, v163
    v_mfma_f32_32x32x16_bf16 v[112:127], v[152:155], v[204:207], v[112:127]
    ds_read_b64_tr_b16 v[152:153], v4 offset:43872
    ds_read_b64_tr_b16 v[154:155], v4 offset:44128
    buffer_load_dwordx4 v[204:207], v2, s[20:23], s58 offen offset:0 sc1
    s_waitcnt lgkmcnt(6)
    v_mfma_f32_32x32x16_bf16 v[16:31], v[128:131], v[208:211], v[16:31]
    ds_read_b64_tr_b16 v[128:129], v4 offset:52416
    ds_read_b64_tr_b16 v[130:131], v4 offset:52672
    s_waitcnt vmcnt(10)
    v_lshlrev_b32 v156, 16, v212
    v_and_b32 v157, v8, v212
    v_lshlrev_b32 v158, 16, v213
    v_mfma_f32_32x32x16_bf16 v[32:47], v[132:135], v[208:211], v[32:47]
    ds_read_b64_tr_b16 v[132:133], v4 offset:52448
    ds_read_b64_tr_b16 v[134:135], v4 offset:52704
    v_and_b32 v159, v8, v213
    v_lshlrev_b32 v160, 16, v214
    v_and_b32 v161, v8, v214
    v_lshlrev_b32 v162, 16, v215
    v_mfma_f32_32x32x16_bf16 v[48:63], v[136:139], v[208:211], v[48:63]
    ds_read_b64_tr_b16 v[136:137], v4 offset:52480
    ds_read_b64_tr_b16 v[138:139], v4 offset:52736
    v_and_b32 v163, v8, v215
    v_fma_f32 v156, v156, v6, v7
    v_fma_f32 v157, v157, v6, v7
    v_mfma_f32_32x32x16_bf16 v[64:79], v[140:143], v[208:211], v[64:79]
    ds_read_b64_tr_b16 v[140:141], v4 offset:52512
    ds_read_b64_tr_b16 v[142:143], v4 offset:52768
    v_fma_f32 v158, v158, v6, v7
    v_fma_f32 v159, v159, v6, v7
    v_fma_f32 v160, v160, v6, v7
    s_waitcnt lgkmcnt(8)
    v_mfma_f32_32x32x16_bf16 v[80:95], v[144:147], v[208:211], v[80:95]
    ds_read_b64_tr_b16 v[144:145], v4 offset:52544
    ds_read_b64_tr_b16 v[146:147], v4 offset:52800
    v_fma_f32 v161, v161, v6, v7
    v_fma_f32 v162, v162, v6, v7
    v_fma_f32 v163, v163, v6, v7
    v_cvt_pk_bf16_f32 v212, v156, v157
    v_mfma_f32_32x32x16_bf16 v[96:111], v[148:151], v[208:211], v[96:111]
    ds_read_b64_tr_b16 v[148:149], v4 offset:52576
    ds_read_b64_tr_b16 v[150:151], v4 offset:52832
    v_cvt_pk_bf16_f32 v213, v158, v159
    v_cvt_pk_bf16_f32 v214, v160, v161
    v_cvt_pk_bf16_f32 v215, v162, v163
    v_mfma_f32_32x32x16_bf16 v[112:127], v[152:155], v[208:211], v[112:127]
    ds_read_b64_tr_b16 v[152:153], v4 offset:52608
    ds_read_b64_tr_b16 v[154:155], v4 offset:52864
    buffer_load_dwordx4 v[208:211], v2, s[20:23], s58 offen offset:1024 sc1
    s_waitcnt lgkmcnt(6)
    v_mfma_f32_32x32x16_bf16 v[16:31], v[128:131], v[212:215], v[16:31]
    v_add_u32 v4, 0xeee0, v4
    ds_read_b64_tr_b16 v[128:129], v4 offset:0
    ds_read_b64_tr_b16 v[130:131], v4 offset:256
    s_waitcnt vmcnt(10)
    v_lshlrev_b32 v156, 16, v216
    v_and_b32 v157, v8, v216
    v_lshlrev_b32 v158, 16, v217
    v_mfma_f32_32x32x16_bf16 v[32:47], v[132:135], v[212:215], v[32:47]
    ds_read_b64_tr_b16 v[132:133], v4 offset:32
    ds_read_b64_tr_b16 v[134:135], v4 offset:288
    v_and_b32 v159, v8, v217
    v_lshlrev_b32 v160, 16, v218
    v_and_b32 v161, v8, v218
    v_lshlrev_b32 v162, 16, v219
    v_mfma_f32_32x32x16_bf16 v[48:63], v[136:139], v[212:215], v[48:63]
    ds_read_b64_tr_b16 v[136:137], v4 offset:64
    ds_read_b64_tr_b16 v[138:139], v4 offset:320
    v_and_b32 v163, v8, v219
    v_fma_f32 v156, v156, v6, v7
    v_fma_f32 v157, v157, v6, v7
    v_mfma_f32_32x32x16_bf16 v[64:79], v[140:143], v[212:215], v[64:79]
    ds_read_b64_tr_b16 v[140:141], v4 offset:96
    ds_read_b64_tr_b16 v[142:143], v4 offset:352
    v_fma_f32 v158, v158, v6, v7
    v_fma_f32 v159, v159, v6, v7
    v_fma_f32 v160, v160, v6, v7
    s_waitcnt lgkmcnt(8)
    v_mfma_f32_32x32x16_bf16 v[80:95], v[144:147], v[212:215], v[80:95]
    ds_read_b64_tr_b16 v[144:145], v4 offset:128
    ds_read_b64_tr_b16 v[146:147], v4 offset:384
    v_fma_f32 v161, v161, v6, v7
    v_fma_f32 v162, v162, v6, v7
    v_fma_f32 v163, v163, v6, v7
    v_cvt_pk_bf16_f32 v216, v156, v157
    v_mfma_f32_32x32x16_bf16 v[96:111], v[148:151], v[212:215], v[96:111]
    ds_read_b64_tr_b16 v[148:149], v4 offset:160
    ds_read_b64_tr_b16 v[150:151], v4 offset:416
    v_cvt_pk_bf16_f32 v217, v158, v159
    v_cvt_pk_bf16_f32 v218, v160, v161
    v_cvt_pk_bf16_f32 v219, v162, v163
    v_mfma_f32_32x32x16_bf16 v[112:127], v[152:155], v[212:215], v[112:127]
    ds_read_b64_tr_b16 v[152:153], v4 offset:192
    ds_read_b64_tr_b16 v[154:155], v4 offset:448
    buffer_load_dwordx4 v[212:215], v2, s[20:23], s58 offen offset:2048 sc1
    s_waitcnt lgkmcnt(6)
    v_mfma_f32_32x32x16_bf16 v[16:31], v[128:131], v[216:219], v[16:31]
    ds_read_b64_tr_b16 v[128:129], v4 offset:8736
    ds_read_b64_tr_b16 v[130:131], v4 offset:8992
    s_waitcnt vmcnt(10)
    v_lshlrev_b32 v156, 16, v220
    v_and_b32 v157, v8, v220
    v_lshlrev_b32 v158, 16, v221
    v_mfma_f32_32x32x16_bf16 v[32:47], v[132:135], v[216:219], v[32:47]
    ds_read_b64_tr_b16 v[132:133], v4 offset:8768
    ds_read_b64_tr_b16 v[134:135], v4 offset:9024
    v_and_b32 v159, v8, v221
    v_lshlrev_b32 v160, 16, v222
    v_and_b32 v161, v8, v222
    v_lshlrev_b32 v162, 16, v223
    v_mfma_f32_32x32x16_bf16 v[48:63], v[136:139], v[216:219], v[48:63]
    ds_read_b64_tr_b16 v[136:137], v4 offset:8800
    ds_read_b64_tr_b16 v[138:139], v4 offset:9056
    v_and_b32 v163, v8, v223
    v_fma_f32 v156, v156, v6, v7
    v_fma_f32 v157, v157, v6, v7
    v_mfma_f32_32x32x16_bf16 v[64:79], v[140:143], v[216:219], v[64:79]
    ds_read_b64_tr_b16 v[140:141], v4 offset:8832
    ds_read_b64_tr_b16 v[142:143], v4 offset:9088
    v_fma_f32 v158, v158, v6, v7
    v_fma_f32 v159, v159, v6, v7
    v_fma_f32 v160, v160, v6, v7
    s_waitcnt lgkmcnt(8)
    v_mfma_f32_32x32x16_bf16 v[80:95], v[144:147], v[216:219], v[80:95]
    ds_read_b64_tr_b16 v[144:145], v4 offset:8864
    ds_read_b64_tr_b16 v[146:147], v4 offset:9120
    v_fma_f32 v161, v161, v6, v7
    v_fma_f32 v162, v162, v6, v7
    v_fma_f32 v163, v163, v6, v7
    v_cvt_pk_bf16_f32 v220, v156, v157
    v_mfma_f32_32x32x16_bf16 v[96:111], v[148:151], v[216:219], v[96:111]
    ds_read_b64_tr_b16 v[148:149], v4 offset:8896
    ds_read_b64_tr_b16 v[150:151], v4 offset:9152
    v_cvt_pk_bf16_f32 v221, v158, v159
    v_cvt_pk_bf16_f32 v222, v160, v161
    v_cvt_pk_bf16_f32 v223, v162, v163
    v_mfma_f32_32x32x16_bf16 v[112:127], v[152:155], v[216:219], v[112:127]
    ds_read_b64_tr_b16 v[152:153], v4 offset:8928
    ds_read_b64_tr_b16 v[154:155], v4 offset:9184
    buffer_load_dwordx4 v[216:219], v2, s[20:23], s58 offen offset:3072 sc1
    s_add_u32 s58, s58, 4096
    s_cmp_eq_u32 s58, s53
    s_cselect_b32 s58, s55, s58
    s_waitcnt lgkmcnt(6)
    v_mfma_f32_32x32x16_bf16 v[16:31], v[128:131], v[220:223], v[16:31]
    ds_read_b64_tr_b16 v[128:129], v4 offset:17472
    ds_read_b64_tr_b16 v[130:131], v4 offset:17728
    s_waitcnt vmcnt(10)
    v_lshlrev_b32 v156, 16, v224
    v_and_b32 v157, v8, v224
    v_lshlrev_b32 v158, 16, v225
    v_mfma_f32_32x32x16_bf16 v[32:47], v[132:135], v[220:223], v[32:47]
    ds_read_b64_tr_b16 v[132:133], v4 offset:17504
    ds_read_b64_tr_b16 v[134:135], v4 offset:17760
    v_and_b32 v159, v8, v225
    v_lshlrev_b32 v160, 16, v226
    v_and_b32 v161, v8, v226
    v_lshlrev_b32 v162, 16, v227
    v_mfma_f32_32x32x16_bf16 v[48:63], v[136:139], v[220:223], v[48:63]
    ds_read_b64_tr_b16 v[136:137], v4 offset:17536
    ds_read_b64_tr_b16 v[138:139], v4 offset:17792
    v_and_b32 v163, v8, v227
    v_fma_f32 v156, v156, v6, v7
    v_fma_f32 v157, v157, v6, v7
    v_mfma_f32_32x32x16_bf16 v[64:79], v[140:143], v[220:223], v[64:79]
    ds_read_b64_tr_b16 v[140:141], v4 offset:17568
    ds_read_b64_tr_b16 v[142:143], v4 offset:17824
    v_fma_f32 v158, v158, v6, v7
    v_fma_f32 v159, v159, v6, v7
    v_fma_f32 v160, v160, v6, v7
    s_waitcnt lgkmcnt(8)
    v_mfma_f32_32x32x16_bf16 v[80:95], v[144:147], v[220:223], v[80:95]
    ds_read_b64_tr_b16 v[144:145], v4 offset:17600
    ds_read_b64_tr_b16 v[146:147], v4 offset:17856
    v_fma_f32 v161, v161, v6, v7
    v_fma_f32 v162, v162, v6, v7
    v_fma_f32 v163, v163, v6, v7
    v_cvt_pk_bf16_f32 v224, v156, v157
    v_mfma_f32_32x32x16_bf16 v[96:111], v[148:151], v[220:223], v[96:111]
    ds_read_b64_tr_b16 v[148:149], v4 offset:17632
    ds_read_b64_tr_b16 v[150:151], v4 offset:17888
    v_cvt_pk_bf16_f32 v225, v158, v159
    v_cvt_pk_bf16_f32 v226, v160, v161
    v_cvt_pk_bf16_f32 v227, v162, v163
    v_mfma_f32_32x32x16_bf16 v[112:127], v[152:155], v[220:223], v[112:127]
    ds_read_b64_tr_b16 v[152:153], v4 offset:17664
    ds_read_b64_tr_b16 v[154:155], v4 offset:17920
    buffer_load_dwordx4 v[220:223], v2, s[20:23], s58 offen offset:0 sc1
    s_waitcnt lgkmcnt(6)
    v_mfma_f32_32x32x16_bf16 v[16:31], v[128:131], v[224:227], v[16:31]
    ds_read_b64_tr_b16 v[128:129], v4 offset:26208
    ds_read_b64_tr_b16 v[130:131], v4 offset:26464
    s_waitcnt vmcnt(10)
    v_lshlrev_b32 v156, 16, v228
    v_and_b32 v157, v8, v228
    v_lshlrev_b32 v158, 16, v229
    v_mfma_f32_32x32x16_bf16 v[32:47], v[132:135], v[224:227], v[32:47]
    ds_read_b64_tr_b16 v[132:133], v4 offset:26240
    ds_read_b64_tr_b16 v[134:135], v4 offset:26496
    v_and_b32 v159, v8, v229
    v_lshlrev_b32 v160, 16, v230
    v_and_b32 v161, v8, v230
    v_lshlrev_b32 v162, 16, v231
    v_mfma_f32_32x32x16_bf16 v[48:63], v[136:139], v[224:227], v[48:63]
    ds_read_b64_tr_b16 v[136:137], v4 offset:26272
    ds_read_b64_tr_b16 v[138:139], v4 offset:26528
    v_and_b32 v163, v8, v231
    v_fma_f32 v156, v156, v6, v7
    v_fma_f32 v157, v157, v6, v7
    v_mfma_f32_32x32x16_bf16 v[64:79], v[140:143], v[224:227], v[64:79]
    ds_read_b64_tr_b16 v[140:141], v4 offset:26304
    ds_read_b64_tr_b16 v[142:143], v4 offset:26560
    v_fma_f32 v158, v158, v6, v7
    v_fma_f32 v159, v159, v6, v7
    v_fma_f32 v160, v160, v6, v7
    s_waitcnt lgkmcnt(8)
    v_mfma_f32_32x32x16_bf16 v[80:95], v[144:147], v[224:227], v[80:95]
    ds_read_b64_tr_b16 v[144:145], v4 offset:26336
    ds_read_b64_tr_b16 v[146:147], v4 offset:26592
    v_fma_f32 v161, v161, v6, v7
    v_fma_f32 v162, v162, v6, v7
    v_fma_f32 v163, v163, v6, v7
    v_cvt_pk_bf16_f32 v228, v156, v157
    v_mfma_f32_32x32x16_bf16 v[96:111], v[148:151], v[224:227], v[96:111]
    ds_read_b64_tr_b16 v[148:149], v4 offset:26368
    ds_read_b64_tr_b16 v[150:151], v4 offset:26624
    v_cvt_pk_bf16_f32 v229, v158, v159
    v_cvt_pk_bf16_f32 v230, v160, v161
    v_cvt_pk_bf16_f32 v231, v162, v163
    v_mfma_f32_32x32x16_bf16 v[112:127], v[152:155], v[224:227], v[112:127]
    ds_read_b64_tr_b16 v[152:153], v4 offset:26400
    ds_read_b64_tr_b16 v[154:155], v4 offset:26656
    buffer_load_dwordx4 v[224:227], v2, s[20:23], s58 offen offset:1024 sc1
    s_barrier
    s_waitcnt lgkmcnt(6)
    v_mfma_f32_32x32x16_bf16 v[16:31], v[128:131], v[228:231], v[16:31]
    ds_read_b64_tr_b16 v[128:129], v4 offset:34944
    ds_read_b64_tr_b16 v[130:131], v4 offset:35200
    s_waitcnt vmcnt(10)
    v_lshlrev_b32 v156, 16, v232
    v_and_b32 v157, v8, v232
    v_lshlrev_b32 v158, 16, v233
    v_mfma_f32_32x32x16_bf16 v[32:47], v[132:135], v[228:231], v[32:47]
    ds_read_b64_tr_b16 v[132:133], v4 offset:34976
    ds_read_b64_tr_b16 v[134:135], v4 offset:35232
    v_and_b32 v159, v8, v233
    v_lshlrev_b32 v160, 16, v234
    v_and_b32 v161, v8, v234
    v_lshlrev_b32 v162, 16, v235
    v_mfma_f32_32x32x16_bf16 v[48:63], v[136:139], v[228:231], v[48:63]
    ds_read_b64_tr_b16 v[136:137], v4 offset:35008
    ds_read_b64_tr_b16 v[138:139], v4 offset:35264
    v_and_b32 v163, v8, v235
    v_fma_f32 v156, v156, v6, v7
    v_fma_f32 v157, v157, v6, v7
    v_mfma_f32_32x32x16_bf16 v[64:79], v[140:143], v[228:231], v[64:79]
    ds_read_b64_tr_b16 v[140:141], v4 offset:35040
    ds_read_b64_tr_b16 v[142:143], v4 offset:35296
    v_fma_f32 v158, v158, v6, v7
    v_fma_f32 v159, v159, v6, v7
    v_fma_f32 v160, v160, v6, v7
    s_waitcnt lgkmcnt(8)
    v_mfma_f32_32x32x16_bf16 v[80:95], v[144:147], v[228:231], v[80:95]
    ds_read_b64_tr_b16 v[144:145], v4 offset:35072
    ds_read_b64_tr_b16 v[146:147], v4 offset:35328
    v_fma_f32 v161, v161, v6, v7
    v_fma_f32 v162, v162, v6, v7
    v_fma_f32 v163, v163, v6, v7
    v_cvt_pk_bf16_f32 v232, v156, v157
    v_mfma_f32_32x32x16_bf16 v[96:111], v[148:151], v[228:231], v[96:111]
    ds_read_b64_tr_b16 v[148:149], v4 offset:35104
    ds_read_b64_tr_b16 v[150:151], v4 offset:35360
    v_cvt_pk_bf16_f32 v233, v158, v159
    v_cvt_pk_bf16_f32 v234, v160, v161
    v_cvt_pk_bf16_f32 v235, v162, v163
    v_mfma_f32_32x32x16_bf16 v[112:127], v[152:155], v[228:231], v[112:127]
    ds_read_b64_tr_b16 v[152:153], v4 offset:35136
    ds_read_b64_tr_b16 v[154:155], v4 offset:35392
    buffer_load_dwordx4 v[228:231], v2, s[20:23], s58 offen offset:2048 sc1
    s_waitcnt lgkmcnt(6)
    v_mfma_f32_32x32x16_bf16 v[16:31], v[128:131], v[232:235], v[16:31]
    ds_read_b64_tr_b16 v[128:129], v4 offset:43680
    ds_read_b64_tr_b16 v[130:131], v4 offset:43936
    s_waitcnt vmcnt(10)
    v_lshlrev_b32 v156, 16, v188
    v_and_b32 v157, v8, v188
    v_lshlrev_b32 v158, 16, v189
    v_mfma_f32_32x32x16_bf16 v[32:47], v[132:135], v[232:235], v[32:47]
    ds_read_b64_tr_b16 v[132:133], v4 offset:43712
    ds_read_b64_tr_b16 v[134:135], v4 offset:43968
    v_and_b32 v159, v8, v189
    v_lshlrev_b32 v160, 16, v190
    v_and_b32 v161, v8, v190
    v_lshlrev_b32 v162, 16, v191
    v_mfma_f32_32x32x16_bf16 v[48:63], v[136:139], v[232:235], v[48:63]
    ds_read_b64_tr_b16 v[136:137], v4 offset:43744
    ds_read_b64_tr_b16 v[138:139], v4 offset:44000
    v_and_b32 v163, v8, v191
    v_fma_f32 v156, v156, v6, v7
    v_fma_f32 v157, v157, v6, v7
    v_mfma_f32_32x32x16_bf16 v[64:79], v[140:143], v[232:235], v[64:79]
    ds_read_b64_tr_b16 v[140:141], v4 offset:43776
    ds_read_b64_tr_b16 v[142:143], v4 offset:44032
    v_fma_f32 v158, v158, v6, v7
    v_fma_f32 v159, v159, v6, v7
    v_fma_f32 v160, v160, v6, v7
    s_waitcnt lgkmcnt(8)
    v_mfma_f32_32x32x16_bf16 v[80:95], v[144:147], v[232:235], v[80:95]
    ds_read_b64_tr_b16 v[144:145], v4 offset:43808
    ds_read_b64_tr_b16 v[146:147], v4 offset:44064
    v_fma_f32 v161, v161, v6, v7
    v_fma_f32 v162, v162, v6, v7
    v_fma_f32 v163, v163, v6, v7
    v_cvt_pk_bf16_f32 v188, v156, v157
    v_mfma_f32_32x32x16_bf16 v[96:111], v[148:151], v[232:235], v[96:111]
    ds_read_b64_tr_b16 v[148:149], v4 offset:43840
    ds_read_b64_tr_b16 v[150:151], v4 offset:44096
    v_cvt_pk_bf16_f32 v189, v158, v159
    v_cvt_pk_bf16_f32 v190, v160, v161
    v_cvt_pk_bf16_f32 v191, v162, v163
    v_mfma_f32_32x32x16_bf16 v[112:127], v[152:155], v[232:235], v[112:127]
    ds_read_b64_tr_b16 v[152:153], v4 offset:43872
    ds_read_b64_tr_b16 v[154:155], v4 offset:44128
    buffer_load_dwordx4 v[232:235], v2, s[20:23], s58 offen offset:3072 sc1
    s_add_u32 s58, s58, 4096
    s_cmp_eq_u32 s58, s53
    s_cselect_b32 s58, s55, s58
    s_waitcnt lgkmcnt(6)
    v_mfma_f32_32x32x16_bf16 v[16:31], v[128:131], v[188:191], v[16:31]
    ds_read_b64_tr_b16 v[128:129], v4 offset:52416
    ds_read_b64_tr_b16 v[130:131], v4 offset:52672
    s_waitcnt vmcnt(10)
    v_lshlrev_b32 v156, 16, v192
    v_and_b32 v157, v8, v192
    v_lshlrev_b32 v158, 16, v193
    v_mfma_f32_32x32x16_bf16 v[32:47], v[132:135], v[188:191], v[32:47]
    ds_read_b64_tr_b16 v[132:133], v4 offset:52448
    ds_read_b64_tr_b16 v[134:135], v4 offset:52704
    v_and_b32 v159, v8, v193
    v_lshlrev_b32 v160, 16, v194
    v_and_b32 v161, v8, v194
    v_lshlrev_b32 v162, 16, v195
    v_mfma_f32_32x32x16_bf16 v[48:63], v[136:139], v[188:191], v[48:63]
    ds_read_b64_tr_b16 v[136:137], v4 offset:52480
    ds_read_b64_tr_b16 v[138:139], v4 offset:52736
    v_and_b32 v163, v8, v195
    v_fma_f32 v156, v156, v6, v7
    v_fma_f32 v157, v157, v6, v7
    v_mfma_f32_32x32x16_bf16 v[64:79], v[140:143], v[188:191], v[64:79]
    ds_read_b64_tr_b16 v[140:141], v4 offset:52512
    ds_read_b64_tr_b16 v[142:143], v4 offset:52768
    v_fma_f32 v158, v158, v6, v7
    v_fma_f32 v159, v159, v6, v7
    v_fma_f32 v160, v160, v6, v7
    s_waitcnt lgkmcnt(8)
    v_mfma_f32_32x32x16_bf16 v[80:95], v[144:147], v[188:191], v[80:95]
    ds_read_b64_tr_b16 v[144:145], v4 offset:52544
    ds_read_b64_tr_b16 v[146:147], v4 offset:52800
    v_fma_f32 v161, v161, v6, v7
    v_fma_f32 v162, v162, v6, v7
    v_fma_f32 v163, v163, v6, v7
    v_cvt_pk_bf16_f32 v192, v156, v157
    v_mfma_f32_32x32x16_bf16 v[96:111], v[148:151], v[188:191], v[96:111]
    ds_read_b64_tr_b16 v[148:149], v4 offset:52576
    ds_read_b64_tr_b16 v[150:151], v4 offset:52832
    v_cvt_pk_bf16_f32 v193, v158, v159
    v_cvt_pk_bf16_f32 v194, v160, v161
    v_cvt_pk_bf16_f32 v195, v162, v163
    v_mfma_f32_32x32x16_bf16 v[112:127], v[152:155], v[188:191], v[112:127]
    ds_read_b64_tr_b16 v[152:153], v4 offset:52608
    ds_read_b64_tr_b16 v[154:155], v4 offset:52864
    buffer_load_dwordx4 v[188:191], v2, s[20:23], s58 offen offset:0 sc1
    s_waitcnt lgkmcnt(6)
    v_mfma_f32_32x32x16_bf16 v[16:31], v[128:131], v[192:195], v[16:31]
    v_add_u32 v4, 0xeee0, v4
    ds_read_b64_tr_b16 v[128:129], v4 offset:0
    ds_read_b64_tr_b16 v[130:131], v4 offset:256
    s_waitcnt vmcnt(10)
    v_lshlrev_b32 v156, 16, v196
    v_and_b32 v157, v8, v196
    v_lshlrev_b32 v158, 16, v197
    v_mfma_f32_32x32x16_bf16 v[32:47], v[132:135], v[192:195], v[32:47]
    ds_read_b64_tr_b16 v[132:133], v4 offset:32
    ds_read_b64_tr_b16 v[134:135], v4 offset:288
    v_and_b32 v159, v8, v197
    v_lshlrev_b32 v160, 16, v198
    v_and_b32 v161, v8, v198
    v_lshlrev_b32 v162, 16, v199
    v_mfma_f32_32x32x16_bf16 v[48:63], v[136:139], v[192:195], v[48:63]
    ds_read_b64_tr_b16 v[136:137], v4 offset:64
    ds_read_b64_tr_b16 v[138:139], v4 offset:320
    v_and_b32 v163, v8, v199
    v_fma_f32 v156, v156, v6, v7
    v_fma_f32 v157, v157, v6, v7
    v_mfma_f32_32x32x16_bf16 v[64:79], v[140:143], v[192:195], v[64:79]
    ds_read_b64_tr_b16 v[140:141], v4 offset:96
    ds_read_b64_tr_b16 v[142:143], v4 offset:352
    v_fma_f32 v158, v158, v6, v7
    v_fma_f32 v159, v159, v6, v7
    v_fma_f32 v160, v160, v6, v7
    s_waitcnt lgkmcnt(8)
    v_mfma_f32_32x32x16_bf16 v[80:95], v[144:147], v[192:195], v[80:95]
    ds_read_b64_tr_b16 v[144:145], v4 offset:128
    ds_read_b64_tr_b16 v[146:147], v4 offset:384
    v_fma_f32 v161, v161, v6, v7
    v_fma_f32 v162, v162, v6, v7
    v_fma_f32 v163, v163, v6, v7
    v_cvt_pk_bf16_f32 v196, v156, v157
    v_mfma_f32_32x32x16_bf16 v[96:111], v[148:151], v[192:195], v[96:111]
    ds_read_b64_tr_b16 v[148:149], v4 offset:160
    ds_read_b64_tr_b16 v[150:151], v4 offset:416
    v_cvt_pk_bf16_f32 v197, v158, v159
    v_cvt_pk_bf16_f32 v198, v160, v161
    v_cvt_pk_bf16_f32 v199, v162, v163
    v_mfma_f32_32x32x16_bf16 v[112:127], v[152:155], v[192:195], v[112:127]
    ds_read_b64_tr_b16 v[152:153], v4 offset:192
    ds_read_b64_tr_b16 v[154:155], v4 offset:448
    buffer_load_dwordx4 v[192:195], v2, s[20:23], s58 offen offset:1024 sc1
    s_waitcnt lgkmcnt(6)
    v_mfma_f32_32x32x16_bf16 v[16:31], v[128:131], v[196:199], v[16:31]
    ds_read_b64_tr_b16 v[128:129], v4 offset:8736
    ds_read_b64_tr_b16 v[130:131], v4 offset:8992
    s_waitcnt vmcnt(10)
    v_lshlrev_b32 v156, 16, v200
    v_and_b32 v157, v8, v200
    v_lshlrev_b32 v158, 16, v201
    v_mfma_f32_32x32x16_bf16 v[32:47], v[132:135], v[196:199], v[32:47]
    ds_read_b64_tr_b16 v[132:133], v4 offset:8768
    ds_read_b64_tr_b16 v[134:135], v4 offset:9024
    v_and_b32 v159, v8, v201
    v_lshlrev_b32 v160, 16, v202
    v_and_b32 v161, v8, v202
    v_lshlrev_b32 v162, 16, v203
    v_mfma_f32_32x32x16_bf16 v[48:63], v[136:139], v[196:199], v[48:63]
    ds_read_b64_tr_b16 v[136:137], v4 offset:8800
    ds_read_b64_tr_b16 v[138:139], v4 offset:9056
    v_and_b32 v163, v8, v203
    v_fma_f32 v156, v156, v6, v7
    v_fma_f32 v157, v157, v6, v7
    v_mfma_f32_32x32x16_bf16 v[64:79], v[140:143], v[196:199], v[64:79]
    ds_read_b64_tr_b16 v[140:141], v4 offset:8832
    ds_read_b64_tr_b16 v[142:143], v4 offset:9088
    v_fma_f32 v158, v158, v6, v7
    v_fma_f32 v159, v159, v6, v7
    v_fma_f32 v160, v160, v6, v7
    s_waitcnt lgkmcnt(8)
    v_mfma_f32_32x32x16_bf16 v[80:95], v[144:147], v[196:199], v[80:95]
    ds_read_b64_tr_b16 v[144:145], v4 offset:8864
    ds_read_b64_tr_b16 v[146:147], v4 offset:9120
    v_fma_f32 v161, v161, v6, v7
    v_fma_f32 v162, v162, v6, v7
    v_fma_f32 v163, v163, v6, v7
    v_cvt_pk_bf16_f32 v200, v156, v157
    v_mfma_f32_32x32x16_bf16 v[96:111], v[148:151], v[196:199], v[96:111]
    ds_read_b64_tr_b16 v[148:149], v4 offset:8896
    ds_read_b64_tr_b16 v[150:151], v4 offset:9152
    v_cvt_pk_bf16_f32 v201, v158, v159
    v_cvt_pk_bf16_f32 v202, v160, v161
    v_cvt_pk_bf16_f32 v203, v162, v163
    v_mfma_f32_32x32x16_bf16 v[112:127], v[152:155], v[196:199], v[112:127]
    ds_read_b64_tr_b16 v[152:153], v4 offset:8928
    ds_read_b64_tr_b16 v[154:155], v4 offset:9184
    buffer_load_dwordx4 v[196:199], v2, s[20:23], s58 offen offset:2048 sc1
    s_waitcnt lgkmcnt(6)
    v_mfma_f32_32x32x16_bf16 v[16:31], v[128:131], v[200:203], v[16:31]
    ds_read_b64_tr_b16 v[128:129], v4 offset:17472
    ds_read_b64_tr_b16 v[130:131], v4 offset:17728
    s_waitcnt vmcnt(10)
    v_lshlrev_b32 v156, 16, v204
    v_and_b32 v157, v8, v204
    v_lshlrev_b32 v158, 16, v205
    v_mfma_f32_32x32x16_bf16 v[32:47], v[132:135], v[200:203], v[32:47]
    ds_read_b64_tr_b16 v[132:133], v4 offset:17504
    ds_read_b64_tr_b16 v[134:135], v4 offset:17760
    v_and_b32 v159, v8, v205
    v_lshlrev_b32 v160, 16, v206
    v_and_b32 v161, v8, v206
    v_lshlrev_b32 v162, 16, v207
    v_mfma_f32_32x32x16_bf16 v[48:63], v[136:139], v[200:203], v[48:63]
    ds_read_b64_tr_b16 v[136:137], v4 offset:17536
    ds_read_b64_tr_b16 v[138:139], v4 offset:17792
    v_and_b32 v163, v8, v207
    v_fma_f32 v156, v156, v6, v7
    v_fma_f32 v157, v157, v6, v7
    v_mfma_f32_32x32x16_bf16 v[64:79], v[140:143], v[200:203], v[64:79]
    ds_read_b64_tr_b16 v[140:141], v4 offset:17568
    ds_read_b64_tr_b16 v[142:143], v4 offset:17824
    v_fma_f32 v158, v158, v6, v7
    v_fma_f32 v159, v159, v6, v7
    v_fma_f32 v160, v160, v6, v7
    s_waitcnt lgkmcnt(8)
    v_mfma_f32_32x32x16_bf16 v[80:95], v[144:147], v[200:203], v[80:95]
    ds_read_b64_tr_b16 v[144:145], v4 offset:17600
    ds_read_b64_tr_b16 v[146:147], v4 offset:17856
    v_fma_f32 v161, v161, v6, v7
    v_fma_f32 v162, v162, v6, v7
    v_fma_f32 v163, v163, v6, v7
    v_cvt_pk_bf16_f32 v204, v156, v157
    v_mfma_f32_32x32x16_bf16 v[96:111], v[148:151], v[200:203], v[96:111]
    ds_read_b64_tr_b16 v[148:149], v4 offset:17632
    ds_read_b64_tr_b16 v[150:151], v4 offset:17888
    v_cvt_pk_bf16_f32 v205, v158, v159
    v_cvt_pk_bf16_f32 v206, v160, v161
    v_cvt_pk_bf16_f32 v207, v162, v163
    v_mfma_f32_32x32x16_bf16 v[112:127], v[152:155], v[200:203], v[112:127]
    ds_read_b64_tr_b16 v[152:153], v4 offset:17664
    ds_read_b64_tr_b16 v[154:155], v4 offset:17920
    buffer_load_dwordx4 v[200:203], v2, s[20:23], s58 offen offset:3072 sc1
    s_add_u32 s58, s58, 4096
    s_cmp_eq_u32 s58, s53
    s_cselect_b32 s58, s55, s58
    s_waitcnt lgkmcnt(6)
    v_mfma_f32_32x32x16_bf16 v[16:31], v[128:131], v[204:207], v[16:31]
    ds_read_b64_tr_b16 v[128:129], v4 offset:26208
    ds_read_b64_tr_b16 v[130:131], v4 offset:26464
    s_waitcnt vmcnt(10)
    v_lshlrev_b32 v156, 16, v208
    v_and_b32 v157, v8, v208
    v_lshlrev_b32 v158, 16, v209
    v_mfma_f32_32x32x16_bf16 v[32:47], v[132:135], v[204:207], v[32:47]
    ds_read_b64_tr_b16 v[132:133], v4 offset:26240
    ds_read_b64_tr_b16 v[134:135], v4 offset:26496
    v_and_b32 v159, v8, v209
    v_lshlrev_b32 v160, 16, v210
    v_and_b32 v161, v8, v210
    v_lshlrev_b32 v162, 16, v211
    v_mfma_f32_32x32x16_bf16 v[48:63], v[136:139], v[204:207], v[48:63]
    ds_read_b64_tr_b16 v[136:137], v4 offset:26272
    ds_read_b64_tr_b16 v[138:139], v4 offset:26528
    v_and_b32 v163, v8, v211
    v_fma_f32 v156, v156, v6, v7
    v_fma_f32 v157, v157, v6, v7
    v_mfma_f32_32x32x16_bf16 v[64:79], v[140:143], v[204:207], v[64:79]
    ds_read_b64_tr_b16 v[140:141], v4 offset:26304
    ds_read_b64_tr_b16 v[142:143], v4 offset:26560
    v_fma_f32 v158, v158, v6, v7
    v_fma_f32 v159, v159, v6, v7
    v_fma_f32 v160, v160, v6, v7
    s_waitcnt lgkmcnt(8)
    v_mfma_f32_32x32x16_bf16 v[80:95], v[144:147], v[204:207], v[80:95]
    ds_read_b64_tr_b16 v[144:145], v4 offset:26336
    ds_read_b64_tr_b16 v[146:147], v4 offset:26592
    v_fma_f32 v161, v161, v6, v7
    v_fma_f32 v162, v162, v6, v7
    v_fma_f32 v163, v163, v6, v7
    v_cvt_pk_bf16_f32 v208, v156, v157
    v_mfma_f32_32x32x16_bf16 v[96:111], v[148:151], v[204:207], v[96:111]
    ds_read_b64_tr_b16 v[148:149], v4 offset:26368
    ds_read_b64_tr_b16 v[150:151], v4 offset:26624
    v_cvt_pk_bf16_f32 v209, v158, v159
    v_cvt_pk_bf16_f32 v210, v160, v161
    v_cvt_pk_bf16_f32 v211, v162, v163
    v_mfma_f32_32x32x16_bf16 v[112:127], v[152:155], v[204:207], v[112:127]
    ds_read_b64_tr_b16 v[152:153], v4 offset:26400
    ds_read_b64_tr_b16 v[154:155], v4 offset:26656
    s_barrier
    s_waitcnt lgkmcnt(6)
    v_mfma_f32_32x32x16_bf16 v[16:31], v[128:131], v[208:211], v[16:31]
    v_add_u32 v4, 0xfffe2240, v4
    ds_read_b64_tr_b16 v[128:129], v4 offset:0
    ds_read_b64_tr_b16 v[130:131], v4 offset:256
    s_waitcnt vmcnt(9)
    v_lshlrev_b32 v156, 16, v212
    v_and_b32 v157, v8, v212
    v_lshlrev_b32 v158, 16, v213
    v_mfma_f32_32x32x16_bf16 v[32:47], v[132:135], v[208:211], v[32:47]
    ds_read_b64_tr_b16 v[132:133], v4 offset:32
    ds_read_b64_tr_b16 v[134:135], v4 offset:288
    v_and_b32 v159, v8, v213
    v_lshlrev_b32 v160, 16, v214
    v_and_b32 v161, v8, v214
    v_lshlrev_b32 v162, 16, v215
    v_mfma_f32_32x32x16_bf16 v[48:63], v[136:139], v[208:211], v[48:63]
    ds_read_b64_tr_b16 v[136:137], v4 offset:64
    ds_read_b64_tr_b16 v[138:139], v4 offset:320
    v_and_b32 v163, v8, v215
    v_fma_f32 v156, v156, v6, v7
    v_fma_f32 v157, v157, v6, v7
    v_mfma_f32_32x32x16_bf16 v[64:79], v[140:143], v[208:211], v[64:79]
    ds_read_b64_tr_b16 v[140:141], v4 offset:96
    ds_read_b64_tr_b16 v[142:143], v4 offset:352
    v_fma_f32 v158, v158, v6, v7
    v_fma_f32 v159, v159, v6, v7
    v_fma_f32 v160, v160, v6, v7
    s_waitcnt lgkmcnt(8)
    v_mfma_f32_32x32x16_bf16 v[80:95], v[144:147], v[208:211], v[80:95]
    ds_read_b64_tr_b16 v[144:145], v4 offset:128
    ds_read_b64_tr_b16 v[146:147], v4 offset:384
    v_fma_f32 v161, v161, v6, v7
    v_fma_f32 v162, v162, v6, v7
    v_fma_f32 v163, v163, v6, v7
    v_cvt_pk_bf16_f32 v212, v156, v157
    v_mfma_f32_32x32x16_bf16 v[96:111], v[148:151], v[208:211], v[96:111]
    ds_read_b64_tr_b16 v[148:149], v4 offset:160
    ds_read_b64_tr_b16 v[150:151], v4 offset:416
    v_cvt_pk_bf16_f32 v213, v158, v159
    v_cvt_pk_bf16_f32 v214, v160, v161
    v_cvt_pk_bf16_f32 v215, v162, v163
    v_mfma_f32_32x32x16_bf16 v[112:127], v[152:155], v[208:211], v[112:127]
    ds_read_b64_tr_b16 v[152:153], v4 offset:192
    ds_read_b64_tr_b16 v[154:155], v4 offset:448
    s_waitcnt lgkmcnt(6)
    v_mfma_f32_32x32x16_bf16 v[16:31], v[128:131], v[212:215], v[16:31]
    ds_read_b64_tr_b16 v[128:129], v4 offset:8736
    ds_read_b64_tr_b16 v[130:131], v4 offset:8992
    s_waitcnt vmcnt(8)
    v_lshlrev_b32 v156, 16, v216
    v_and_b32 v157, v8, v216
    v_lshlrev_b32 v158, 16, v217
    v_mfma_f32_32x32x16_bf16 v[32:47], v[132:135], v[212:215], v[32:47]
    ds_read_b64_tr_b16 v[132:133], v4 offset:8768
    ds_read_b64_tr_b16 v[134:135], v4 offset:9024
    v_and_b32 v159, v8, v217
    v_lshlrev_b32 v160, 16, v218
    v_and_b32 v161, v8, v218
    v_lshlrev_b32 v162, 16, v219
    v_mfma_f32_32x32x16_bf16 v[48:63], v[136:139], v[212:215], v[48:63]
    ds_read_b64_tr_b16 v[136:137], v4 offset:8800
    ds_read_b64_tr_b16 v[138:139], v4 offset:9056
    v_and_b32 v163, v8, v219
    v_fma_f32 v156, v156, v6, v7
    v_fma_f32 v157, v157, v6, v7
    v_mfma_f32_32x32x16_bf16 v[64:79], v[140:143], v[212:215], v[64:79]
    ds_read_b64_tr_b16 v[140:141], v4 offset:8832
    ds_read_b64_tr_b16 v[142:143], v4 offset:9088
    v_fma_f32 v158, v158, v6, v7
    v_fma_f32 v159, v159, v6, v7
    v_fma_f32 v160, v160, v6, v7
    s_waitcnt lgkmcnt(8)
    v_mfma_f32_32x32x16_bf16 v[80:95], v[144:147], v[212:215], v[80:95]
    ds_read_b64_tr_b16 v[144:145], v4 offset:8864
    ds_read_b64_tr_b16 v[146:147], v4 offset:9120
    v_fma_f32 v161, v161, v6, v7
    v_fma_f32 v162, v162, v6, v7
    v_fma_f32 v163, v163, v6, v7
    v_cvt_pk_bf16_f32 v216, v156, v157
    v_mfma_f32_32x32x16_bf16 v[96:111], v[148:151], v[212:215], v[96:111]
    ds_read_b64_tr_b16 v[148:149], v4 offset:8896
    ds_read_b64_tr_b16 v[150:151], v4 offset:9152
    v_cvt_pk_bf16_f32 v217, v158, v159
    v_cvt_pk_bf16_f32 v218, v160, v161
    v_cvt_pk_bf16_f32 v219, v162, v163
    v_mfma_f32_32x32x16_bf16 v[112:127], v[152:155], v[212:215], v[112:127]
    ds_read_b64_tr_b16 v[152:153], v4 offset:8928
    ds_read_b64_tr_b16 v[154:155], v4 offset:9184
    s_waitcnt lgkmcnt(6)
    v_mfma_f32_32x32x16_bf16 v[16:31], v[128:131], v[216:219], v[16:31]
    ds_read_b64_tr_b16 v[128:129], v4 offset:17472
    ds_read_b64_tr_b16 v[130:131], v4 offset:17728
    s_waitcnt vmcnt(7)
    v_lshlrev_b32 v156, 16, v220
    v_and_b32 v157, v8, v220
    v_lshlrev_b32 v158, 16, v221
    v_and_b32 v159, v8, v221
    v_mfma_f32_32x32x16_bf16 v[32:47], v[132:135], v[216:219], v[32:47]
    ds_read_b64_tr_b16 v[132:133], v4 offset:17504
    ds_read_b64_tr_b16 v[134:135], v4 offset:17760
    v_lshlrev_b32 v160, 16, v222
    v_and_b32 v161, v8, v222
    v_lshlrev_b32 v162, 16, v223
    v_and_b32 v163, v8, v223
    v_mfma_f32_32x32x16_bf16 v[48:63], v[136:139], v[216:219], v[48:63]
    ds_read_b64_tr_b16 v[136:137], v4 offset:17536
    ds_read_b64_tr_b16 v[138:139], v4 offset:17792
    v_fma_f32 v156, v156, v6, v7
    v_fma_f32 v157, v157, v6, v7
    v_fma_f32 v158, v158, v6, v7
    v_fma_f32 v159, v159, v6, v7
    v_mfma_f32_32x32x16_bf16 v[64:79], v[140:143], v[216:219], v[64:79]
    ds_read_b64_tr_b16 v[140:141], v4 offset:17568
    ds_read_b64_tr_b16 v[142:143], v4 offset:17824
    v_fma_f32 v160, v160, v6, v7
    v_fma_f32 v161, v161, v6, v7
    v_fma_f32 v162, v162, v6, v7
    v_fma_f32 v163, v163, v6, v7
    s_waitcnt lgkmcnt(8)
    v_mfma_f32_32x32x16_bf16 v[80:95], v[144:147], v[216:219], v[80:95]
    ds_read_b64_tr_b16 v[144:145], v4 offset:17600
    ds_read_b64_tr_b16 v[146:147], v4 offset:17856
    v_cvt_pk_bf16_f32 v220, v156, v157
    v_cvt_pk_bf16_f32 v221, v158, v159
    v_cvt_pk_bf16_f32 v222, v160, v161
    v_cvt_pk_bf16_f32 v223, v162, v163
    v_mfma_f32_32x32x16_bf16 v[96:111], v[148:151], v[216:219], v[96:111]
    ds_read_b64_tr_b16 v[148:149], v4 offset:17632
    ds_read_b64_tr_b16 v[150:151], v4 offset:17888
    s_waitcnt vmcnt(6)
    v_lshlrev_b32 v156, 16, v224
    v_and_b32 v157, v8, v224
    v_lshlrev_b32 v158, 16, v225
    v_and_b32 v159, v8, v225
    v_mfma_f32_32x32x16_bf16 v[112:127], v[152:155], v[216:219], v[112:127]
    ds_read_b64_tr_b16 v[152:153], v4 offset:17664
    ds_read_b64_tr_b16 v[154:155], v4 offset:17920
    v_lshlrev_b32 v160, 16, v226
    v_and_b32 v161, v8, v226
    v_lshlrev_b32 v162, 16, v227
    v_and_b32 v163, v8, v227
    s_waitcnt lgkmcnt(6)
    v_mfma_f32_32x32x16_bf16 v[16:31], v[128:131], v[220:223], v[16:31]
    ds_read_b64_tr_b16 v[128:129], v4 offset:26208
    ds_read_b64_tr_b16 v[130:131], v4 offset:26464
    v_fma_f32 v156, v156, v6, v7
    v_fma_f32 v157, v157, v6, v7
    v_fma_f32 v158, v158, v6, v7
    v_fma_f32 v159, v159, v6, v7
    v_mfma_f32_32x32x16_bf16 v[32:47], v[132:135], v[220:223], v[32:47]
    ds_read_b64_tr_b16 v[132:133], v4 offset:26240
    ds_read_b64_tr_b16 v[134:135], v4 offset:26496
    v_fma_f32 v160, v160, v6, v7
    v_fma_f32 v161, v161, v6, v7
    v_fma_f32 v162, v162, v6, v7
    v_fma_f32 v163, v163, v6, v7
    v_mfma_f32_32x32x16_bf16 v[48:63], v[136:139], v[220:223], v[48:63]
    ds_read_b64_tr_b16 v[136:137], v4 offset:26272
    ds_read_b64_tr_b16 v[138:139], v4 offset:26528
    v_cvt_pk_bf16_f32 v224, v156, v157
    v_cvt_pk_bf16_f32 v225, v158, v159
    v_cvt_pk_bf16_f32 v226, v160, v161
    v_cvt_pk_bf16_f32 v227, v162, v163
    v_mfma_f32_32x32x16_bf16 v[64:79], v[140:143], v[220:223], v[64:79]
    ds_read_b64_tr_b16 v[140:141], v4 offset:26304
    ds_read_b64_tr_b16 v[142:143], v4 offset:26560
    s_waitcnt vmcnt(5)
    v_lshlrev_b32 v156, 16, v228
    v_and_b32 v157, v8, v228
    v_lshlrev_b32 v158, 16, v229
    v_and_b32 v159, v8, v229
    s_waitcnt lgkmcnt(8)
    v_mfma_f32_32x32x16_bf16 v[80:95], v[144:147], v[220:223], v[80:95]
    ds_read_b64_tr_b16 v[144:145], v4 offset:26336
    ds_read_b64_tr_b16 v[146:147], v4 offset:26592
    v_lshlrev_b32 v160, 16, v230
    v_and_b32 v161, v8, v230
    v_lshlrev_b32 v162, 16, v231
    v_and_b32 v163, v8, v231
    v_mfma_f32_32x32x16_bf16 v[96:111], v[148:151], v[220:223], v[96:111]
    ds_read_b64_tr_b16 v[148:149], v4 offset:26368
    ds_read_b64_tr_b16 v[150:151], v4 offset:26624
    v_fma_f32 v156, v156, v6, v7
    v_fma_f32 v157, v157, v6, v7
    v_fma_f32 v158, v158, v6, v7
    v_fma_f32 v159, v159, v6, v7
    v_mfma_f32_32x32x16_bf16 v[112:127], v[152:155], v[220:223], v[112:127]
    ds_read_b64_tr_b16 v[152:153], v4 offset:26400
    ds_read_b64_tr_b16 v[154:155], v4 offset:26656
    v_fma_f32 v160, v160, v6, v7
    v_fma_f32 v161, v161, v6, v7
    v_fma_f32 v162, v162, v6, v7
    v_fma_f32 v163, v163, v6, v7
    s_barrier
    s_waitcnt lgkmcnt(6)
    v_mfma_f32_32x32x16_bf16 v[16:31], v[128:131], v[224:227], v[16:31]
    ds_read_b64_tr_b16 v[128:129], v4 offset:34944
    ds_read_b64_tr_b16 v[130:131], v4 offset:35200
    v_cvt_pk_bf16_f32 v228, v156, v157
    v_cvt_pk_bf16_f32 v229, v158, v159
    v_cvt_pk_bf16_f32 v230, v160, v161
    v_cvt_pk_bf16_f32 v231, v162, v163
    v_mfma_f32_32x32x16_bf16 v[32:47], v[132:135], v[224:227], v[32:47]
    ds_read_b64_tr_b16 v[132:133], v4 offset:34976
    ds_read_b64_tr_b16 v[134:135], v4 offset:35232
    s_waitcnt vmcnt(4)
    v_lshlrev_b32 v156, 16, v232
    v_and_b32 v157, v8, v232
    v_lshlrev_b32 v158, 16, v233
    v_and_b32 v159, v8, v233
    v_mfma_f32_32x32x16_bf16 v[48:63], v[136:139], v[224:227], v[48:63]
    ds_read_b64_tr_b16 v[136:137], v4 offset:35008
    ds_read_b64_tr_b16 v[138:139], v4 offset:35264
    v_lshlrev_b32 v160, 16, v234
    v_and_b32 v161, v8, v234
    v_lshlrev_b32 v162, 16, v235
    v_and_b32 v163, v8, v235
    v_mfma_f32_32x32x16_bf16 v[64:79], v[140:143], v[224:227], v[64:79]
    ds_read_b64_tr_b16 v[140:141], v4 offset:35040
    ds_read_b64_tr_b16 v[142:143], v4 offset:35296
    v_fma_f32 v156, v156, v6, v7
    v_fma_f32 v157, v157, v6, v7
    v_fma_f32 v158, v158, v6, v7
    v_fma_f32 v159, v159, v6, v7
    s_waitcnt lgkmcnt(8)
    v_mfma_f32_32x32x16_bf16 v[80:95], v[144:147], v[224:227], v[80:95]
    ds_read_b64_tr_b16 v[144:145], v4 offset:35072
    ds_read_b64_tr_b16 v[146:147], v4 offset:35328
    v_fma_f32 v160, v160, v6, v7
    v_fma_f32 v161, v161, v6, v7
    v_fma_f32 v162, v162, v6, v7
    v_fma_f32 v163, v163, v6, v7
    v_mfma_f32_32x32x16_bf16 v[96:111], v[148:151], v[224:227], v[96:111]
    ds_read_b64_tr_b16 v[148:149], v4 offset:35104
    ds_read_b64_tr_b16 v[150:151], v4 offset:35360
    v_cvt_pk_bf16_f32 v232, v156, v157
    v_cvt_pk_bf16_f32 v233, v158, v159
    v_cvt_pk_bf16_f32 v234, v160, v161
    v_cvt_pk_bf16_f32 v235, v162, v163
    v_mfma_f32_32x32x16_bf16 v[112:127], v[152:155], v[224:227], v[112:127]
    ds_read_b64_tr_b16 v[152:153], v4 offset:35136
    ds_read_b64_tr_b16 v[154:155], v4 offset:35392
    s_waitcnt vmcnt(3)
    v_lshlrev_b32 v156, 16, v188
    v_and_b32 v157, v8, v188
    v_lshlrev_b32 v158, 16, v189
    v_and_b32 v159, v8, v189
    s_waitcnt lgkmcnt(6)
    v_mfma_f32_32x32x16_bf16 v[16:31], v[128:131], v[228:231], v[16:31]
    ds_read_b64_tr_b16 v[128:129], v4 offset:43680
    ds_read_b64_tr_b16 v[130:131], v4 offset:43936
    v_lshlrev_b32 v160, 16, v190
    v_and_b32 v161, v8, v190
    v_lshlrev_b32 v162, 16, v191
    v_and_b32 v163, v8, v191
    v_mfma_f32_32x32x16_bf16 v[32:47], v[132:135], v[228:231], v[32:47]
    ds_read_b64_tr_b16 v[132:133], v4 offset:43712
    ds_read_b64_tr_b16 v[134:135], v4 offset:43968
    v_fma_f32 v156, v156, v6, v7
    v_fma_f32 v157, v157, v6, v7
    v_fma_f32 v158, v158, v6, v7
    v_fma_f32 v159, v159, v6, v7
    v_mfma_f32_32x32x16_bf16 v[48:63], v[136:139], v[228:231], v[48:63]
    ds_read_b64_tr_b16 v[136:137], v4 offset:43744
    ds_read_b64_tr_b16 v[138:139], v4 offset:44000
    v_fma_f32 v160, v160, v6, v7
    v_fma_f32 v161, v161, v6, v7
    v_fma_f32 v162, v162, v6, v7
    v_fma_f32 v163, v163, v6, v7
    v_mfma_f32_32x32x16_bf16 v[64:79], v[140:143], v[228:231], v[64:79]
    ds_read_b64_tr_b16 v[140:141], v4 offset:43776
    ds_read_b64_tr_b16 v[142:143], v4 offset:44032
    v_cvt_pk_bf16_f32 v188, v156, v157
    v_cvt_pk_bf16_f32 v189, v158, v159
    v_cvt_pk_bf16_f32 v190, v160, v161
    v_cvt_pk_bf16_f32 v191, v162, v163
    s_waitcnt lgkmcnt(8)
    v_mfma_f32_32x32x16_bf16 v[80:95], v[144:147], v[228:231], v[80:95]
    ds_read_b64_tr_b16 v[144:145], v4 offset:43808
    ds_read_b64_tr_b16 v[146:147], v4 offset:44064
    s_waitcnt vmcnt(2)
    v_lshlrev_b32 v156, 16, v192
    v_and_b32 v157, v8, v192
    v_lshlrev_b32 v158, 16, v193
    v_and_b32 v159, v8, v193
    v_mfma_f32_32x32x16_bf16 v[96:111], v[148:151], v[228:231], v[96:111]
    ds_read_b64_tr_b16 v[148:149], v4 offset:43840
    ds_read_b64_tr_b16 v[150:151], v4 offset:44096
    v_lshlrev_b32 v160, 16, v194
    v_and_b32 v161, v8, v194
    v_lshlrev_b32 v162, 16, v195
    v_and_b32 v163, v8, v195
    v_mfma_f32_32x32x16_bf16 v[112:127], v[152:155], v[228:231], v[112:127]
    ds_read_b64_tr_b16 v[152:153], v4 offset:43872
    ds_read_b64_tr_b16 v[154:155], v4 offset:44128
    v_fma_f32 v156, v156, v6, v7
    v_fma_f32 v157, v157, v6, v7
    v_fma_f32 v158, v158, v6, v7
    v_fma_f32 v159, v159, v6, v7
    s_waitcnt lgkmcnt(6)
    v_mfma_f32_32x32x16_bf16 v[16:31], v[128:131], v[232:235], v[16:31]
    ds_read_b64_tr_b16 v[128:129], v4 offset:52416
    ds_read_b64_tr_b16 v[130:131], v4 offset:52672
    v_fma_f32 v160, v160, v6, v7
    v_fma_f32 v161, v161, v6, v7
    v_fma_f32 v162, v162, v6, v7
    v_fma_f32 v163, v163, v6, v7
    v_mfma_f32_32x32x16_bf16 v[32:47], v[132:135], v[232:235], v[32:47]
    ds_read_b64_tr_b16 v[132:133], v4 offset:52448
    ds_read_b64_tr_b16 v[134:135], v4 offset:52704
    v_cvt_pk_bf16_f32 v192, v156, v157
    v_cvt_pk_bf16_f32 v193, v158, v159
    v_cvt_pk_bf16_f32 v194, v160, v161
    v_cvt_pk_bf16_f32 v195, v162, v163
    v_mfma_f32_32x32x16_bf16 v[48:63], v[136:139], v[232:235], v[48:63]
    ds_read_b64_tr_b16 v[136:137], v4 offset:52480
    ds_read_b64_tr_b16 v[138:139], v4 offset:52736
    s_waitcnt vmcnt(1)
    v_lshlrev_b32 v156, 16, v196
    v_and_b32 v157, v8, v196
    v_lshlrev_b32 v158, 16, v197
    v_and_b32 v159, v8, v197
    v_mfma_f32_32x32x16_bf16 v[64:79], v[140:143], v[232:235], v[64:79]
    ds_read_b64_tr_b16 v[140:141], v4 offset:52512
    ds_read_b64_tr_b16 v[142:143], v4 offset:52768
    v_lshlrev_b32 v160, 16, v198
    v_and_b32 v161, v8, v198
    v_lshlrev_b32 v162, 16, v199
    v_and_b32 v163, v8, v199
    s_waitcnt lgkmcnt(8)
    v_mfma_f32_32x32x16_bf16 v[80:95], v[144:147], v[232:235], v[80:95]
    ds_read_b64_tr_b16 v[144:145], v4 offset:52544
    ds_read_b64_tr_b16 v[146:147], v4 offset:52800
    v_fma_f32 v156, v156, v6, v7
    v_fma_f32 v157, v157, v6, v7
    v_fma_f32 v158, v158, v6, v7
    v_fma_f32 v159, v159, v6, v7
    v_mfma_f32_32x32x16_bf16 v[96:111], v[148:151], v[232:235], v[96:111]
    ds_read_b64_tr_b16 v[148:149], v4 offset:52576
    ds_read_b64_tr_b16 v[150:151], v4 offset:52832
    v_fma_f32 v160, v160, v6, v7
    v_fma_f32 v161, v161, v6, v7
    v_fma_f32 v162, v162, v6, v7
    v_fma_f32 v163, v163, v6, v7
    v_mfma_f32_32x32x16_bf16 v[112:127], v[152:155], v[232:235], v[112:127]
    ds_read_b64_tr_b16 v[152:153], v4 offset:52608
    ds_read_b64_tr_b16 v[154:155], v4 offset:52864
    v_cvt_pk_bf16_f32 v196, v156, v157
    v_cvt_pk_bf16_f32 v197, v158, v159
    v_cvt_pk_bf16_f32 v198, v160, v161
    v_cvt_pk_bf16_f32 v199, v162, v163
    s_waitcnt lgkmcnt(6)
    v_mfma_f32_32x32x16_bf16 v[16:31], v[128:131], v[188:191], v[16:31]
    v_add_u32 v4, 0xeee0, v4
    ds_read_b64_tr_b16 v[128:129], v4 offset:0
    ds_read_b64_tr_b16 v[130:131], v4 offset:256
    s_waitcnt vmcnt(0)
    v_lshlrev_b32 v156, 16, v200
    v_and_b32 v157, v8, v200
    v_lshlrev_b32 v158, 16, v201
    v_and_b32 v159, v8, v201
    v_mfma_f32_32x32x16_bf16 v[32:47], v[132:135], v[188:191], v[32:47]
    ds_read_b64_tr_b16 v[132:133], v4 offset:8736
    ds_read_b64_tr_b16 v[134:135], v4 offset:8992
    v_lshlrev_b32 v160, 16, v202
    v_and_b32 v161, v8, v202
    v_lshlrev_b32 v162, 16, v203
    v_and_b32 v163, v8, v203
    v_mfma_f32_32x32x16_bf16 v[48:63], v[136:139], v[188:191], v[48:63]
    ds_read_b64_tr_b16 v[136:137], v4 offset:17472
    ds_read_b64_tr_b16 v[138:139], v4 offset:17728
    v_fma_f32 v156, v156, v6, v7
    v_fma_f32 v157, v157, v6, v7
    v_fma_f32 v158, v158, v6, v7
    v_fma_f32 v159, v159, v6, v7
    v_mfma_f32_32x32x16_bf16 v[64:79], v[140:143], v[188:191], v[64:79]
    ds_read_b64_tr_b16 v[140:141], v4 offset:32
    ds_read_b64_tr_b16 v[142:143], v4 offset:288
    v_fma_f32 v160, v160, v6, v7
    v_fma_f32 v161, v161, v6, v7
    v_fma_f32 v162, v162, v6, v7
    v_fma_f32 v163, v163, v6, v7
    s_waitcnt lgkmcnt(8)
    v_mfma_f32_32x32x16_bf16 v[80:95], v[144:147], v[188:191], v[80:95]
    ds_read_b64_tr_b16 v[144:145], v4 offset:8768
    ds_read_b64_tr_b16 v[146:147], v4 offset:9024
    v_cvt_pk_bf16_f32 v200, v156, v157
    v_cvt_pk_bf16_f32 v201, v158, v159
    v_cvt_pk_bf16_f32 v202, v160, v161
    v_cvt_pk_bf16_f32 v203, v162, v163
    v_mfma_f32_32x32x16_bf16 v[96:111], v[148:151], v[188:191], v[96:111]
    ds_read_b64_tr_b16 v[148:149], v4 offset:17504
    ds_read_b64_tr_b16 v[150:151], v4 offset:17760
    v_mfma_f32_32x32x16_bf16 v[112:127], v[152:155], v[188:191], v[112:127]
    ds_read_b64_tr_b16 v[152:153], v4 offset:64
    ds_read_b64_tr_b16 v[154:155], v4 offset:320
    s_waitcnt lgkmcnt(6)
    v_mfma_f32_32x32x16_bf16 v[16:31], v[128:131], v[192:195], v[16:31]
    ds_read_b64_tr_b16 v[128:129], v4 offset:8800
    ds_read_b64_tr_b16 v[130:131], v4 offset:9056
    v_mfma_f32_32x32x16_bf16 v[16:31], v[132:135], v[196:199], v[16:31]
    ds_read_b64_tr_b16 v[132:133], v4 offset:17536
    ds_read_b64_tr_b16 v[134:135], v4 offset:17792
    v_mfma_f32_32x32x16_bf16 v[16:31], v[136:139], v[200:203], v[16:31]
    ds_read_b64_tr_b16 v[136:137], v4 offset:96
    ds_read_b64_tr_b16 v[138:139], v4 offset:352
    v_mfma_f32_32x32x16_bf16 v[32:47], v[140:143], v[192:195], v[32:47]
    ds_read_b64_tr_b16 v[140:141], v4 offset:8832
    ds_read_b64_tr_b16 v[142:143], v4 offset:9088
    s_waitcnt lgkmcnt(8)
    v_mfma_f32_32x32x16_bf16 v[32:47], v[144:147], v[196:199], v[32:47]
    ds_read_b64_tr_b16 v[144:145], v4 offset:17568
    ds_read_b64_tr_b16 v[146:147], v4 offset:17824
    s_nop 2
    v_max_f32 v16, 0, v16
    v_max_f32 v17, 0, v17
    v_max_f32 v18, 0, v18
    v_max_f32 v19, 0, v19
    v_mul_f32 v16, v16, v20
    v_mul_f32 v17, v17, v21
    v_mul_f32 v18, v18, v22
    v_mfma_f32_32x32x16_bf16 v[32:47], v[148:151], v[200:203], v[32:47]
    ds_read_b64_tr_b16 v[148:149], v4 offset:128
    ds_read_b64_tr_b16 v[150:151], v4 offset:384
    v_mul_f32 v19, v19, v23
    v_cvt_pk_bf16_f32 v164, v16, v17
    v_cvt_pk_bf16_f32 v165, v18, v19
    v_max_f32 v24, 0, v24
    v_max_f32 v25, 0, v25
    v_max_f32 v26, 0, v26
    v_max_f32 v27, 0, v27
    v_mfma_f32_32x32x16_bf16 v[48:63], v[152:155], v[192:195], v[48:63]
    ds_read_b64_tr_b16 v[152:153], v4 offset:8864
    ds_read_b64_tr_b16 v[154:155], v4 offset:9120
    v_mul_f32 v24, v24, v28
    v_mul_f32 v25, v25, v29
    v_mul_f32 v26, v26, v30
    v_mul_f32 v27, v27, v31
    v_cvt_pk_bf16_f32 v166, v24, v25
    v_cvt_pk_bf16_f32 v167, v26, v27
    buffer_store_dwordx4 v[164:167], v2, s[20:23], s62 offen offset:0 sc1
    s_waitcnt lgkmcnt(6)
    v_mfma_f32_32x32x16_bf16 v[48:63], v[128:131], v[196:199], v[48:63]
    ds_read_b64_tr_b16 v[128:129], v4 offset:17600
    ds_read_b64_tr_b16 v[130:131], v4 offset:17856
    v_max_f32 v32, 0, v32
    v_max_f32 v33, 0, v33
    v_max_f32 v34, 0, v34
    v_max_f32 v35, 0, v35
    v_mul_f32 v32, v32, v36
    v_mul_f32 v33, v33, v37
    v_mul_f32 v34, v34, v38
    v_mfma_f32_32x32x16_bf16 v[48:63], v[132:135], v[200:203], v[48:63]
    ds_read_b64_tr_b16 v[132:133], v4 offset:160
    ds_read_b64_tr_b16 v[134:135], v4 offset:416
    v_mul_f32 v35, v35, v39
    v_cvt_pk_bf16_f32 v168, v32, v33
    v_cvt_pk_bf16_f32 v169, v34, v35
    v_max_f32 v40, 0, v40
    v_max_f32 v41, 0, v41
    v_max_f32 v42, 0, v42
    v_max_f32 v43, 0, v43
    v_mfma_f32_32x32x16_bf16 v[64:79], v[136:139], v[192:195], v[64:79]
    ds_read_b64_tr_b16 v[136:137], v4 offset:8896
    ds_read_b64_tr_b16 v[138:139], v4 offset:9152
    v_mul_f32 v40, v40, v44
    v_mul_f32 v41, v41, v45
    v_mul_f32 v42, v42, v46
    v_mul_f32 v43, v43, v47
    v_cvt_pk_bf16_f32 v170, v40, v41
    v_cvt_pk_bf16_f32 v171, v42, v43
    buffer_store_dwordx4 v[168:171], v2, s[20:23], s62 offen offset:1024 sc1
    v_mfma_f32_32x32x16_bf16 v[64:79], v[140:143], v[196:199], v[64:79]
    ds_read_b64_tr_b16 v[140:141], v4 offset:17632
    ds_read_b64_tr_b16 v[142:143], v4 offset:17888
    v_max_f32 v48, 0, v48
    v_max_f32 v49, 0, v49
    v_max_f32 v50, 0, v50
    v_max_f32 v51, 0, v51
    v_mul_f32 v48, v48, v52
    v_mul_f32 v49, v49, v53
    v_mul_f32 v50, v50, v54
    s_waitcnt lgkmcnt(8)
    v_mfma_f32_32x32x16_bf16 v[64:79], v[144:147], v[200:203], v[64:79]
    ds_read_b64_tr_b16 v[144:145], v4 offset:192
    ds_read_b64_tr_b16 v[146:147], v4 offset:448
    v_mul_f32 v51, v51, v55
    v_cvt_pk_bf16_f32 v164, v48, v49
    v_cvt_pk_bf16_f32 v165, v50, v51
    v_max_f32 v56, 0, v56
    v_max_f32 v57, 0, v57
    v_max_f32 v58, 0, v58
    v_max_f32 v59, 0, v59
    v_mfma_f32_32x32x16_bf16 v[80:95], v[148:151], v[192:195], v[80:95]
    ds_read_b64_tr_b16 v[148:149], v4 offset:8928
    ds_read_b64_tr_b16 v[150:151], v4 offset:9184
    v_mul_f32 v56, v56, v60
    v_mul_f32 v57, v57, v61
    v_mul_f32 v58, v58, v62
    v_mul_f32 v59, v59, v63
    v_cvt_pk_bf16_f32 v166, v56, v57
    v_cvt_pk_bf16_f32 v167, v58, v59
    buffer_store_dwordx4 v[164:167], v2, s[20:23], s62 offen offset:2048 sc1
    v_mfma_f32_32x32x16_bf16 v[80:95], v[152:155], v[196:199], v[80:95]
    ds_read_b64_tr_b16 v[152:153], v4 offset:17664
    ds_read_b64_tr_b16 v[154:155], v4 offset:17920
    v_max_f32 v64, 0, v64
    v_max_f32 v65, 0, v65
    v_max_f32 v66, 0, v66
    v_max_f32 v67, 0, v67
    v_mul_f32 v64, v64, v68
    v_mul_f32 v65, v65, v69
    v_mul_f32 v66, v66, v70
    s_waitcnt lgkmcnt(6)
    v_mfma_f32_32x32x16_bf16 v[80:95], v[128:131], v[200:203], v[80:95]
    v_mul_f32 v67, v67, v71
    v_cvt_pk_bf16_f32 v168, v64, v65
    v_cvt_pk_bf16_f32 v169, v66, v67
    v_max_f32 v72, 0, v72
    v_max_f32 v73, 0, v73
    v_max_f32 v74, 0, v74
    v_max_f32 v75, 0, v75
    v_mfma_f32_32x32x16_bf16 v[96:111], v[132:135], v[192:195], v[96:111]
    v_mul_f32 v72, v72, v76
    v_mul_f32 v73, v73, v77
    v_mul_f32 v74, v74, v78
    v_mul_f32 v75, v75, v79
    v_cvt_pk_bf16_f32 v170, v72, v73
    v_cvt_pk_bf16_f32 v171, v74, v75
    buffer_store_dwordx4 v[168:171], v2, s[20:23], s62 offen offset:3072 sc1
    v_mfma_f32_32x32x16_bf16 v[96:111], v[136:139], v[196:199], v[96:111]
    v_max_f32 v80, 0, v80
    v_max_f32 v81, 0, v81
    v_max_f32 v82, 0, v82
    v_max_f32 v83, 0, v83
    v_mul_f32 v80, v80, v84
    v_mul_f32 v81, v81, v85
    v_mul_f32 v82, v82, v86
    v_mfma_f32_32x32x16_bf16 v[96:111], v[140:143], v[200:203], v[96:111]
    v_mul_f32 v83, v83, v87
    v_cvt_pk_bf16_f32 v164, v80, v81
    v_cvt_pk_bf16_f32 v165, v82, v83
    v_max_f32 v88, 0, v88
    v_max_f32 v89, 0, v89
    v_max_f32 v90, 0, v90
    v_max_f32 v91, 0, v91
    s_waitcnt lgkmcnt(0)
    v_mfma_f32_32x32x16_bf16 v[112:127], v[144:147], v[192:195], v[112:127]
    v_mul_f32 v88, v88, v92
    v_mul_f32 v89, v89, v93
    v_mul_f32 v90, v90, v94
    v_mul_f32 v91, v91, v95
    v_cvt_pk_bf16_f32 v166, v88, v89
    v_cvt_pk_bf16_f32 v167, v90, v91
    buffer_store_dwordx4 v[164:167], v2, s[20:23], s63 offen offset:0 sc1
    v_mfma_f32_32x32x16_bf16 v[112:127], v[148:151], v[196:199], v[112:127]
    v_max_f32 v96, 0, v96
    v_max_f32 v97, 0, v97
    v_max_f32 v98, 0, v98
    v_max_f32 v99, 0, v99
    v_mul_f32 v96, v96, v100
    v_mul_f32 v97, v97, v101
    v_mul_f32 v98, v98, v102
    v_mfma_f32_32x32x16_bf16 v[112:127], v[152:155], v[200:203], v[112:127]
    v_mul_f32 v99, v99, v103
    v_cvt_pk_bf16_f32 v168, v96, v97
    v_cvt_pk_bf16_f32 v169, v98, v99
    v_max_f32 v104, 0, v104
    v_max_f32 v105, 0, v105
    v_max_f32 v106, 0, v106
    v_max_f32 v107, 0, v107
    v_mul_f32 v104, v104, v108
    v_mul_f32 v105, v105, v109
    v_mul_f32 v106, v106, v110
    v_mul_f32 v107, v107, v111
    v_cvt_pk_bf16_f32 v170, v104, v105
    v_cvt_pk_bf16_f32 v171, v106, v107
    buffer_store_dwordx4 v[168:171], v2, s[20:23], s63 offen offset:1024 sc1
    v_max_f32 v112, 0, v112
    v_max_f32 v113, 0, v113
    v_max_f32 v114, 0, v114
    v_max_f32 v115, 0, v115
    v_mul_f32 v112, v112, v116
    v_mul_f32 v113, v113, v117
    v_mul_f32 v114, v114, v118
    v_mul_f32 v115, v115, v119
    v_cvt_pk_bf16_f32 v164, v112, v113
    v_cvt_pk_bf16_f32 v165, v114, v115
    v_max_f32 v120, 0, v120
    v_max_f32 v121, 0, v121
    v_max_f32 v122, 0, v122
    v_max_f32 v123, 0, v123
    v_mul_f32 v120, v120, v124
    v_mul_f32 v121, v121, v125
    v_mul_f32 v122, v122, v126
    v_mul_f32 v123, v123, v127
    v_cvt_pk_bf16_f32 v166, v120, v121
    v_cvt_pk_bf16_f32 v167, v122, v123
    buffer_store_dwordx4 v[164:167], v2, s[20:23], s63 offen offset:2048 sc1
    s_waitcnt vmcnt(0)
    s_barrier
    s_cmp_ge_u32 s6, 28
    s_cbranch_scc1 L_p5_skip_c
    s_lshr_b32 s52, s3, 2
    s_lshl_b32 s54, s47, 1
    s_add_u32 s53, s54, s52
    s_lshl_b32 s63, s46, 2
    s_add_u32 s63, s63, s4
    s_mul_i32 s62, s53, 28672
    s_lshl_b32 s61, s63, 10
    s_add_u32 s62, s62, s61
    s_add_u32 s62, s62, 9437184
    buffer_load_dwordx4 v[16:19], v2, s[20:23], s62 offen sc1
    v_mul_u32_u24 v3, 896, v12
    v_lshl_add_u32 v3, v13, 4, v3
    s_mul_i32 s62, s53, 28672
    s_lshl_b32 s61, s63, 5
    s_add_u32 s62, s62, s61
    s_mul_i32 s7, s4, 38912
    v_add_u32 v8, s7, v2
    s_mul_i32 s60, s4, 28672
    s_add_u32 s60, s60, 12582912
    s_mul_i32 s55, s54, 114688
    s_add_u32 s55, s55, s60
    s_add_u32 s58, s55, 114688
    s_and_b32 s60, s6, 3
    s_mul_i32 s60, s60, 1
    s_and_b32 s59, s46, 7
    s_mul_i32 s59, s59, 0
    s_add_u32 s59, s59, s60
    s_add_u32 s59, s59, 0
    s_mul_i32 s60, s5, 7
    s_lshr_b32 s60, s60, 1
    s_add_u32 s59, s59, s60
    s_cmp_ge_u32 s59, 28
    s_cselect_b32 s60, 28, 0
    s_sub_u32 s59, s59, s60
    s_cmp_ge_u32 s59, 28
    s_cselect_b32 s60, 28, 0
    s_sub_u32 s59, s59, s60
    s_cmp_ge_u32 s59, 28
    s_cselect_b32 s60, 28, 0
    s_sub_u32 s59, s59, s60
    s_and_b32 s60, s6, 3
    s_mul_i32 s60, s60, 1
    s_and_b32 s52, s46, 7
    s_mul_i32 s52, s52, 0
    s_add_u32 s52, s52, s60
    s_add_u32 s52, s52, 19
    s_mul_i32 s60, s5, 7
    s_lshr_b32 s60, s60, 1
    s_add_u32 s52, s52, s60
    s_cmp_ge_u32 s52, 28
    s_cselect_b32 s60, 28, 0
    s_sub_u32 s52, s52, s60
    s_cmp_ge_u32 s52, 28
    s_cselect_b32 s60, 28, 0
    s_sub_u32 s52, s52, s60
    s_cmp_ge_u32 s52, 28
    s_cselect_b32 s60, 28, 0
    s_sub_u32 s52, s52, s60
    s_lshl_b32 s59, s59, 10
    s_lshl_b32 s52, s52, 10
    s_lshr_b32 s60, s4, 1
    s_and_b32 s61, s4, 1
    v_bfe_u32 v9, v1, 2, 2
    v_lshl_add_u32 v10, v13, 3, v9
    v_lshlrev_b32 v10, 7, v10
    v_lshrrev_b32 v9, 1, v9
    v_xor_b32 v9, s60, v9
    v_lshl_add_u32 v10, v9, 6, v10
    v_bfe_u32 v9, v1, 4, 1
    v_xor_b32 v9, s61, v9
    v_lshl_add_u32 v10, v9, 5, v10
    v_and_b32 v9, 1, v1
    v_lshl_add_u32 v10, v9, 4, v10
    v_bfe_u32 v9, v1, 1, 1
    v_lshl_add_u32 v4, v9, 3, v10
    s_mul_i32 s60, s4, 18432
    s_add_u32 s60, s60, 87360
    v_xor_b32 v5, 64, v4
    v_add_u32 v4, s60, v4
    v_add_u32 v5, s60, v5
    ds_read_b64_tr_b16 v[88:89], v4 offset:0
    ds_read_b64_tr_b16 v[90:91], v4 offset:512
    ds_read_b64_tr_b16 v[92:93], v5 offset:0
    ds_read_b64_tr_b16 v[94:95], v5 offset:512
    ds_read_b64_tr_b16 v[96:97], v4 offset:2048
    ds_read_b64_tr_b16 v[98:99], v4 offset:2560
    ds_read_b64_tr_b16 v[100:101], v5 offset:2048
    ds_read_b64_tr_b16 v[102:103], v5 offset:2560
    s_waitcnt lgkmcnt(4)
    ds_read_b64_tr_b16 v[104:105], v4 offset:4096
    ds_read_b64_tr_b16 v[106:107], v4 offset:4608
    ds_read_b64_tr_b16 v[108:109], v5 offset:4096
    ds_read_b64_tr_b16 v[110:111], v5 offset:4608
    ds_read_b64_tr_b16 v[112:113], v4 offset:6144
    ds_read_b64_tr_b16 v[114:115], v4 offset:6656
    ds_read_b64_tr_b16 v[116:117], v5 offset:6144
    ds_read_b64_tr_b16 v[118:119], v5 offset:6656
    s_waitcnt lgkmcnt(4)
    ds_read_b64_tr_b16 v[120:121], v4 offset:8192
    ds_read_b64_tr_b16 v[122:123], v4 offset:8704
    ds_read_b64_tr_b16 v[124:125], v5 offset:8192
    ds_read_b64_tr_b16 v[126:127], v5 offset:8704
    ds_read_b64_tr_b16 v[128:129], v4 offset:10240
    ds_read_b64_tr_b16 v[130:131], v4 offset:10752
    ds_read_b64_tr_b16 v[132:133], v5 offset:10240
    ds_read_b64_tr_b16 v[134:135], v5 offset:10752
    s_waitcnt lgkmcnt(4)
    ds_read_b64_tr_b16 v[136:137], v4 offset:12288
    ds_read_b64_tr_b16 v[138:139], v4 offset:12800
    ds_read_b64_tr_b16 v[140:141], v5 offset:12288
    ds_read_b64_tr_b16 v[142:143], v5 offset:12800
    ds_read_b64_tr_b16 v[144:145], v4 offset:14336
    ds_read_b64_tr_b16 v[146:147], v4 offset:14848
    ds_read_b64_tr_b16 v[148:149], v5 offset:14336
    ds_read_b64_tr_b16 v[150:151], v5 offset:14848
    s_waitcnt lgkmcnt(4)
    ds_read_b64_tr_b16 v[152:153], v4 offset:16384
    ds_read_b64_tr_b16 v[154:155], v4 offset:16896
    ds_read_b64_tr_b16 v[156:157], v5 offset:16384
    ds_read_b64_tr_b16 v[158:159], v5 offset:16896
    s_waitcnt lgkmcnt(0)
    s_mov_b32 m0, s7
    s_setprio 3
    s_barrier
    s_add_u32 s60, s59, s58
    s_add_u32 s61, s59, s55
    buffer_load_dwordx4 v2, s[20:23], s60 offen sc1 lds
    s_add_u32 m0, m0, 1024
    s_add_u32 s59, s59, 1024
    s_cmp_eq_u32 s59, 28672
    s_cselect_b32 s59, 0, s59
    buffer_load_dwordx4 v2, s[20:23], s61 offen sc1 lds
    s_add_u32 m0, m0, 1024
    s_add_u32 s60, s59, s58
    s_add_u32 s61, s59, s55
    buffer_load_dwordx4 v2, s[20:23], s60 offen sc1 lds
    s_add_u32 m0, m0, 1024
    s_add_u32 s59, s59, 1024
    s_cmp_eq_u32 s59, 28672
    s_cselect_b32 s59, 0, s59
    buffer_load_dwordx4 v2, s[20:23], s61 offen sc1 lds
    s_add_u32 m0, m0, 1024
    s_add_u32 s60, s59, s58
    s_add_u32 s61, s59, s55
    buffer_load_dwordx4 v2, s[20:23], s60 offen sc1 lds
    s_add_u32 m0, m0, 1024
    s_add_u32 s59, s59, 1024
    s_cmp_eq_u32 s59, 28672
    s_cselect_b32 s59, 0, s59
    buffer_load_dwordx4 v2, s[20:23], s61 offen sc1 lds
    s_add_u32 m0, m0, 1024
    s_add_u32 s60, s59, s58
    s_add_u32 s61, s59, s55
    buffer_load_dwordx4 v2, s[20:23], s60 offen sc1 lds
    s_add_u32 m0, m0, 1024
    s_add_u32 s59, s59, 1024
    s_cmp_eq_u32 s59, 28672
    s_cselect_b32 s59, 0, s59
    buffer_load_dwordx4 v2, s[20:23], s61 offen sc1 lds
    s_add_u32 m0, m0, 1024
    s_add_u32 s60, s59, s58
    s_add_u32 s61, s59, s55
    buffer_load_dwordx4 v2, s[20:23], s60 offen sc1 lds
    s_add_u32 m0, m0, 1024
    s_add_u32 s59, s59, 1024
    s_cmp_eq_u32 s59, 28672
    s_cselect_b32 s59, 0, s59
    buffer_load_dwordx4 v2, s[20:23], s61 offen sc1 lds
    s_add_u32 m0, m0, 1024
    s_waitcnt vmcnt(6)
    s_barrier
    s_add_u32 s60, s59, s58
    s_add_u32 s61, s59, s55
    buffer_load_dwordx4 v2, s[20:23], s60 offen sc1 lds
    s_add_u32 m0, m0, 1024
    s_add_u32 s59, s59, 1024
    s_cmp_eq_u32 s59, 28672
    s_cselect_b32 s59, 0, s59
    buffer_load_dwordx4 v2, s[20:23], s61 offen sc1 lds
    s_add_u32 m0, m0, 1024
    s_add_u32 s60, s59, s58
    s_add_u32 s61, s59, s55
    buffer_load_dwordx4 v2, s[20:23], s60 offen sc1 lds
    s_add_u32 m0, m0, 1024
    s_add_u32 s59, s59, 1024
    s_cmp_eq_u32 s59, 28672
    s_cselect_b32 s59, 0, s59
    buffer_load_dwordx4 v2, s[20:23], s61 offen sc1 lds
    s_add_u32 m0, m0, 1024
    s_add_u32 s60, s59, s58
    s_add_u32 s61, s59, s55
    buffer_load_dwordx4 v2, s[20:23], s60 offen sc1 lds
    s_add_u32 m0, m0, 1024
    s_add_u32 s59, s59, 1024
    s_cmp_eq_u32 s59, 28672
    s_cselect_b32 s59, 0, s59
    buffer_load_dwordx4 v2, s[20:23], s61 offen sc1 lds
    s_add_u32 m0, m0, 1024
    s_waitcnt vmcnt(6)
    s_barrier
    s_add_u32 s60, s59, s58
    s_add_u32 s61, s59, s55
    buffer_load_dwordx4 v2, s[20:23], s60 offen sc1 lds
    s_add_u32 m0, m0, 1024
    s_add_u32 s59, s59, 1024
    s_cmp_eq_u32 s59, 28672
    s_cselect_b32 s59, 0, s59
    buffer_load_dwordx4 v2, s[20:23], s61 offen sc1 lds
    s_add_u32 m0, m0, 1024
    s_add_u32 s60, s59, s58
    s_add_u32 s61, s59, s55
    buffer_load_dwordx4 v2, s[20:23], s60 offen sc1 lds
    s_add_u32 m0, m0, 1024
    s_add_u32 s59, s59, 1024
    s_cmp_eq_u32 s59, 28672
    s_cselect_b32 s59, 0, s59
    buffer_load_dwordx4 v2, s[20:23], s61 offen sc1 lds
    s_add_u32 m0, m0, 1024
    s_add_u32 s60, s59, s58
    s_add_u32 s61, s59, s55
    buffer_load_dwordx4 v2, s[20:23], s60 offen sc1 lds
    s_add_u32 m0, m0, 1024
    s_add_u32 s59, s59, 1024
    s_cmp_eq_u32 s59, 28672
    s_cselect_b32 s59, 0, s59
    buffer_load_dwordx4 v2, s[20:23], s61 offen sc1 lds
    s_add_u32 m0, m0, 1024
    s_waitcnt vmcnt(6)
    s_barrier
    s_add_u32 s60, s59, s58
    s_add_u32 s61, s59, s55
    buffer_load_dwordx4 v2, s[20:23], s60 offen sc1 lds
    s_add_u32 m0, m0, 1024
    s_add_u32 s59, s59, 1024
    s_cmp_eq_u32 s59, 28672
    s_cselect_b32 s59, 0, s59
    buffer_load_dwordx4 v2, s[20:23], s61 offen sc1 lds
    s_add_u32 m0, m0, 1024
    s_add_u32 s60, s59, s58
    s_add_u32 s61, s59, s55
    buffer_load_dwordx4 v2, s[20:23], s60 offen sc1 lds
    s_add_u32 m0, m0, 1024
    s_add_u32 s59, s59, 1024
    s_cmp_eq_u32 s59, 28672
    s_cselect_b32 s59, 0, s59
    buffer_load_dwordx4 v2, s[20:23], s61 offen sc1 lds
    s_add_u32 m0, m0, 1024
    s_add_u32 s60, s59, s58
    s_add_u32 s61, s59, s55
    buffer_load_dwordx4 v2, s[20:23], s60 offen sc1 lds
    s_add_u32 m0, m0, 1024
    s_add_u32 s59, s59, 1024
    s_cmp_eq_u32 s59, 28672
    s_cselect_b32 s59, 0, s59
    buffer_load_dwordx4 v2, s[20:23], s61 offen sc1 lds
    s_add_u32 m0, m0, 1024
    s_add_u32 s60, s59, s58
    s_add_u32 s61, s59, s55
    buffer_load_dwordx4 v2, s[20:23], s60 offen sc1 lds
    s_add_u32 m0, m0, 1024
    s_add_u32 s59, s59, 1024
    s_cmp_eq_u32 s59, 28672
    s_cselect_b32 s59, 0, s59
    buffer_load_dwordx4 v2, s[20:23], s61 offen sc1 lds
    s_add_u32 m0, m0, 1024
    s_waitcnt vmcnt(8)
    s_barrier
    s_add_u32 s60, s59, s58
    s_add_u32 s61, s59, s55
    buffer_load_dwordx4 v2, s[20:23], s60 offen sc1 lds
    s_add_u32 m0, m0, 1024
    s_add_u32 s59, s59, 1024
    s_cmp_eq_u32 s59, 28672
    s_cselect_b32 s59, 0, s59
    buffer_load_dwordx4 v2, s[20:23], s61 offen sc1 lds
    s_add_u32 m0, m0, 1024
    s_add_u32 s60, s59, s58
    s_add_u32 s61, s59, s55
    buffer_load_dwordx4 v2, s[20:23], s60 offen sc1 lds
    s_add_u32 m0, m0, 1024
    s_add_u32 s59, s59, 1024
    s_cmp_eq_u32 s59, 28672
    s_cselect_b32 s59, 0, s59
    buffer_load_dwordx4 v2, s[20:23], s61 offen sc1 lds
    s_add_u32 m0, m0, 1024
    s_add_u32 s60, s59, s58
    s_add_u32 s61, s59, s55
    buffer_load_dwordx4 v2, s[20:23], s60 offen sc1 lds
    s_add_u32 m0, m0, 1024
    s_add_u32 s59, s59, 1024
    s_cmp_eq_u32 s59, 28672
    s_cselect_b32 s59, 0, s59
    buffer_load_dwordx4 v2, s[20:23], s61 offen sc1 lds
    s_add_u32 m0, m0, 1024
    s_add_u32 s60, s59, s58
    s_add_u32 s61, s59, s55
    buffer_load_dwordx4 v2, s[20:23], s60 offen sc1 lds
    s_add_u32 m0, m0, 1024
    s_add_u32 s59, s59, 1024
    s_cmp_eq_u32 s59, 28672
    s_cselect_b32 s59, 0, s59
    buffer_load_dwordx4 v2, s[20:23], s61 offen sc1 lds
    s_add_u32 m0, m0, 1024
    s_waitcnt vmcnt(8)
    s_barrier
    s_add_u32 s60, s52, s55
    s_add_u32 s61, s52, s58
    buffer_load_dwordx4 v[160:163], v2, s[20:23], s60 offen sc1
    buffer_load_dwordx4 v[164:167], v2, s[20:23], s61 offen sc1
    s_add_u32 s52, s52, 1024
    s_cmp_eq_u32 s52, 28672
    s_cselect_b32 s52, 0, s52
    s_add_u32 s60, s52, s55
    s_add_u32 s61, s52, s58
    buffer_load_dwordx4 v[168:171], v2, s[20:23], s60 offen sc1
    buffer_load_dwordx4 v[172:175], v2, s[20:23], s61 offen sc1
    s_add_u32 s52, s52, 1024
    s_cmp_eq_u32 s52, 28672
    s_cselect_b32 s52, 0, s52
    s_add_u32 s60, s52, s55
    s_add_u32 s61, s52, s58
    buffer_load_dwordx4 v[176:179], v2, s[20:23], s60 offen sc1
    buffer_load_dwordx4 v[180:183], v2, s[20:23], s61 offen sc1
    s_add_u32 s52, s52, 1024
    s_cmp_eq_u32 s52, 28672
    s_cselect_b32 s52, 0, s52
    s_waitcnt vmcnt(6)
    s_barrier
    s_add_u32 s60, s52, s55
    s_add_u32 s61, s52, s58
    buffer_load_dwordx4 v[184:187], v2, s[20:23], s60 offen sc1
    buffer_load_dwordx4 v[188:191], v2, s[20:23], s61 offen sc1
    s_add_u32 s52, s52, 1024
    s_cmp_eq_u32 s52, 28672
    s_cselect_b32 s52, 0, s52
    s_add_u32 s60, s52, s55
    s_add_u32 s61, s52, s58
    buffer_load_dwordx4 v[192:195], v2, s[20:23], s60 offen sc1
    buffer_load_dwordx4 v[196:199], v2, s[20:23], s61 offen sc1
    s_add_u32 s52, s52, 1024
    s_cmp_eq_u32 s52, 28672
    s_cselect_b32 s52, 0, s52
    s_add_u32 s60, s52, s55
    s_add_u32 s61, s52, s58
    buffer_load_dwordx4 v[200:203], v2, s[20:23], s60 offen sc1
    buffer_load_dwordx4 v[204:207], v2, s[20:23], s61 offen sc1
    s_add_u32 s52, s52, 1024
    s_cmp_eq_u32 s52, 28672
    s_cselect_b32 s52, 0, s52
    s_add_u32 s60, s52, s55
    s_add_u32 s61, s52, s58
    buffer_load_dwordx4 v[208:211], v2, s[20:23], s60 offen sc1
    buffer_load_dwordx4 v[212:215], v2, s[20:23], s61 offen sc1
    s_add_u32 s52, s52, 1024
    s_cmp_eq_u32 s52, 28672
    s_cselect_b32 s52, 0, s52
    s_add_u32 s60, s52, s55
    s_add_u32 s61, s52, s58
    buffer_load_dwordx4 v[216:219], v2, s[20:23], s60 offen sc1
    buffer_load_dwordx4 v[220:223], v2, s[20:23], s61 offen sc1
    s_add_u32 s52, s52, 1024
    s_cmp_eq_u32 s52, 28672
    s_cselect_b32 s52, 0, s52
    s_add_u32 s60, s52, s55
    s_add_u32 s61, s52, s58
    buffer_load_dwordx4 v[224:227], v2, s[20:23], s60 offen sc1
    buffer_load_dwordx4 v[228:231], v2, s[20:23], s61 offen sc1
    s_add_u32 s52, s52, 1024
    s_cmp_eq_u32 s52, 28672
    s_cselect_b32 s52, 0, s52
    s_xor_b32 s60, s4, 1
    s_mul_i32 s60, s60, 38912
    v_add_u32 v241, s60, v2
    s_xor_b32 s60, s4, 2
    s_mul_i32 s60, s60, 38912
    v_add_u32 v242, s60, v2
    s_xor_b32 s60, s4, 3
    s_mul_i32 s60, s60, 38912
    v_add_u32 v243, s60, v2
    s_xor_b32 s60, s4, 0
    s_mul_i32 s60, s60, 38912
    v_add_u32 v244, s60, v2
    s_xor_b32 s60, s4, 1
    s_mul_i32 s60, s60, 38912
    v_add_u32 v245, s60, v2
    s_xor_b32 s60, s4, 2
    s_mul_i32 s60, s60, 38912
    v_add_u32 v246, s60, v2
    s_xor_b32 s60, s4, 3
    s_mul_i32 s60, s60, 38912
    v_add_u32 v247, s60, v2
    v_lshlrev_b32 v232, 16, v16
    v_and_b32 v233, 0xffff0000, v16
    v_lshlrev_b32 v234, 16, v17
    v_and_b32 v235, 0xffff0000, v17
    v_lshlrev_b32 v236, 16, v18
    v_and_b32 v237, 0xffff0000, v18
    v_lshlrev_b32 v238, 16, v19
    v_and_b32 v239, 0xffff0000, v19
    s_waitcnt vmcnt(16)
    v_mfma_f32_32x32x16_bf16 v[24:39], v[88:91], v[160:163], 0
    v_mfma_f32_32x32x16_bf16 v[40:55], v[92:95], v[160:163], 0
    v_mfma_f32_32x32x16_bf16 v[56:71], v[88:91], v[164:167], 0
    v_mfma_f32_32x32x16_bf16 v[72:87], v[92:95], v[164:167], 0
    s_waitcnt vmcnt(14)
    v_mfma_f32_32x32x16_bf16 v[24:39], v[96:99], v[168:171], v[24:39]
    v_mfma_f32_32x32x16_bf16 v[40:55], v[100:103], v[168:171], v[40:55]
    v_mfma_f32_32x32x16_bf16 v[56:71], v[96:99], v[172:175], v[56:71]
    v_mfma_f32_32x32x16_bf16 v[72:87], v[100:103], v[172:175], v[72:87]
    s_waitcnt vmcnt(12)
    v_mfma_f32_32x32x16_bf16 v[24:39], v[104:107], v[176:179], v[24:39]
    v_mfma_f32_32x32x16_bf16 v[40:55], v[108:111], v[176:179], v[40:55]
    v_mfma_f32_32x32x16_bf16 v[56:71], v[104:107], v[180:183], v[56:71]
    v_mfma_f32_32x32x16_bf16 v[72:87], v[108:111], v[180:183], v[72:87]
    s_waitcnt vmcnt(10)
    v_mfma_f32_32x32x16_bf16 v[24:39], v[112:115], v[184:187], v[24:39]
    v_mfma_f32_32x32x16_bf16 v[40:55], v[116:119], v[184:187], v[40:55]
    v_mfma_f32_32x32x16_bf16 v[56:71], v[112:115], v[188:191], v[56:71]
    v_mfma_f32_32x32x16_bf16 v[72:87], v[116:119], v[188:191], v[72:87]
    s_waitcnt vmcnt(8)
    v_mfma_f32_32x32x16_bf16 v[24:39], v[120:123], v[192:195], v[24:39]
    v_mfma_f32_32x32x16_bf16 v[40:55], v[124:127], v[192:195], v[40:55]
    v_mfma_f32_32x32x16_bf16 v[56:71], v[120:123], v[196:199], v[56:71]
    v_mfma_f32_32x32x16_bf16 v[72:87], v[124:127], v[196:199], v[72:87]
    s_waitcnt vmcnt(6)
    v_mfma_f32_32x32x16_bf16 v[24:39], v[128:131], v[200:203], v[24:39]
    v_mfma_f32_32x32x16_bf16 v[40:55], v[132:135], v[200:203], v[40:55]
    v_mfma_f32_32x32x16_bf16 v[56:71], v[128:131], v[204:207], v[56:71]
    v_mfma_f32_32x32x16_bf16 v[72:87], v[132:135], v[204:207], v[72:87]
    s_waitcnt vmcnt(4)
    v_mfma_f32_32x32x16_bf16 v[72:87], v[140:143], v[212:215], v[72:87]
    s_waitcnt vmcnt(2)
    v_mfma_f32_32x32x16_bf16 v[72:87], v[148:151], v[220:223], v[72:87]
    s_waitcnt vmcnt(0)
    v_mfma_f32_32x32x16_bf16 v[72:87], v[156:159], v[228:231], v[72:87]
    v_mfma_f32_32x32x16_bf16 v[56:71], v[136:139], v[212:215], v[56:71]
    v_mfma_f32_32x32x16_bf16 v[56:71], v[144:147], v[220:223], v[56:71]
    v_mfma_f32_32x32x16_bf16 v[56:71], v[152:155], v[228:231], v[56:71]
    v_mfma_f32_32x32x16_bf16 v[40:55], v[140:143], v[208:211], v[40:55]
    s_nop 7
    ds_write_b128 v8, v[72:75] offset:10240
    ds_write_b128 v8, v[76:79] offset:11264
    v_mfma_f32_32x32x16_bf16 v[40:55], v[148:151], v[216:219], v[40:55]
    ds_write_b128 v8, v[80:83] offset:12288
    ds_write_b128 v8, v[84:87] offset:13312
    v_mfma_f32_32x32x16_bf16 v[40:55], v[156:159], v[224:227], v[40:55]
    ds_write_b128 v8, v[56:59] offset:6144
    ds_write_b128 v8, v[60:63] offset:7168
    v_mfma_f32_32x32x16_bf16 v[24:39], v[136:139], v[208:211], v[24:39]
    ds_write_b128 v8, v[64:67] offset:8192
    ds_write_b128 v8, v[68:71] offset:9216
    v_mfma_f32_32x32x16_bf16 v[24:39], v[144:147], v[216:219], v[24:39]
    s_nop 5
    ds_write_b128 v8, v[40:43] offset:2048
    ds_write_b128 v8, v[44:47] offset:3072
    v_mfma_f32_32x32x16_bf16 v[24:39], v[152:155], v[224:227], v[24:39]
    ds_write_b128 v8, v[48:51] offset:4096
    ds_write_b128 v8, v[52:55] offset:5120
    s_nop 9
    ds_write_b128 v8, v[32:35] offset:0
    ds_write_b128 v8, v[36:39] offset:1024
    v_pk_add_f32 v[24:25], v[24:25], v[232:233]
    v_pk_add_f32 v[26:27], v[26:27], v[234:235]
    v_pk_add_f32 v[28:29], v[28:29], v[236:237]
    v_pk_add_f32 v[30:31], v[30:31], v[238:239]
    s_waitcnt lgkmcnt(0)
    s_barrier
    ds_read_b128 v[32:35], v241 offset:0
    ds_read_b128 v[36:39], v241 offset:1024
    ds_read_b128 v[40:43], v242 offset:2048
    ds_read_b128 v[44:47], v242 offset:3072
    ds_read_b128 v[48:51], v243 offset:4096
    ds_read_b128 v[52:55], v243 offset:5120
    ds_read_b128 v[56:59], v244 offset:20480
    ds_read_b128 v[60:63], v244 offset:21504
    ds_read_b128 v[64:67], v245 offset:22528
    ds_read_b128 v[68:71], v245 offset:23552
    ds_read_b128 v[72:75], v246 offset:24576
    ds_read_b128 v[76:79], v246 offset:25600
    ds_read_b128 v[80:83], v247 offset:26624
    ds_read_b128 v[84:87], v247 offset:27648
    s_waitcnt lgkmcnt(12)
    v_pk_add_f32 v[24:25], v[24:25], v[32:33]
    v_pk_add_f32 v[26:27], v[26:27], v[34:35]
    v_pk_add_f32 v[28:29], v[28:29], v[36:37]
    v_pk_add_f32 v[30:31], v[30:31], v[38:39]
    s_waitcnt lgkmcnt(10)
    v_pk_add_f32 v[24:25], v[24:25], v[40:41]
    v_pk_add_f32 v[26:27], v[26:27], v[42:43]
    v_pk_add_f32 v[28:29], v[28:29], v[44:45]
    v_pk_add_f32 v[30:31], v[30:31], v[46:47]
    s_waitcnt lgkmcnt(8)
    v_pk_add_f32 v[24:25], v[24:25], v[48:49]
    v_pk_add_f32 v[26:27], v[26:27], v[50:51]
    v_pk_add_f32 v[28:29], v[28:29], v[52:53]
    v_pk_add_f32 v[30:31], v[30:31], v[54:55]
    s_waitcnt lgkmcnt(6)
    v_pk_add_f32 v[24:25], v[24:25], v[56:57]
    v_pk_add_f32 v[26:27], v[26:27], v[58:59]
    v_pk_add_f32 v[28:29], v[28:29], v[60:61]
    v_pk_add_f32 v[30:31], v[30:31], v[62:63]
    s_waitcnt lgkmcnt(4)
    v_pk_add_f32 v[24:25], v[24:25], v[64:65]
    v_pk_add_f32 v[26:27], v[26:27], v[66:67]
    v_pk_add_f32 v[28:29], v[28:29], v[68:69]
    v_pk_add_f32 v[30:31], v[30:31], v[70:71]
    s_waitcnt lgkmcnt(2)
    v_pk_add_f32 v[24:25], v[24:25], v[72:73]
    v_pk_add_f32 v[26:27], v[26:27], v[74:75]
    v_pk_add_f32 v[28:29], v[28:29], v[76:77]
    v_pk_add_f32 v[30:31], v[30:31], v[78:79]
    s_waitcnt lgkmcnt(0)
    v_pk_add_f32 v[24:25], v[24:25], v[80:81]
    v_pk_add_f32 v[26:27], v[26:27], v[82:83]
    v_pk_add_f32 v[28:29], v[28:29], v[84:85]
    v_pk_add_f32 v[30:31], v[30:31], v[86:87]
    v_cvt_pk_bf16_f32 v232, v24, v25
    v_cvt_pk_bf16_f32 v233, v26, v27
    v_cvt_pk_bf16_f32 v234, v28, v29
    v_cvt_pk_bf16_f32 v235, v30, v31
    buffer_store_dwordx4 v[232:235], v3, s[36:39], s62 offen
L_p5_skip_c:
L_end:
    s_endpgm

.section .rodata,"a"
.p2align 6
.amdhsa_kernel sequential_preLN__softmax_full_mha__glu_gated_reglu__prompt_kernel
  .amdhsa_next_free_vgpr 256
  .amdhsa_next_free_sgpr 102
  .amdhsa_accum_offset 256
  .amdhsa_group_segment_fixed_size 0
  .amdhsa_kernarg_size 80
  .amdhsa_user_sgpr_count 2
  .amdhsa_user_sgpr_kernarg_segment_ptr 1
  .amdhsa_system_sgpr_workgroup_id_x 1
.end_amdhsa_kernel
```
